```python
import torch

def _softmax(x, axis=-1):
    return torch.softmax(x, dim=axis)
def _gelu(x):
    return torch.nn.functional.gelu(x, approximate="tanh")
def _silu(x):
    return torch.nn.functional.silu(x)
def _sigmoid(x):
    return torch.sigmoid(x)
def _layernorm(x, axis=-1, eps=1e-5):
    m = x.mean(dim=axis, keepdim=True)
    v = x.var(dim=axis, keepdim=True, unbiased=False)
    return (x - m) / torch.sqrt(v + eps)
def _scatter_add(tgt, idx, src, axis=0):
    return tgt.clone().index_add_(axis, idx, src)
def _segment_sum(src, seg, n):
    out = torch.zeros((n,) + src.shape[1:], dtype=src.dtype)
    return out.index_add_(0, seg, src)
def _pad(x, pw):
    flat = tuple(v for pair in reversed(pw) for v in pair)
    return torch.nn.functional.pad(x, flat)

kernel_name = 'interleave_layers__ssm_conv_h3__dense_activation_silu__prompt'

def setup_inputs():

    _w = (lambda a: (lambda t: t.to(torch.bfloat16) if t.is_floating_point() else t)(torch.as_tensor(a)))
    def _A_setup():
        B, S, D = 1, 2048, 640
        ks = 4
        return {
            "q": _w((lambda *s: torch.randn(*s, dtype=torch.bfloat16) * 0.05)(B, S, D)),
            "k": _w((lambda *s: torch.randn(*s, dtype=torch.bfloat16) * 0.2)(B, S, D)),
            "v": _w((lambda *s: torch.randn(*s, dtype=torch.bfloat16) * 0.2)(B, S, D)),
            "shift_k": _w((lambda *s: torch.randn(*s, dtype=torch.bfloat16) * 0.2)(D, ks) * 0.5),
            "ssm_k": _w((lambda *s: torch.randn(*s, dtype=torch.bfloat16) * 0.8)(D, S) * (1.0 / S ** 0.5)),
            "ssm_D": _w((lambda *s: torch.randn(*s, dtype=torch.bfloat16) * 0.2)(D)),
        }
    _A_in = _A_setup()

    def _B_setup():
        B, S, D, F = 1, 2048, 640, 1728
        return {
            "x": _w((lambda *s: torch.randn(*s, dtype=torch.bfloat16) * 0.05)(B, S, D)),
            "w1": _w((lambda *s: torch.randn(*s, dtype=torch.bfloat16) * 0.8)(D, F) * (D ** -0.5)),
            "w2": _w((lambda *s: torch.randn(*s, dtype=torch.bfloat16) * 0.2)(F, D) * (F ** -0.5)),
        }
    _B_in = _B_setup()

    return {
        "A_q": _A_in["q"],
        "A_k": _A_in["k"],
        "A_v": _A_in["v"],
        "A_shift_k": _A_in["shift_k"],
        "A_ssm_k": _A_in["ssm_k"],
        "A_ssm_D": _A_in["ssm_D"],
        "B_x": _B_in["x"],
        "B_w1": _B_in["w1"],
        "B_w2": _B_in["w2"],
    }

def reference(A_q, A_k, A_v, A_shift_k, A_ssm_k, A_ssm_D, B_x, B_w1, B_w2):
    def _A_ref(q, k, v, shift_k, ssm_k, ssm_D):
        B, S, D = q.shape
        ks = shift_k.shape[-1]
        k_pad = _pad(k, ((0, 0), (ks - 1, 0), (0, 0)))
        k_shift = torch.zeros_like(k)
        for t in range(ks):
            k_shift = k_shift + k_pad[:, t:t + S, :] * shift_k[:, ks - 1 - t][None, None, :]
        kv = k_shift * v
        L = 2 * S
        kv_pad = _pad(kv, ((0, 0), (0, S), (0, 0)))
        kf_pad = _pad(ssm_k, ((0, 0), (0, S)))
        kv_f = (lambda x, axes=(-2,-1): torch.fft.rfft2(x.float(), dim=axes))(kv_pad[:, None, :, :], axes=(1, 2))
        kf_f = (lambda x, axes=(-2,-1): torch.fft.rfft2(x.float(), dim=axes))(kf_pad[:, None, :], axes=(1, 2))
        kf_f = (lambda x, *d: x.permute(*d))(kf_f, 1, 2, 0)
        y_f = kv_f * kf_f[None, :, :, :]
        y = (lambda x, s, axes=(-2,-1): torch.fft.irfft2(x, s=s, dim=axes).to(torch.bfloat16))(y_f, (1, L), axes=(1, 2))[:, 0, :S, :]
        y = y + kv * ssm_D[None, None, :]
        return q * y

    def _B_ref(x, w1, w2):
        h = torch.einsum("bsd,df->bsf", x, w1)
        h = _silu(h)
        out = torch.einsum("bsf,fd->bsd", h, w2)
        return out

    x = A_q
    x = x + _A_ref(_layernorm(x, axis=-1), A_k, A_v, A_shift_k, A_ssm_k, A_ssm_D)
    x = x + _B_ref(_layernorm(x, axis=-1), B_w1, B_w2)
    x = x + _A_ref(_layernorm(x, axis=-1), A_k, A_v, A_shift_k, A_ssm_k, A_ssm_D)
    x = x + _B_ref(_layernorm(x, axis=-1), B_w1, B_w2)
    return x
```

```asm
; @launch kernel=k0_kernel grid=(160,1,1) block=(256,1,1) lds=0
; @launch kernel=k1_kernel grid=(242,1,1) block=(256,1,1) lds=151552
; @launch kernel=g1a_kernel grid=(256,1,1) block=(512,1,1) lds=82432
; @launch kernel=g2a_kernel grid=(256,1,1) block=(256,1,1) lds=61440
; @launch kernel=g1b_kernel grid=(256,1,1) block=(512,1,1) lds=82432
; @launch kernel=g2b_kernel grid=(256,1,1) block=(256,1,1) lds=61440
.amdgcn_target "amdgcn-amd-amdhsa--gfx950"
.text
.p2align 8
.globl k0_kernel
.type k0_kernel,@function
k0_kernel:
    s_cmp_ge_u32 s2, 160
    s_cbranch_scc1 k0_exit
    s_load_dwordx16 s[16:31], s[0:1], 0
    s_load_dwordx8 s[32:39], s[0:1], 64
    v_lshrrev_b32 v1, 6, v0
    v_and_b32 v2, 63, v0
    v_readfirstlane_b32 s3, v1
    s_waitcnt lgkmcnt(0)
    s_mov_b32 s40, s18
    s_mov_b32 s41, s19
    s_mov_b32 s42, 0x280000
    s_mov_b32 s43, 0x00020000
    s_mov_b32 s44, s20
    s_mov_b32 s45, s21
    s_mov_b32 s46, 0x280000
    s_mov_b32 s47, 0x00020000
    s_add_u32 s48, s38, 0x2400000
    s_addc_u32 s49, s39, 0
    s_mov_b32 s50, 0x280000
    s_mov_b32 s51, 0x00020000
    s_mov_b32 s52, s22
    s_mov_b32 s53, s23
    s_mov_b32 s54, 0x1400
    s_mov_b32 s55, 0x00020000
    s_lshl_b32 s4, s2, 2
    s_add_u32 s4, s4, s3
    s_mul_hi_u32 s5, s4, 0xccccccd
    s_mul_i32 s6, s5, 20
    s_sub_u32 s6, s4, s6
    v_and_b32 v9, 7, v2
    v_lshrrev_b32 v10, 3, v2
    s_lshl_b32 s7, s5, 6
    v_lshl_add_u32 v11, v10, 3, s7
    v_mul_u32_u24 v3, 1280, v11
    s_lshl_b32 s8, s6, 6
    v_lshl_add_u32 v12, v9, 3, s8
    v_add_u32 v3, v3, v12
    v_subrev_u32 v4, 3840, v3
    s_mov_b32 s58, 3840
    s_mov_b32 s59, 7680
    buffer_load_dwordx2 v[16:17], v4, s[40:43], 0 offen offset:0
    buffer_load_dwordx2 v[18:19], v4, s[40:43], 0 offen offset:1280
    buffer_load_dwordx2 v[20:21], v4, s[40:43], 0 offen offset:2560
    buffer_load_dwordx2 v[22:23], v3, s[40:43], 0 offen offset:0
    buffer_load_dwordx2 v[24:25], v3, s[40:43], 0 offen offset:1280
    buffer_load_dwordx2 v[26:27], v3, s[40:43], 0 offen offset:2560
    buffer_load_dwordx2 v[28:29], v3, s[40:43], s58 offen offset:0
    buffer_load_dwordx2 v[30:31], v3, s[40:43], s58 offen offset:1280
    buffer_load_dwordx2 v[32:33], v3, s[40:43], s58 offen offset:2560
    buffer_load_dwordx2 v[34:35], v3, s[40:43], s59 offen offset:0
    buffer_load_dwordx2 v[36:37], v3, s[40:43], s59 offen offset:1280
    buffer_load_dwordx2 v[38:39], v3, s[44:47], 0 offen offset:0
    buffer_load_dwordx2 v[40:41], v3, s[44:47], 0 offen offset:1280
    buffer_load_dwordx2 v[42:43], v3, s[44:47], 0 offen offset:2560
    buffer_load_dwordx2 v[44:45], v3, s[44:47], s58 offen offset:0
    buffer_load_dwordx2 v[46:47], v3, s[44:47], s58 offen offset:1280
    buffer_load_dwordx2 v[48:49], v3, s[44:47], s58 offen offset:2560
    buffer_load_dwordx2 v[50:51], v3, s[44:47], s59 offen offset:0
    buffer_load_dwordx2 v[52:53], v3, s[44:47], s59 offen offset:1280
    v_lshlrev_b32 v13, 2, v12
    buffer_load_dwordx4 v[56:59], v13, s[52:55], 0 offen offset:0
    buffer_load_dwordx4 v[60:63], v13, s[52:55], 0 offen offset:16
    v_lshlrev_b32 v14, 11, v12
    v_lshl_add_u32 v14, v11, 1, v14
    s_mov_b32 s92, 0xffff0000
    s_waitcnt vmcnt(0)
    v_lshlrev_b32 v64, 16, v16
    v_lshlrev_b32 v65, 16, v18
    v_lshlrev_b32 v66, 16, v20
    v_lshlrev_b32 v67, 16, v22
    v_lshlrev_b32 v68, 16, v24
    v_lshlrev_b32 v69, 16, v26
    v_lshlrev_b32 v70, 16, v28
    v_lshlrev_b32 v71, 16, v30
    v_lshlrev_b32 v72, 16, v32
    v_lshlrev_b32 v73, 16, v34
    v_lshlrev_b32 v74, 16, v36
    v_lshlrev_b32 v76, 16, v38
    v_lshlrev_b32 v77, 16, v40
    v_lshlrev_b32 v78, 16, v42
    v_lshlrev_b32 v79, 16, v44
    v_lshlrev_b32 v80, 16, v46
    v_lshlrev_b32 v81, 16, v48
    v_lshlrev_b32 v82, 16, v50
    v_lshlrev_b32 v83, 16, v52
    v_lshlrev_b32 v92, 16, v56
    v_and_b32 v93, s92, v56
    v_lshlrev_b32 v94, 16, v57
    v_and_b32 v95, s92, v57
    v_mul_f32 v84, v95, v64
    v_mul_f32 v85, v95, v65
    v_mul_f32 v86, v95, v66
    v_mul_f32 v87, v95, v67
    v_mul_f32 v88, v95, v68
    v_mul_f32 v89, v95, v69
    v_mul_f32 v90, v95, v70
    v_mul_f32 v91, v95, v71
    v_fma_f32 v84, v65, v94, v84
    v_fma_f32 v85, v66, v94, v85
    v_fma_f32 v86, v67, v94, v86
    v_fma_f32 v87, v68, v94, v87
    v_fma_f32 v88, v69, v94, v88
    v_fma_f32 v89, v70, v94, v89
    v_fma_f32 v90, v71, v94, v90
    v_fma_f32 v91, v72, v94, v91
    v_fma_f32 v84, v66, v93, v84
    v_fma_f32 v85, v67, v93, v85
    v_fma_f32 v86, v68, v93, v86
    v_fma_f32 v87, v69, v93, v87
    v_fma_f32 v88, v70, v93, v88
    v_fma_f32 v89, v71, v93, v89
    v_fma_f32 v90, v72, v93, v90
    v_fma_f32 v91, v73, v93, v91
    v_fma_f32 v84, v67, v92, v84
    v_fma_f32 v85, v68, v92, v85
    v_fma_f32 v86, v69, v92, v86
    v_fma_f32 v87, v70, v92, v87
    v_fma_f32 v88, v71, v92, v88
    v_fma_f32 v89, v72, v92, v89
    v_fma_f32 v90, v73, v92, v90
    v_fma_f32 v91, v74, v92, v91
    v_mul_f32 v84, v84, v76
    v_mul_f32 v85, v85, v77
    v_mul_f32 v86, v86, v78
    v_mul_f32 v87, v87, v79
    v_mul_f32 v88, v88, v80
    v_mul_f32 v89, v89, v81
    v_mul_f32 v90, v90, v82
    v_mul_f32 v91, v91, v83
    v_cvt_pk_bf16_f32 v96, v84, v85
    v_cvt_pk_bf16_f32 v97, v86, v87
    v_cvt_pk_bf16_f32 v98, v88, v89
    v_cvt_pk_bf16_f32 v99, v90, v91
    buffer_store_dwordx4 v[96:99], v14, s[48:51], 0 offen sc1
    v_and_b32 v64, s92, v16
    v_and_b32 v65, s92, v18
    v_and_b32 v66, s92, v20
    v_and_b32 v67, s92, v22
    v_and_b32 v68, s92, v24
    v_and_b32 v69, s92, v26
    v_and_b32 v70, s92, v28
    v_and_b32 v71, s92, v30
    v_and_b32 v72, s92, v32
    v_and_b32 v73, s92, v34
    v_and_b32 v74, s92, v36
    v_and_b32 v76, s92, v38
    v_and_b32 v77, s92, v40
    v_and_b32 v78, s92, v42
    v_and_b32 v79, s92, v44
    v_and_b32 v80, s92, v46
    v_and_b32 v81, s92, v48
    v_and_b32 v82, s92, v50
    v_and_b32 v83, s92, v52
    v_lshlrev_b32 v92, 16, v58
    v_and_b32 v93, s92, v58
    v_lshlrev_b32 v94, 16, v59
    v_and_b32 v95, s92, v59
    v_mul_f32 v84, v95, v64
    v_mul_f32 v85, v95, v65
    v_mul_f32 v86, v95, v66
    v_mul_f32 v87, v95, v67
    v_mul_f32 v88, v95, v68
    v_mul_f32 v89, v95, v69
    v_mul_f32 v90, v95, v70
    v_mul_f32 v91, v95, v71
    v_fma_f32 v84, v65, v94, v84
    v_fma_f32 v85, v66, v94, v85
    v_fma_f32 v86, v67, v94, v86
    v_fma_f32 v87, v68, v94, v87
    v_fma_f32 v88, v69, v94, v88
    v_fma_f32 v89, v70, v94, v89
    v_fma_f32 v90, v71, v94, v90
    v_fma_f32 v91, v72, v94, v91
    v_fma_f32 v84, v66, v93, v84
    v_fma_f32 v85, v67, v93, v85
    v_fma_f32 v86, v68, v93, v86
    v_fma_f32 v87, v69, v93, v87
    v_fma_f32 v88, v70, v93, v88
    v_fma_f32 v89, v71, v93, v89
    v_fma_f32 v90, v72, v93, v90
    v_fma_f32 v91, v73, v93, v91
    v_fma_f32 v84, v67, v92, v84
    v_fma_f32 v85, v68, v92, v85
    v_fma_f32 v86, v69, v92, v86
    v_fma_f32 v87, v70, v92, v87
    v_fma_f32 v88, v71, v92, v88
    v_fma_f32 v89, v72, v92, v89
    v_fma_f32 v90, v73, v92, v90
    v_fma_f32 v91, v74, v92, v91
    v_mul_f32 v84, v84, v76
    v_mul_f32 v85, v85, v77
    v_mul_f32 v86, v86, v78
    v_mul_f32 v87, v87, v79
    v_mul_f32 v88, v88, v80
    v_mul_f32 v89, v89, v81
    v_mul_f32 v90, v90, v82
    v_mul_f32 v91, v91, v83
    v_cvt_pk_bf16_f32 v100, v84, v85
    v_cvt_pk_bf16_f32 v101, v86, v87
    v_cvt_pk_bf16_f32 v102, v88, v89
    v_cvt_pk_bf16_f32 v103, v90, v91
    s_mov_b32 s9, 4096
    buffer_store_dwordx4 v[100:103], v14, s[48:51], s9 offen sc1
    v_lshlrev_b32 v64, 16, v17
    v_lshlrev_b32 v65, 16, v19
    v_lshlrev_b32 v66, 16, v21
    v_lshlrev_b32 v67, 16, v23
    v_lshlrev_b32 v68, 16, v25
    v_lshlrev_b32 v69, 16, v27
    v_lshlrev_b32 v70, 16, v29
    v_lshlrev_b32 v71, 16, v31
    v_lshlrev_b32 v72, 16, v33
    v_lshlrev_b32 v73, 16, v35
    v_lshlrev_b32 v74, 16, v37
    v_lshlrev_b32 v76, 16, v39
    v_lshlrev_b32 v77, 16, v41
    v_lshlrev_b32 v78, 16, v43
    v_lshlrev_b32 v79, 16, v45
    v_lshlrev_b32 v80, 16, v47
    v_lshlrev_b32 v81, 16, v49
    v_lshlrev_b32 v82, 16, v51
    v_lshlrev_b32 v83, 16, v53
    v_lshlrev_b32 v92, 16, v60
    v_and_b32 v93, s92, v60
    v_lshlrev_b32 v94, 16, v61
    v_and_b32 v95, s92, v61
    v_mul_f32 v84, v95, v64
    v_mul_f32 v85, v95, v65
    v_mul_f32 v86, v95, v66
    v_mul_f32 v87, v95, v67
    v_mul_f32 v88, v95, v68
    v_mul_f32 v89, v95, v69
    v_mul_f32 v90, v95, v70
    v_mul_f32 v91, v95, v71
    v_fma_f32 v84, v65, v94, v84
    v_fma_f32 v85, v66, v94, v85
    v_fma_f32 v86, v67, v94, v86
    v_fma_f32 v87, v68, v94, v87
    v_fma_f32 v88, v69, v94, v88
    v_fma_f32 v89, v70, v94, v89
    v_fma_f32 v90, v71, v94, v90
    v_fma_f32 v91, v72, v94, v91
    v_fma_f32 v84, v66, v93, v84
    v_fma_f32 v85, v67, v93, v85
    v_fma_f32 v86, v68, v93, v86
    v_fma_f32 v87, v69, v93, v87
    v_fma_f32 v88, v70, v93, v88
    v_fma_f32 v89, v71, v93, v89
    v_fma_f32 v90, v72, v93, v90
    v_fma_f32 v91, v73, v93, v91
    v_fma_f32 v84, v67, v92, v84
    v_fma_f32 v85, v68, v92, v85
    v_fma_f32 v86, v69, v92, v86
    v_fma_f32 v87, v70, v92, v87
    v_fma_f32 v88, v71, v92, v88
    v_fma_f32 v89, v72, v92, v89
    v_fma_f32 v90, v73, v92, v90
    v_fma_f32 v91, v74, v92, v91
    v_mul_f32 v84, v84, v76
    v_mul_f32 v85, v85, v77
    v_mul_f32 v86, v86, v78
    v_mul_f32 v87, v87, v79
    v_mul_f32 v88, v88, v80
    v_mul_f32 v89, v89, v81
    v_mul_f32 v90, v90, v82
    v_mul_f32 v91, v91, v83
    v_cvt_pk_bf16_f32 v104, v84, v85
    v_cvt_pk_bf16_f32 v105, v86, v87
    v_cvt_pk_bf16_f32 v106, v88, v89
    v_cvt_pk_bf16_f32 v107, v90, v91
    s_mov_b32 s9, 8192
    buffer_store_dwordx4 v[104:107], v14, s[48:51], s9 offen sc1
    v_and_b32 v64, s92, v17
    v_and_b32 v65, s92, v19
    v_and_b32 v66, s92, v21
    v_and_b32 v67, s92, v23
    v_and_b32 v68, s92, v25
    v_and_b32 v69, s92, v27
    v_and_b32 v70, s92, v29
    v_and_b32 v71, s92, v31
    v_and_b32 v72, s92, v33
    v_and_b32 v73, s92, v35
    v_and_b32 v74, s92, v37
    v_and_b32 v76, s92, v39
    v_and_b32 v77, s92, v41
    v_and_b32 v78, s92, v43
    v_and_b32 v79, s92, v45
    v_and_b32 v80, s92, v47
    v_and_b32 v81, s92, v49
    v_and_b32 v82, s92, v51
    v_and_b32 v83, s92, v53
    v_lshlrev_b32 v92, 16, v62
    v_and_b32 v93, s92, v62
    v_lshlrev_b32 v94, 16, v63
    v_and_b32 v95, s92, v63
    v_mul_f32 v84, v95, v64
    v_mul_f32 v85, v95, v65
    v_mul_f32 v86, v95, v66
    v_mul_f32 v87, v95, v67
    v_mul_f32 v88, v95, v68
    v_mul_f32 v89, v95, v69
    v_mul_f32 v90, v95, v70
    v_mul_f32 v91, v95, v71
    v_fma_f32 v84, v65, v94, v84
    v_fma_f32 v85, v66, v94, v85
    v_fma_f32 v86, v67, v94, v86
    v_fma_f32 v87, v68, v94, v87
    v_fma_f32 v88, v69, v94, v88
    v_fma_f32 v89, v70, v94, v89
    v_fma_f32 v90, v71, v94, v90
    v_fma_f32 v91, v72, v94, v91
    v_fma_f32 v84, v66, v93, v84
    v_fma_f32 v85, v67, v93, v85
    v_fma_f32 v86, v68, v93, v86
    v_fma_f32 v87, v69, v93, v87
    v_fma_f32 v88, v70, v93, v88
    v_fma_f32 v89, v71, v93, v89
    v_fma_f32 v90, v72, v93, v90
    v_fma_f32 v91, v73, v93, v91
    v_fma_f32 v84, v67, v92, v84
    v_fma_f32 v85, v68, v92, v85
    v_fma_f32 v86, v69, v92, v86
    v_fma_f32 v87, v70, v92, v87
    v_fma_f32 v88, v71, v92, v88
    v_fma_f32 v89, v72, v92, v89
    v_fma_f32 v90, v73, v92, v90
    v_fma_f32 v91, v74, v92, v91
    v_mul_f32 v84, v84, v76
    v_mul_f32 v85, v85, v77
    v_mul_f32 v86, v86, v78
    v_mul_f32 v87, v87, v79
    v_mul_f32 v88, v88, v80
    v_mul_f32 v89, v89, v81
    v_mul_f32 v90, v90, v82
    v_mul_f32 v91, v91, v83
    v_cvt_pk_bf16_f32 v108, v84, v85
    v_cvt_pk_bf16_f32 v109, v86, v87
    v_cvt_pk_bf16_f32 v110, v88, v89
    v_cvt_pk_bf16_f32 v111, v90, v91
    s_mov_b32 s9, 12288
    buffer_store_dwordx4 v[108:111], v14, s[48:51], s9 offen sc1
    s_endpgm
k0_exit:
    s_endpgm
.p2align 8
.globl k1_kernel
.type k1_kernel,@function
k1_kernel:
    s_cmp_ge_u32 s2, 242
    s_cbranch_scc1 k1_exit
    s_load_dwordx16 s[16:31], s[0:1], 0
    s_load_dwordx8 s[32:39], s[0:1], 64
    v_lshrrev_b32 v1, 6, v0
    v_and_b32 v2, 63, v0
    v_readfirstlane_b32 s3, v1
    s_cmp_ge_u32 s2, 160
    s_cbranch_scc1 k1_jobs
    s_and_b32 s4, s2, 7
    s_mul_i32 s4, s4, 20
    s_lshr_b32 s5, s2, 3
    s_add_u32 s57, s4, s5
    s_lshl_b32 s56, s57, 3
    s_lshl_b32 s60, s57, 2
    s_add_u32 s60, s60, s3
    s_lshl_b32 s60, s60, 12
    v_lshlrev_b32 v5, 4, v2
    v_add_u32 v5, s60, v5
    v_subrev_u32 v6, 16, v5
    s_mul_i32 s63, s3, 4608
    s_add_u32 s63, s63, 133120
    s_waitcnt lgkmcnt(0)
    s_mov_b32 s48, s24
    s_mov_b32 s49, s25
    s_mov_b32 s50, 0x280000
    s_mov_b32 s51, 0x00020000
    s_add_u32 s40, s38, 0x2400000
    s_addc_u32 s41, s39, 0
    s_mov_b32 s42, 0x280000
    s_mov_b32 s43, 0x00020000
    buffer_load_dwordx4 v[48:51], v6, s[48:51], 0 offen offset:0
    buffer_load_dwordx4 v[52:55], v5, s[48:51], 0 offen offset:0
    buffer_load_dwordx4 v[56:59], v6, s[48:51], 0 offen offset:1024
    buffer_load_dwordx4 v[60:63], v5, s[48:51], 0 offen offset:1024
    buffer_load_dwordx4 v[64:67], v6, s[48:51], 0 offen offset:2048
    buffer_load_dwordx4 v[68:71], v5, s[48:51], 0 offen offset:2048
    buffer_load_dwordx4 v[72:75], v6, s[48:51], 0 offen offset:3072
    buffer_load_dwordx4 v[76:79], v5, s[48:51], 0 offen offset:3072
    s_add_u32 m0, s63, 512
    s_nop 0
    buffer_load_dwordx4 v5, s[40:43], 0 offen offset:0 lds
    buffer_load_dwordx4 v5, s[40:43], 0 offen offset:1024 lds
    buffer_load_dwordx4 v5, s[40:43], 0 offen offset:2048 lds
    buffer_load_dwordx4 v5, s[40:43], 0 offen offset:3072 lds
    s_load_dwordx2 s[72:73], s[26:27], s56
    s_mov_b32 s52, s38
    s_mov_b32 s53, s39
    s_mov_b32 s54, 0x280000
    s_mov_b32 s55, 0x00020000
    v_mov_b32 v80, 0
    v_mov_b32 v81, 0
    v_mov_b32 v82, 0
    v_mov_b32 v83, 0
    v_and_b32 v7, 31, v2
    v_lshlrev_b32 v7, 4, v7
    v_add_u32 v7, s63, v7
    ds_write_b128 v7, v[80:83]
    s_mul_i32 s61, s3, 33280
    v_and_b32 v7, 7, v2
    v_mul_u32_u24 v7, 4160, v7
    v_add_u32 v7, s61, v7
    ds_write_b128 v7, v[80:83]
    s_waitcnt lgkmcnt(0)
    s_lshl_b32 s62, s3, 4
    s_lshr_b64 s[74:75], s[72:73], s62
    s_lshl_b32 s74, s74, 16
    s_mov_b32 s92, 0xffff0000
    s_mov_b32 s93, 0x0000ffff
    v_lshlrev_b32 v7, 4, v2
    v_add_u32 v7, s61, v7
    s_waitcnt vmcnt(4)
    v_cmp_eq_u32 vcc, 0, v2
    s_nop 1
    v_cndmask_b32 v48, v48, v80, vcc
    v_cndmask_b32 v49, v49, v80, vcc
    v_cndmask_b32 v50, v50, v80, vcc
    v_cndmask_b32 v51, v51, v80, vcc
    v_bfi_b32 v84, s93, v52, v51
    v_bfi_b32 v85, s93, v51, v50
    v_bfi_b32 v86, s93, v50, v49
    v_bfi_b32 v87, s93, v49, v48
    ds_write_b128 v7, v[84:87] offset:16
    v_alignbit_b32 v88, v52, v52, 16
    v_alignbit_b32 v89, v51, v51, 16
    v_alignbit_b32 v90, v50, v50, 16
    v_alignbit_b32 v91, v49, v49, 16
    ds_write_b128 v7, v[88:91] offset:4176
    v_bfi_b32 v92, s93, v53, v52
    v_bfi_b32 v93, s93, v52, v51
    v_bfi_b32 v94, s93, v51, v50
    v_bfi_b32 v95, s93, v50, v49
    ds_write_b128 v7, v[92:95] offset:8336
    v_alignbit_b32 v96, v53, v53, 16
    v_alignbit_b32 v97, v52, v52, 16
    v_alignbit_b32 v98, v51, v51, 16
    v_alignbit_b32 v99, v50, v50, 16
    ds_write_b128 v7, v[96:99] offset:12496
    v_bfi_b32 v84, s93, v54, v53
    v_bfi_b32 v85, s93, v53, v52
    v_bfi_b32 v86, s93, v52, v51
    v_bfi_b32 v87, s93, v51, v50
    ds_write_b128 v7, v[84:87] offset:16656
    v_alignbit_b32 v88, v54, v54, 16
    v_alignbit_b32 v89, v53, v53, 16
    v_alignbit_b32 v90, v52, v52, 16
    v_alignbit_b32 v91, v51, v51, 16
    ds_write_b128 v7, v[88:91] offset:20816
    v_bfi_b32 v92, s93, v55, v54
    v_bfi_b32 v93, s93, v54, v53
    v_bfi_b32 v94, s93, v53, v52
    v_bfi_b32 v95, s93, v52, v51
    ds_write_b128 v7, v[92:95] offset:24976
    v_alignbit_b32 v96, v55, v55, 16
    v_alignbit_b32 v97, v54, v54, 16
    v_alignbit_b32 v98, v53, v53, 16
    v_alignbit_b32 v99, v52, v52, 16
    ds_write_b128 v7, v[96:99] offset:29136
    v_bfi_b32 v84, s93, v60, v59
    v_bfi_b32 v85, s93, v59, v58
    v_bfi_b32 v86, s93, v58, v57
    v_bfi_b32 v87, s93, v57, v56
    ds_write_b128 v7, v[84:87] offset:1040
    v_alignbit_b32 v88, v60, v60, 16
    v_alignbit_b32 v89, v59, v59, 16
    v_alignbit_b32 v90, v58, v58, 16
    v_alignbit_b32 v91, v57, v57, 16
    ds_write_b128 v7, v[88:91] offset:5200
    v_bfi_b32 v92, s93, v61, v60
    v_bfi_b32 v93, s93, v60, v59
    v_bfi_b32 v94, s93, v59, v58
    v_bfi_b32 v95, s93, v58, v57
    ds_write_b128 v7, v[92:95] offset:9360
    v_alignbit_b32 v96, v61, v61, 16
    v_alignbit_b32 v97, v60, v60, 16
    v_alignbit_b32 v98, v59, v59, 16
    v_alignbit_b32 v99, v58, v58, 16
    ds_write_b128 v7, v[96:99] offset:13520
    v_bfi_b32 v84, s93, v62, v61
    v_bfi_b32 v85, s93, v61, v60
    v_bfi_b32 v86, s93, v60, v59
    v_bfi_b32 v87, s93, v59, v58
    ds_write_b128 v7, v[84:87] offset:17680
    v_alignbit_b32 v88, v62, v62, 16
    v_alignbit_b32 v89, v61, v61, 16
    v_alignbit_b32 v90, v60, v60, 16
    v_alignbit_b32 v91, v59, v59, 16
    ds_write_b128 v7, v[88:91] offset:21840
    v_bfi_b32 v92, s93, v63, v62
    v_bfi_b32 v93, s93, v62, v61
    v_bfi_b32 v94, s93, v61, v60
    v_bfi_b32 v95, s93, v60, v59
    ds_write_b128 v7, v[92:95] offset:26000
    v_alignbit_b32 v96, v63, v63, 16
    v_alignbit_b32 v97, v62, v62, 16
    v_alignbit_b32 v98, v61, v61, 16
    v_alignbit_b32 v99, v60, v60, 16
    ds_write_b128 v7, v[96:99] offset:30160
    v_bfi_b32 v84, s93, v68, v67
    v_bfi_b32 v85, s93, v67, v66
    v_bfi_b32 v86, s93, v66, v65
    v_bfi_b32 v87, s93, v65, v64
    ds_write_b128 v7, v[84:87] offset:2064
    v_alignbit_b32 v88, v68, v68, 16
    v_alignbit_b32 v89, v67, v67, 16
    v_alignbit_b32 v90, v66, v66, 16
    v_alignbit_b32 v91, v65, v65, 16
    ds_write_b128 v7, v[88:91] offset:6224
    v_bfi_b32 v92, s93, v69, v68
    v_bfi_b32 v93, s93, v68, v67
    v_bfi_b32 v94, s93, v67, v66
    v_bfi_b32 v95, s93, v66, v65
    ds_write_b128 v7, v[92:95] offset:10384
    v_alignbit_b32 v96, v69, v69, 16
    v_alignbit_b32 v97, v68, v68, 16
    v_alignbit_b32 v98, v67, v67, 16
    v_alignbit_b32 v99, v66, v66, 16
    ds_write_b128 v7, v[96:99] offset:14544
    v_bfi_b32 v84, s93, v70, v69
    v_bfi_b32 v85, s93, v69, v68
    v_bfi_b32 v86, s93, v68, v67
    v_bfi_b32 v87, s93, v67, v66
    ds_write_b128 v7, v[84:87] offset:18704
    v_alignbit_b32 v88, v70, v70, 16
    v_alignbit_b32 v89, v69, v69, 16
    v_alignbit_b32 v90, v68, v68, 16
    v_alignbit_b32 v91, v67, v67, 16
    ds_write_b128 v7, v[88:91] offset:22864
    v_bfi_b32 v92, s93, v71, v70
    v_bfi_b32 v93, s93, v70, v69
    v_bfi_b32 v94, s93, v69, v68
    v_bfi_b32 v95, s93, v68, v67
    ds_write_b128 v7, v[92:95] offset:27024
    v_alignbit_b32 v96, v71, v71, 16
    v_alignbit_b32 v97, v70, v70, 16
    v_alignbit_b32 v98, v69, v69, 16
    v_alignbit_b32 v99, v68, v68, 16
    ds_write_b128 v7, v[96:99] offset:31184
    v_bfi_b32 v84, s93, v76, v75
    v_bfi_b32 v85, s93, v75, v74
    v_bfi_b32 v86, s93, v74, v73
    v_bfi_b32 v87, s93, v73, v72
    ds_write_b128 v7, v[84:87] offset:3088
    v_alignbit_b32 v88, v76, v76, 16
    v_alignbit_b32 v89, v75, v75, 16
    v_alignbit_b32 v90, v74, v74, 16
    v_alignbit_b32 v91, v73, v73, 16
    ds_write_b128 v7, v[88:91] offset:7248
    v_bfi_b32 v92, s93, v77, v76
    v_bfi_b32 v93, s93, v76, v75
    v_bfi_b32 v94, s93, v75, v74
    v_bfi_b32 v95, s93, v74, v73
    ds_write_b128 v7, v[92:95] offset:11408
    v_alignbit_b32 v96, v77, v77, 16
    v_alignbit_b32 v97, v76, v76, 16
    v_alignbit_b32 v98, v75, v75, 16
    v_alignbit_b32 v99, v74, v74, 16
    ds_write_b128 v7, v[96:99] offset:15568
    v_bfi_b32 v84, s93, v78, v77
    v_bfi_b32 v85, s93, v77, v76
    v_bfi_b32 v86, s93, v76, v75
    v_bfi_b32 v87, s93, v75, v74
    ds_write_b128 v7, v[84:87] offset:19728
    v_alignbit_b32 v88, v78, v78, 16
    v_alignbit_b32 v89, v77, v77, 16
    v_alignbit_b32 v90, v76, v76, 16
    v_alignbit_b32 v91, v75, v75, 16
    ds_write_b128 v7, v[88:91] offset:23888
    v_bfi_b32 v92, s93, v79, v78
    v_bfi_b32 v93, s93, v78, v77
    v_bfi_b32 v94, s93, v77, v76
    v_bfi_b32 v95, s93, v76, v75
    ds_write_b128 v7, v[92:95] offset:28048
    v_alignbit_b32 v96, v79, v79, 16
    v_alignbit_b32 v97, v78, v78, 16
    v_alignbit_b32 v98, v77, v77, 16
    v_alignbit_b32 v99, v76, v76, 16
    ds_write_b128 v7, v[96:99] offset:32208
    v_and_b32 v9, 15, v2
    v_lshrrev_b32 v10, 4, v2
    v_and_b32 v11, 7, v9
    v_mul_u32_u24 v11, 4160, v11
    v_lshrrev_b32 v12, 3, v9
    v_add_u32 v12, 3, v12
    v_sub_u32 v12, v12, v10
    v_lshl_add_u32 v11, v12, 4, v11
    v_add_u32 v5, s61, v11
    v_lshlrev_b32 v11, 5, v9
    v_lshl_add_u32 v11, v10, 4, v11
    v_add_u32 v6, s63, v11
    v_add_u32 v6, 32, v6
    v_lshlrev_b32 v11, 5, v9
    v_lshl_add_u32 v11, v10, 3, v11
    v_add_u32 v7, s63, v11
    v_add_u32 v7, 0x200, v7
    v_mov_b32 v16, 0
    v_mov_b32 v17, 0
    v_mov_b32 v18, 0
    v_mov_b32 v19, 0
    v_mov_b32 v20, 0
    v_mov_b32 v21, 0
    v_mov_b32 v22, 0
    v_mov_b32 v23, 0
    v_mov_b32 v24, 0
    v_mov_b32 v25, 0
    v_mov_b32 v26, 0
    v_mov_b32 v27, 0
    v_mov_b32 v28, 0
    v_mov_b32 v29, 0
    v_mov_b32 v30, 0
    v_mov_b32 v31, 0
    v_mov_b32 v32, 0
    v_mov_b32 v33, 0
    v_mov_b32 v34, 0
    v_mov_b32 v35, 0
    v_mov_b32 v36, 0
    v_mov_b32 v37, 0
    v_mov_b32 v38, 0
    v_mov_b32 v39, 0
    v_mov_b32 v40, 0
    v_mov_b32 v41, 0
    v_mov_b32 v42, 0
    v_mov_b32 v43, 0
    v_mov_b32 v44, 0
    v_mov_b32 v45, 0
    v_mov_b32 v46, 0
    v_mov_b32 v47, 0
    s_waitcnt vmcnt(0)
    s_waitcnt lgkmcnt(0)
    ds_read_b128 v[80:83], v6 offset:448
    ds_read_b128 v[48:51], v5 offset:0
    ds_read_b128 v[84:87], v6 offset:960
    ds_read_b128 v[52:55], v5 offset:512
    ds_read_b128 v[88:91], v6 offset:1472
    ds_read_b128 v[56:59], v5 offset:1024
    ds_read_b128 v[92:95], v6 offset:1984
    ds_read_b128 v[60:63], v5 offset:1536
    ds_read_b128 v[96:99], v6 offset:2496
    ds_read_b128 v[64:67], v5 offset:2048
    ds_read_b128 v[100:103], v6 offset:3008
    ds_read_b128 v[68:71], v5 offset:2560
    ds_read_b128 v[104:107], v6 offset:3520
    ds_read_b128 v[72:75], v5 offset:3072
    ds_read_b128 v[108:111], v6 offset:4032
    ds_read_b128 v[76:79], v5 offset:3584
    s_waitcnt lgkmcnt(0)
    ds_read_b128 v[144:147], v6 offset:384
    ds_read_b128 v[112:115], v5 offset:64
    ds_read_b128 v[148:151], v6 offset:896
    ds_read_b128 v[116:119], v5 offset:576
    ds_read_b128 v[152:155], v6 offset:1408
    ds_read_b128 v[120:123], v5 offset:1088
    ds_read_b128 v[156:159], v6 offset:1920
    ds_read_b128 v[124:127], v5 offset:1600
    ds_read_b128 v[160:163], v6 offset:2432
    ds_read_b128 v[128:131], v5 offset:2112
    ds_read_b128 v[164:167], v6 offset:2944
    ds_read_b128 v[132:135], v5 offset:2624
    ds_read_b128 v[168:171], v6 offset:3456
    ds_read_b128 v[136:139], v5 offset:3136
    ds_read_b128 v[172:175], v6 offset:3968
    ds_read_b128 v[140:143], v5 offset:3648
    v_mfma_f32_16x16x32_bf16 v[16:19], v[48:51], v[80:83], v[16:19]
    v_mfma_f32_16x16x32_bf16 v[20:23], v[48:51], v[84:87], v[20:23]
    v_mfma_f32_16x16x32_bf16 v[24:27], v[48:51], v[88:91], v[24:27]
    v_mfma_f32_16x16x32_bf16 v[28:31], v[48:51], v[92:95], v[28:31]
    v_mfma_f32_16x16x32_bf16 v[32:35], v[48:51], v[96:99], v[32:35]
    v_mfma_f32_16x16x32_bf16 v[36:39], v[48:51], v[100:103], v[36:39]
    v_mfma_f32_16x16x32_bf16 v[40:43], v[48:51], v[104:107], v[40:43]
    v_mfma_f32_16x16x32_bf16 v[44:47], v[48:51], v[108:111], v[44:47]
    v_mfma_f32_16x16x32_bf16 v[20:23], v[52:55], v[80:83], v[20:23]
    v_mfma_f32_16x16x32_bf16 v[24:27], v[52:55], v[84:87], v[24:27]
    v_mfma_f32_16x16x32_bf16 v[28:31], v[52:55], v[88:91], v[28:31]
    v_mfma_f32_16x16x32_bf16 v[32:35], v[52:55], v[92:95], v[32:35]
    v_mfma_f32_16x16x32_bf16 v[36:39], v[52:55], v[96:99], v[36:39]
    v_mfma_f32_16x16x32_bf16 v[40:43], v[52:55], v[100:103], v[40:43]
    v_mfma_f32_16x16x32_bf16 v[44:47], v[52:55], v[104:107], v[44:47]
    v_mfma_f32_16x16x32_bf16 v[24:27], v[56:59], v[80:83], v[24:27]
    v_mfma_f32_16x16x32_bf16 v[28:31], v[56:59], v[84:87], v[28:31]
    v_mfma_f32_16x16x32_bf16 v[32:35], v[56:59], v[88:91], v[32:35]
    v_mfma_f32_16x16x32_bf16 v[36:39], v[56:59], v[92:95], v[36:39]
    v_mfma_f32_16x16x32_bf16 v[40:43], v[56:59], v[96:99], v[40:43]
    v_mfma_f32_16x16x32_bf16 v[44:47], v[56:59], v[100:103], v[44:47]
    v_mfma_f32_16x16x32_bf16 v[28:31], v[60:63], v[80:83], v[28:31]
    v_mfma_f32_16x16x32_bf16 v[32:35], v[60:63], v[84:87], v[32:35]
    v_mfma_f32_16x16x32_bf16 v[36:39], v[60:63], v[88:91], v[36:39]
    v_mfma_f32_16x16x32_bf16 v[40:43], v[60:63], v[92:95], v[40:43]
    v_mfma_f32_16x16x32_bf16 v[44:47], v[60:63], v[96:99], v[44:47]
    v_mfma_f32_16x16x32_bf16 v[32:35], v[64:67], v[80:83], v[32:35]
    v_mfma_f32_16x16x32_bf16 v[36:39], v[64:67], v[84:87], v[36:39]
    v_mfma_f32_16x16x32_bf16 v[40:43], v[64:67], v[88:91], v[40:43]
    v_mfma_f32_16x16x32_bf16 v[44:47], v[64:67], v[92:95], v[44:47]
    v_mfma_f32_16x16x32_bf16 v[36:39], v[68:71], v[80:83], v[36:39]
    v_mfma_f32_16x16x32_bf16 v[40:43], v[68:71], v[84:87], v[40:43]
    v_mfma_f32_16x16x32_bf16 v[44:47], v[68:71], v[88:91], v[44:47]
    v_mfma_f32_16x16x32_bf16 v[40:43], v[72:75], v[80:83], v[40:43]
    v_mfma_f32_16x16x32_bf16 v[44:47], v[72:75], v[84:87], v[44:47]
    v_mfma_f32_16x16x32_bf16 v[44:47], v[76:79], v[80:83], v[44:47]
    s_waitcnt lgkmcnt(0)
    ds_read_b128 v[80:83], v6 offset:320
    ds_read_b128 v[48:51], v5 offset:128
    ds_read_b128 v[84:87], v6 offset:832
    ds_read_b128 v[52:55], v5 offset:640
    ds_read_b128 v[88:91], v6 offset:1344
    ds_read_b128 v[56:59], v5 offset:1152
    ds_read_b128 v[92:95], v6 offset:1856
    ds_read_b128 v[60:63], v5 offset:1664
    ds_read_b128 v[96:99], v6 offset:2368
    ds_read_b128 v[64:67], v5 offset:2176
    ds_read_b128 v[100:103], v6 offset:2880
    ds_read_b128 v[68:71], v5 offset:2688
    ds_read_b128 v[104:107], v6 offset:3392
    ds_read_b128 v[72:75], v5 offset:3200
    ds_read_b128 v[108:111], v6 offset:3904
    ds_read_b128 v[76:79], v5 offset:3712
    v_mfma_f32_16x16x32_bf16 v[16:19], v[112:115], v[144:147], v[16:19]
    v_mfma_f32_16x16x32_bf16 v[20:23], v[112:115], v[148:151], v[20:23]
    v_mfma_f32_16x16x32_bf16 v[24:27], v[112:115], v[152:155], v[24:27]
    v_mfma_f32_16x16x32_bf16 v[28:31], v[112:115], v[156:159], v[28:31]
    v_mfma_f32_16x16x32_bf16 v[32:35], v[112:115], v[160:163], v[32:35]
    v_mfma_f32_16x16x32_bf16 v[36:39], v[112:115], v[164:167], v[36:39]
    v_mfma_f32_16x16x32_bf16 v[40:43], v[112:115], v[168:171], v[40:43]
    v_mfma_f32_16x16x32_bf16 v[44:47], v[112:115], v[172:175], v[44:47]
    v_mfma_f32_16x16x32_bf16 v[20:23], v[116:119], v[144:147], v[20:23]
    v_mfma_f32_16x16x32_bf16 v[24:27], v[116:119], v[148:151], v[24:27]
    v_mfma_f32_16x16x32_bf16 v[28:31], v[116:119], v[152:155], v[28:31]
    v_mfma_f32_16x16x32_bf16 v[32:35], v[116:119], v[156:159], v[32:35]
    v_mfma_f32_16x16x32_bf16 v[36:39], v[116:119], v[160:163], v[36:39]
    v_mfma_f32_16x16x32_bf16 v[40:43], v[116:119], v[164:167], v[40:43]
    v_mfma_f32_16x16x32_bf16 v[44:47], v[116:119], v[168:171], v[44:47]
    v_mfma_f32_16x16x32_bf16 v[24:27], v[120:123], v[144:147], v[24:27]
    v_mfma_f32_16x16x32_bf16 v[28:31], v[120:123], v[148:151], v[28:31]
    v_mfma_f32_16x16x32_bf16 v[32:35], v[120:123], v[152:155], v[32:35]
    v_mfma_f32_16x16x32_bf16 v[36:39], v[120:123], v[156:159], v[36:39]
    v_mfma_f32_16x16x32_bf16 v[40:43], v[120:123], v[160:163], v[40:43]
    v_mfma_f32_16x16x32_bf16 v[44:47], v[120:123], v[164:167], v[44:47]
    v_mfma_f32_16x16x32_bf16 v[28:31], v[124:127], v[144:147], v[28:31]
    v_mfma_f32_16x16x32_bf16 v[32:35], v[124:127], v[148:151], v[32:35]
    v_mfma_f32_16x16x32_bf16 v[36:39], v[124:127], v[152:155], v[36:39]
    v_mfma_f32_16x16x32_bf16 v[40:43], v[124:127], v[156:159], v[40:43]
    v_mfma_f32_16x16x32_bf16 v[44:47], v[124:127], v[160:163], v[44:47]
    v_mfma_f32_16x16x32_bf16 v[32:35], v[128:131], v[144:147], v[32:35]
    v_mfma_f32_16x16x32_bf16 v[36:39], v[128:131], v[148:151], v[36:39]
    v_mfma_f32_16x16x32_bf16 v[40:43], v[128:131], v[152:155], v[40:43]
    v_mfma_f32_16x16x32_bf16 v[44:47], v[128:131], v[156:159], v[44:47]
    v_mfma_f32_16x16x32_bf16 v[36:39], v[132:135], v[144:147], v[36:39]
    v_mfma_f32_16x16x32_bf16 v[40:43], v[132:135], v[148:151], v[40:43]
    v_mfma_f32_16x16x32_bf16 v[44:47], v[132:135], v[152:155], v[44:47]
    v_mfma_f32_16x16x32_bf16 v[40:43], v[136:139], v[144:147], v[40:43]
    v_mfma_f32_16x16x32_bf16 v[44:47], v[136:139], v[148:151], v[44:47]
    v_mfma_f32_16x16x32_bf16 v[44:47], v[140:143], v[144:147], v[44:47]
    s_waitcnt lgkmcnt(0)
    ds_read_b128 v[144:147], v6 offset:256
    ds_read_b128 v[112:115], v5 offset:192
    ds_read_b128 v[148:151], v6 offset:768
    ds_read_b128 v[116:119], v5 offset:704
    ds_read_b128 v[152:155], v6 offset:1280
    ds_read_b128 v[120:123], v5 offset:1216
    ds_read_b128 v[156:159], v6 offset:1792
    ds_read_b128 v[124:127], v5 offset:1728
    ds_read_b128 v[160:163], v6 offset:2304
    ds_read_b128 v[128:131], v5 offset:2240
    ds_read_b128 v[164:167], v6 offset:2816
    ds_read_b128 v[132:135], v5 offset:2752
    ds_read_b128 v[168:171], v6 offset:3328
    ds_read_b128 v[136:139], v5 offset:3264
    ds_read_b128 v[172:175], v6 offset:3840
    ds_read_b128 v[140:143], v5 offset:3776
    v_mfma_f32_16x16x32_bf16 v[16:19], v[48:51], v[80:83], v[16:19]
    v_mfma_f32_16x16x32_bf16 v[20:23], v[48:51], v[84:87], v[20:23]
    v_mfma_f32_16x16x32_bf16 v[24:27], v[48:51], v[88:91], v[24:27]
    v_mfma_f32_16x16x32_bf16 v[28:31], v[48:51], v[92:95], v[28:31]
    v_mfma_f32_16x16x32_bf16 v[32:35], v[48:51], v[96:99], v[32:35]
    v_mfma_f32_16x16x32_bf16 v[36:39], v[48:51], v[100:103], v[36:39]
    v_mfma_f32_16x16x32_bf16 v[40:43], v[48:51], v[104:107], v[40:43]
    v_mfma_f32_16x16x32_bf16 v[44:47], v[48:51], v[108:111], v[44:47]
    v_mfma_f32_16x16x32_bf16 v[20:23], v[52:55], v[80:83], v[20:23]
    v_mfma_f32_16x16x32_bf16 v[24:27], v[52:55], v[84:87], v[24:27]
    v_mfma_f32_16x16x32_bf16 v[28:31], v[52:55], v[88:91], v[28:31]
    v_mfma_f32_16x16x32_bf16 v[32:35], v[52:55], v[92:95], v[32:35]
    v_mfma_f32_16x16x32_bf16 v[36:39], v[52:55], v[96:99], v[36:39]
    v_mfma_f32_16x16x32_bf16 v[40:43], v[52:55], v[100:103], v[40:43]
    v_mfma_f32_16x16x32_bf16 v[44:47], v[52:55], v[104:107], v[44:47]
    v_mfma_f32_16x16x32_bf16 v[24:27], v[56:59], v[80:83], v[24:27]
    v_mfma_f32_16x16x32_bf16 v[28:31], v[56:59], v[84:87], v[28:31]
    v_mfma_f32_16x16x32_bf16 v[32:35], v[56:59], v[88:91], v[32:35]
    v_mfma_f32_16x16x32_bf16 v[36:39], v[56:59], v[92:95], v[36:39]
    v_mfma_f32_16x16x32_bf16 v[40:43], v[56:59], v[96:99], v[40:43]
    v_mfma_f32_16x16x32_bf16 v[44:47], v[56:59], v[100:103], v[44:47]
    v_mfma_f32_16x16x32_bf16 v[28:31], v[60:63], v[80:83], v[28:31]
    v_mfma_f32_16x16x32_bf16 v[32:35], v[60:63], v[84:87], v[32:35]
    v_mfma_f32_16x16x32_bf16 v[36:39], v[60:63], v[88:91], v[36:39]
    v_mfma_f32_16x16x32_bf16 v[40:43], v[60:63], v[92:95], v[40:43]
    v_mfma_f32_16x16x32_bf16 v[44:47], v[60:63], v[96:99], v[44:47]
    v_mfma_f32_16x16x32_bf16 v[32:35], v[64:67], v[80:83], v[32:35]
    v_mfma_f32_16x16x32_bf16 v[36:39], v[64:67], v[84:87], v[36:39]
    v_mfma_f32_16x16x32_bf16 v[40:43], v[64:67], v[88:91], v[40:43]
    v_mfma_f32_16x16x32_bf16 v[44:47], v[64:67], v[92:95], v[44:47]
    v_mfma_f32_16x16x32_bf16 v[36:39], v[68:71], v[80:83], v[36:39]
    v_mfma_f32_16x16x32_bf16 v[40:43], v[68:71], v[84:87], v[40:43]
    v_mfma_f32_16x16x32_bf16 v[44:47], v[68:71], v[88:91], v[44:47]
    v_mfma_f32_16x16x32_bf16 v[40:43], v[72:75], v[80:83], v[40:43]
    v_mfma_f32_16x16x32_bf16 v[44:47], v[72:75], v[84:87], v[44:47]
    v_mfma_f32_16x16x32_bf16 v[44:47], v[76:79], v[80:83], v[44:47]
    s_waitcnt lgkmcnt(0)
    ds_read_b128 v[80:83], v6 offset:192
    ds_read_b128 v[48:51], v5 offset:256
    ds_read_b128 v[84:87], v6 offset:704
    ds_read_b128 v[52:55], v5 offset:768
    ds_read_b128 v[88:91], v6 offset:1216
    ds_read_b128 v[56:59], v5 offset:1280
    ds_read_b128 v[92:95], v6 offset:1728
    ds_read_b128 v[60:63], v5 offset:1792
    ds_read_b128 v[96:99], v6 offset:2240
    ds_read_b128 v[64:67], v5 offset:2304
    ds_read_b128 v[100:103], v6 offset:2752
    ds_read_b128 v[68:71], v5 offset:2816
    ds_read_b128 v[104:107], v6 offset:3264
    ds_read_b128 v[72:75], v5 offset:3328
    ds_read_b128 v[108:111], v6 offset:3776
    ds_read_b128 v[76:79], v5 offset:3840
    v_mfma_f32_16x16x32_bf16 v[16:19], v[112:115], v[144:147], v[16:19]
    v_mfma_f32_16x16x32_bf16 v[20:23], v[112:115], v[148:151], v[20:23]
    v_mfma_f32_16x16x32_bf16 v[24:27], v[112:115], v[152:155], v[24:27]
    v_mfma_f32_16x16x32_bf16 v[28:31], v[112:115], v[156:159], v[28:31]
    v_mfma_f32_16x16x32_bf16 v[32:35], v[112:115], v[160:163], v[32:35]
    v_mfma_f32_16x16x32_bf16 v[36:39], v[112:115], v[164:167], v[36:39]
    v_mfma_f32_16x16x32_bf16 v[40:43], v[112:115], v[168:171], v[40:43]
    v_mfma_f32_16x16x32_bf16 v[44:47], v[112:115], v[172:175], v[44:47]
    v_mfma_f32_16x16x32_bf16 v[20:23], v[116:119], v[144:147], v[20:23]
    v_mfma_f32_16x16x32_bf16 v[24:27], v[116:119], v[148:151], v[24:27]
    v_mfma_f32_16x16x32_bf16 v[28:31], v[116:119], v[152:155], v[28:31]
    v_mfma_f32_16x16x32_bf16 v[32:35], v[116:119], v[156:159], v[32:35]
    v_mfma_f32_16x16x32_bf16 v[36:39], v[116:119], v[160:163], v[36:39]
    v_mfma_f32_16x16x32_bf16 v[40:43], v[116:119], v[164:167], v[40:43]
    v_mfma_f32_16x16x32_bf16 v[44:47], v[116:119], v[168:171], v[44:47]
    v_mfma_f32_16x16x32_bf16 v[24:27], v[120:123], v[144:147], v[24:27]
    v_mfma_f32_16x16x32_bf16 v[28:31], v[120:123], v[148:151], v[28:31]
    v_mfma_f32_16x16x32_bf16 v[32:35], v[120:123], v[152:155], v[32:35]
    v_mfma_f32_16x16x32_bf16 v[36:39], v[120:123], v[156:159], v[36:39]
    v_mfma_f32_16x16x32_bf16 v[40:43], v[120:123], v[160:163], v[40:43]
    v_mfma_f32_16x16x32_bf16 v[44:47], v[120:123], v[164:167], v[44:47]
    v_mfma_f32_16x16x32_bf16 v[28:31], v[124:127], v[144:147], v[28:31]
    v_mfma_f32_16x16x32_bf16 v[32:35], v[124:127], v[148:151], v[32:35]
    v_mfma_f32_16x16x32_bf16 v[36:39], v[124:127], v[152:155], v[36:39]
    v_mfma_f32_16x16x32_bf16 v[40:43], v[124:127], v[156:159], v[40:43]
    v_mfma_f32_16x16x32_bf16 v[44:47], v[124:127], v[160:163], v[44:47]
    v_mfma_f32_16x16x32_bf16 v[32:35], v[128:131], v[144:147], v[32:35]
    v_mfma_f32_16x16x32_bf16 v[36:39], v[128:131], v[148:151], v[36:39]
    v_mfma_f32_16x16x32_bf16 v[40:43], v[128:131], v[152:155], v[40:43]
    v_mfma_f32_16x16x32_bf16 v[44:47], v[128:131], v[156:159], v[44:47]
    v_mfma_f32_16x16x32_bf16 v[36:39], v[132:135], v[144:147], v[36:39]
    v_mfma_f32_16x16x32_bf16 v[40:43], v[132:135], v[148:151], v[40:43]
    v_mfma_f32_16x16x32_bf16 v[44:47], v[132:135], v[152:155], v[44:47]
    v_mfma_f32_16x16x32_bf16 v[40:43], v[136:139], v[144:147], v[40:43]
    v_mfma_f32_16x16x32_bf16 v[44:47], v[136:139], v[148:151], v[44:47]
    v_mfma_f32_16x16x32_bf16 v[44:47], v[140:143], v[144:147], v[44:47]
    s_waitcnt lgkmcnt(0)
    ds_read_b128 v[144:147], v6 offset:128
    ds_read_b128 v[112:115], v5 offset:320
    ds_read_b128 v[148:151], v6 offset:640
    ds_read_b128 v[116:119], v5 offset:832
    ds_read_b128 v[152:155], v6 offset:1152
    ds_read_b128 v[120:123], v5 offset:1344
    ds_read_b128 v[156:159], v6 offset:1664
    ds_read_b128 v[124:127], v5 offset:1856
    ds_read_b128 v[160:163], v6 offset:2176
    ds_read_b128 v[128:131], v5 offset:2368
    ds_read_b128 v[164:167], v6 offset:2688
    ds_read_b128 v[132:135], v5 offset:2880
    ds_read_b128 v[168:171], v6 offset:3200
    ds_read_b128 v[136:139], v5 offset:3392
    ds_read_b128 v[172:175], v6 offset:3712
    ds_read_b128 v[140:143], v5 offset:3904
    v_mfma_f32_16x16x32_bf16 v[16:19], v[48:51], v[80:83], v[16:19]
    v_mfma_f32_16x16x32_bf16 v[20:23], v[48:51], v[84:87], v[20:23]
    v_mfma_f32_16x16x32_bf16 v[24:27], v[48:51], v[88:91], v[24:27]
    v_mfma_f32_16x16x32_bf16 v[28:31], v[48:51], v[92:95], v[28:31]
    v_mfma_f32_16x16x32_bf16 v[32:35], v[48:51], v[96:99], v[32:35]
    v_mfma_f32_16x16x32_bf16 v[36:39], v[48:51], v[100:103], v[36:39]
    v_mfma_f32_16x16x32_bf16 v[40:43], v[48:51], v[104:107], v[40:43]
    v_mfma_f32_16x16x32_bf16 v[44:47], v[48:51], v[108:111], v[44:47]
    v_mfma_f32_16x16x32_bf16 v[20:23], v[52:55], v[80:83], v[20:23]
    v_mfma_f32_16x16x32_bf16 v[24:27], v[52:55], v[84:87], v[24:27]
    v_mfma_f32_16x16x32_bf16 v[28:31], v[52:55], v[88:91], v[28:31]
    v_mfma_f32_16x16x32_bf16 v[32:35], v[52:55], v[92:95], v[32:35]
    v_mfma_f32_16x16x32_bf16 v[36:39], v[52:55], v[96:99], v[36:39]
    v_mfma_f32_16x16x32_bf16 v[40:43], v[52:55], v[100:103], v[40:43]
    v_mfma_f32_16x16x32_bf16 v[44:47], v[52:55], v[104:107], v[44:47]
    v_mfma_f32_16x16x32_bf16 v[24:27], v[56:59], v[80:83], v[24:27]
    v_mfma_f32_16x16x32_bf16 v[28:31], v[56:59], v[84:87], v[28:31]
    v_mfma_f32_16x16x32_bf16 v[32:35], v[56:59], v[88:91], v[32:35]
    v_mfma_f32_16x16x32_bf16 v[36:39], v[56:59], v[92:95], v[36:39]
    v_mfma_f32_16x16x32_bf16 v[40:43], v[56:59], v[96:99], v[40:43]
    v_mfma_f32_16x16x32_bf16 v[44:47], v[56:59], v[100:103], v[44:47]
    v_mfma_f32_16x16x32_bf16 v[28:31], v[60:63], v[80:83], v[28:31]
    v_mfma_f32_16x16x32_bf16 v[32:35], v[60:63], v[84:87], v[32:35]
    v_mfma_f32_16x16x32_bf16 v[36:39], v[60:63], v[88:91], v[36:39]
    v_mfma_f32_16x16x32_bf16 v[40:43], v[60:63], v[92:95], v[40:43]
    v_mfma_f32_16x16x32_bf16 v[44:47], v[60:63], v[96:99], v[44:47]
    v_mfma_f32_16x16x32_bf16 v[32:35], v[64:67], v[80:83], v[32:35]
    v_mfma_f32_16x16x32_bf16 v[36:39], v[64:67], v[84:87], v[36:39]
    v_mfma_f32_16x16x32_bf16 v[40:43], v[64:67], v[88:91], v[40:43]
    v_mfma_f32_16x16x32_bf16 v[44:47], v[64:67], v[92:95], v[44:47]
    v_mfma_f32_16x16x32_bf16 v[36:39], v[68:71], v[80:83], v[36:39]
    v_mfma_f32_16x16x32_bf16 v[40:43], v[68:71], v[84:87], v[40:43]
    v_mfma_f32_16x16x32_bf16 v[44:47], v[68:71], v[88:91], v[44:47]
    v_mfma_f32_16x16x32_bf16 v[40:43], v[72:75], v[80:83], v[40:43]
    v_mfma_f32_16x16x32_bf16 v[44:47], v[72:75], v[84:87], v[44:47]
    v_mfma_f32_16x16x32_bf16 v[44:47], v[76:79], v[80:83], v[44:47]
    s_waitcnt lgkmcnt(0)
    ds_read_b128 v[80:83], v6 offset:64
    ds_read_b128 v[48:51], v5 offset:384
    ds_read_b128 v[84:87], v6 offset:576
    ds_read_b128 v[52:55], v5 offset:896
    ds_read_b128 v[88:91], v6 offset:1088
    ds_read_b128 v[56:59], v5 offset:1408
    ds_read_b128 v[92:95], v6 offset:1600
    ds_read_b128 v[60:63], v5 offset:1920
    ds_read_b128 v[96:99], v6 offset:2112
    ds_read_b128 v[64:67], v5 offset:2432
    ds_read_b128 v[100:103], v6 offset:2624
    ds_read_b128 v[68:71], v5 offset:2944
    ds_read_b128 v[104:107], v6 offset:3136
    ds_read_b128 v[72:75], v5 offset:3456
    ds_read_b128 v[108:111], v6 offset:3648
    ds_read_b128 v[76:79], v5 offset:3968
    v_mfma_f32_16x16x32_bf16 v[16:19], v[112:115], v[144:147], v[16:19]
    v_mfma_f32_16x16x32_bf16 v[20:23], v[112:115], v[148:151], v[20:23]
    v_mfma_f32_16x16x32_bf16 v[24:27], v[112:115], v[152:155], v[24:27]
    v_mfma_f32_16x16x32_bf16 v[28:31], v[112:115], v[156:159], v[28:31]
    v_mfma_f32_16x16x32_bf16 v[32:35], v[112:115], v[160:163], v[32:35]
    v_mfma_f32_16x16x32_bf16 v[36:39], v[112:115], v[164:167], v[36:39]
    v_mfma_f32_16x16x32_bf16 v[40:43], v[112:115], v[168:171], v[40:43]
    v_mfma_f32_16x16x32_bf16 v[44:47], v[112:115], v[172:175], v[44:47]
    v_mfma_f32_16x16x32_bf16 v[20:23], v[116:119], v[144:147], v[20:23]
    v_mfma_f32_16x16x32_bf16 v[24:27], v[116:119], v[148:151], v[24:27]
    v_mfma_f32_16x16x32_bf16 v[28:31], v[116:119], v[152:155], v[28:31]
    v_mfma_f32_16x16x32_bf16 v[32:35], v[116:119], v[156:159], v[32:35]
    v_mfma_f32_16x16x32_bf16 v[36:39], v[116:119], v[160:163], v[36:39]
    v_mfma_f32_16x16x32_bf16 v[40:43], v[116:119], v[164:167], v[40:43]
    v_mfma_f32_16x16x32_bf16 v[44:47], v[116:119], v[168:171], v[44:47]
    v_mfma_f32_16x16x32_bf16 v[24:27], v[120:123], v[144:147], v[24:27]
    v_mfma_f32_16x16x32_bf16 v[28:31], v[120:123], v[148:151], v[28:31]
    v_mfma_f32_16x16x32_bf16 v[32:35], v[120:123], v[152:155], v[32:35]
    v_mfma_f32_16x16x32_bf16 v[36:39], v[120:123], v[156:159], v[36:39]
    v_mfma_f32_16x16x32_bf16 v[40:43], v[120:123], v[160:163], v[40:43]
    v_mfma_f32_16x16x32_bf16 v[44:47], v[120:123], v[164:167], v[44:47]
    v_mfma_f32_16x16x32_bf16 v[28:31], v[124:127], v[144:147], v[28:31]
    v_mfma_f32_16x16x32_bf16 v[32:35], v[124:127], v[148:151], v[32:35]
    v_mfma_f32_16x16x32_bf16 v[36:39], v[124:127], v[152:155], v[36:39]
    v_mfma_f32_16x16x32_bf16 v[40:43], v[124:127], v[156:159], v[40:43]
    v_mfma_f32_16x16x32_bf16 v[44:47], v[124:127], v[160:163], v[44:47]
    v_mfma_f32_16x16x32_bf16 v[32:35], v[128:131], v[144:147], v[32:35]
    v_mfma_f32_16x16x32_bf16 v[36:39], v[128:131], v[148:151], v[36:39]
    v_mfma_f32_16x16x32_bf16 v[40:43], v[128:131], v[152:155], v[40:43]
    v_mfma_f32_16x16x32_bf16 v[44:47], v[128:131], v[156:159], v[44:47]
    v_mfma_f32_16x16x32_bf16 v[36:39], v[132:135], v[144:147], v[36:39]
    v_mfma_f32_16x16x32_bf16 v[40:43], v[132:135], v[148:151], v[40:43]
    v_mfma_f32_16x16x32_bf16 v[44:47], v[132:135], v[152:155], v[44:47]
    v_mfma_f32_16x16x32_bf16 v[40:43], v[136:139], v[144:147], v[40:43]
    v_mfma_f32_16x16x32_bf16 v[44:47], v[136:139], v[148:151], v[44:47]
    v_mfma_f32_16x16x32_bf16 v[44:47], v[140:143], v[144:147], v[44:47]
    s_waitcnt lgkmcnt(0)
    ds_read_b128 v[144:147], v6 offset:0
    ds_read_b128 v[112:115], v5 offset:448
    ds_read_b128 v[148:151], v6 offset:512
    ds_read_b128 v[116:119], v5 offset:960
    ds_read_b128 v[152:155], v6 offset:1024
    ds_read_b128 v[120:123], v5 offset:1472
    ds_read_b128 v[156:159], v6 offset:1536
    ds_read_b128 v[124:127], v5 offset:1984
    ds_read_b128 v[160:163], v6 offset:2048
    ds_read_b128 v[128:131], v5 offset:2496
    ds_read_b128 v[164:167], v6 offset:2560
    ds_read_b128 v[132:135], v5 offset:3008
    ds_read_b128 v[168:171], v6 offset:3072
    ds_read_b128 v[136:139], v5 offset:3520
    ds_read_b128 v[172:175], v6 offset:3584
    ds_read_b128 v[140:143], v5 offset:4032
    v_mfma_f32_16x16x32_bf16 v[16:19], v[48:51], v[80:83], v[16:19]
    v_mfma_f32_16x16x32_bf16 v[20:23], v[48:51], v[84:87], v[20:23]
    v_mfma_f32_16x16x32_bf16 v[24:27], v[48:51], v[88:91], v[24:27]
    v_mfma_f32_16x16x32_bf16 v[28:31], v[48:51], v[92:95], v[28:31]
    v_mfma_f32_16x16x32_bf16 v[32:35], v[48:51], v[96:99], v[32:35]
    v_mfma_f32_16x16x32_bf16 v[36:39], v[48:51], v[100:103], v[36:39]
    v_mfma_f32_16x16x32_bf16 v[40:43], v[48:51], v[104:107], v[40:43]
    v_mfma_f32_16x16x32_bf16 v[44:47], v[48:51], v[108:111], v[44:47]
    v_mfma_f32_16x16x32_bf16 v[20:23], v[52:55], v[80:83], v[20:23]
    v_mfma_f32_16x16x32_bf16 v[24:27], v[52:55], v[84:87], v[24:27]
    v_mfma_f32_16x16x32_bf16 v[28:31], v[52:55], v[88:91], v[28:31]
    v_mfma_f32_16x16x32_bf16 v[32:35], v[52:55], v[92:95], v[32:35]
    v_mfma_f32_16x16x32_bf16 v[36:39], v[52:55], v[96:99], v[36:39]
    v_mfma_f32_16x16x32_bf16 v[40:43], v[52:55], v[100:103], v[40:43]
    v_mfma_f32_16x16x32_bf16 v[44:47], v[52:55], v[104:107], v[44:47]
    v_mfma_f32_16x16x32_bf16 v[24:27], v[56:59], v[80:83], v[24:27]
    v_mfma_f32_16x16x32_bf16 v[28:31], v[56:59], v[84:87], v[28:31]
    v_mfma_f32_16x16x32_bf16 v[32:35], v[56:59], v[88:91], v[32:35]
    v_mfma_f32_16x16x32_bf16 v[36:39], v[56:59], v[92:95], v[36:39]
    v_mfma_f32_16x16x32_bf16 v[40:43], v[56:59], v[96:99], v[40:43]
    v_mfma_f32_16x16x32_bf16 v[44:47], v[56:59], v[100:103], v[44:47]
    v_mfma_f32_16x16x32_bf16 v[28:31], v[60:63], v[80:83], v[28:31]
    v_mfma_f32_16x16x32_bf16 v[32:35], v[60:63], v[84:87], v[32:35]
    v_mfma_f32_16x16x32_bf16 v[36:39], v[60:63], v[88:91], v[36:39]
    v_mfma_f32_16x16x32_bf16 v[40:43], v[60:63], v[92:95], v[40:43]
    v_mfma_f32_16x16x32_bf16 v[44:47], v[60:63], v[96:99], v[44:47]
    v_mfma_f32_16x16x32_bf16 v[32:35], v[64:67], v[80:83], v[32:35]
    v_mfma_f32_16x16x32_bf16 v[36:39], v[64:67], v[84:87], v[36:39]
    v_mfma_f32_16x16x32_bf16 v[40:43], v[64:67], v[88:91], v[40:43]
    v_mfma_f32_16x16x32_bf16 v[44:47], v[64:67], v[92:95], v[44:47]
    v_mfma_f32_16x16x32_bf16 v[36:39], v[68:71], v[80:83], v[36:39]
    v_mfma_f32_16x16x32_bf16 v[40:43], v[68:71], v[84:87], v[40:43]
    v_mfma_f32_16x16x32_bf16 v[44:47], v[68:71], v[88:91], v[44:47]
    v_mfma_f32_16x16x32_bf16 v[40:43], v[72:75], v[80:83], v[40:43]
    v_mfma_f32_16x16x32_bf16 v[44:47], v[72:75], v[84:87], v[44:47]
    v_mfma_f32_16x16x32_bf16 v[44:47], v[76:79], v[80:83], v[44:47]
    s_waitcnt lgkmcnt(0)
    v_mfma_f32_16x16x32_bf16 v[16:19], v[112:115], v[144:147], v[16:19]
    v_mfma_f32_16x16x32_bf16 v[20:23], v[112:115], v[148:151], v[20:23]
    v_mfma_f32_16x16x32_bf16 v[24:27], v[112:115], v[152:155], v[24:27]
    v_mfma_f32_16x16x32_bf16 v[28:31], v[112:115], v[156:159], v[28:31]
    v_mfma_f32_16x16x32_bf16 v[32:35], v[112:115], v[160:163], v[32:35]
    v_mfma_f32_16x16x32_bf16 v[36:39], v[112:115], v[164:167], v[36:39]
    v_mfma_f32_16x16x32_bf16 v[40:43], v[112:115], v[168:171], v[40:43]
    v_mfma_f32_16x16x32_bf16 v[44:47], v[112:115], v[172:175], v[44:47]
    v_mfma_f32_16x16x32_bf16 v[20:23], v[116:119], v[144:147], v[20:23]
    v_mfma_f32_16x16x32_bf16 v[24:27], v[116:119], v[148:151], v[24:27]
    v_mfma_f32_16x16x32_bf16 v[28:31], v[116:119], v[152:155], v[28:31]
    v_mfma_f32_16x16x32_bf16 v[32:35], v[116:119], v[156:159], v[32:35]
    v_mfma_f32_16x16x32_bf16 v[36:39], v[116:119], v[160:163], v[36:39]
    v_mfma_f32_16x16x32_bf16 v[40:43], v[116:119], v[164:167], v[40:43]
    v_mfma_f32_16x16x32_bf16 v[44:47], v[116:119], v[168:171], v[44:47]
    v_mfma_f32_16x16x32_bf16 v[24:27], v[120:123], v[144:147], v[24:27]
    v_mfma_f32_16x16x32_bf16 v[28:31], v[120:123], v[148:151], v[28:31]
    v_mfma_f32_16x16x32_bf16 v[32:35], v[120:123], v[152:155], v[32:35]
    v_mfma_f32_16x16x32_bf16 v[36:39], v[120:123], v[156:159], v[36:39]
    v_mfma_f32_16x16x32_bf16 v[40:43], v[120:123], v[160:163], v[40:43]
    v_mfma_f32_16x16x32_bf16 v[44:47], v[120:123], v[164:167], v[44:47]
    v_mfma_f32_16x16x32_bf16 v[28:31], v[124:127], v[144:147], v[28:31]
    v_mfma_f32_16x16x32_bf16 v[32:35], v[124:127], v[148:151], v[32:35]
    v_mfma_f32_16x16x32_bf16 v[36:39], v[124:127], v[152:155], v[36:39]
    v_mfma_f32_16x16x32_bf16 v[40:43], v[124:127], v[156:159], v[40:43]
    v_mfma_f32_16x16x32_bf16 v[44:47], v[124:127], v[160:163], v[44:47]
    v_mfma_f32_16x16x32_bf16 v[32:35], v[128:131], v[144:147], v[32:35]
    v_mfma_f32_16x16x32_bf16 v[36:39], v[128:131], v[148:151], v[36:39]
    v_mfma_f32_16x16x32_bf16 v[40:43], v[128:131], v[152:155], v[40:43]
    v_mfma_f32_16x16x32_bf16 v[44:47], v[128:131], v[156:159], v[44:47]
    v_mfma_f32_16x16x32_bf16 v[36:39], v[132:135], v[144:147], v[36:39]
    v_mfma_f32_16x16x32_bf16 v[40:43], v[132:135], v[148:151], v[40:43]
    v_mfma_f32_16x16x32_bf16 v[44:47], v[132:135], v[152:155], v[44:47]
    v_mfma_f32_16x16x32_bf16 v[40:43], v[136:139], v[144:147], v[40:43]
    v_mfma_f32_16x16x32_bf16 v[44:47], v[136:139], v[148:151], v[44:47]
    v_mfma_f32_16x16x32_bf16 v[44:47], v[140:143], v[144:147], v[44:47]
    ds_read_b64 v[48:49], v7 offset:0
    ds_read_b64 v[50:51], v7 offset:512
    ds_read_b64 v[52:53], v7 offset:1024
    ds_read_b64 v[54:55], v7 offset:1536
    ds_read_b64 v[56:57], v7 offset:2048
    ds_read_b64 v[58:59], v7 offset:2560
    ds_read_b64 v[60:61], v7 offset:3072
    ds_read_b64 v[62:63], v7 offset:3584
    s_waitcnt lgkmcnt(0)
    s_nop 7
    v_lshlrev_b32 v64, 16, v48
    v_and_b32 v65, s92, v48
    v_lshlrev_b32 v66, 16, v49
    v_and_b32 v67, s92, v49
    v_mul_f32 v64, s74, v64
    v_mul_f32 v65, s74, v65
    v_mul_f32 v66, s74, v66
    v_mul_f32 v67, s74, v67
    v_cvt_pk_bf16_f32 v68, v64, v65
    v_cvt_pk_bf16_f32 v69, v66, v67
    v_cvt_pk_bf16_f32 v70, v16, v17
    v_cvt_pk_bf16_f32 v71, v18, v19
    v_lshlrev_b32 v64, 16, v68
    v_and_b32 v65, s92, v68
    v_lshlrev_b32 v66, 16, v69
    v_and_b32 v67, s92, v69
    v_lshlrev_b32 v72, 16, v70
    v_and_b32 v73, s92, v70
    v_lshlrev_b32 v74, 16, v71
    v_and_b32 v75, s92, v71
    v_add_f32 v64, v64, v72
    v_add_f32 v65, v65, v73
    v_add_f32 v66, v66, v74
    v_add_f32 v67, v67, v75
    v_cvt_pk_bf16_f32 v68, v64, v65
    v_cvt_pk_bf16_f32 v69, v66, v67
    ds_write_b64 v7, v[68:69] offset:0
    v_lshlrev_b32 v76, 16, v50
    v_and_b32 v77, s92, v50
    v_lshlrev_b32 v78, 16, v51
    v_and_b32 v79, s92, v51
    v_mul_f32 v76, s74, v76
    v_mul_f32 v77, s74, v77
    v_mul_f32 v78, s74, v78
    v_mul_f32 v79, s74, v79
    v_cvt_pk_bf16_f32 v80, v76, v77
    v_cvt_pk_bf16_f32 v81, v78, v79
    v_cvt_pk_bf16_f32 v82, v20, v21
    v_cvt_pk_bf16_f32 v83, v22, v23
    v_lshlrev_b32 v76, 16, v80
    v_and_b32 v77, s92, v80
    v_lshlrev_b32 v78, 16, v81
    v_and_b32 v79, s92, v81
    v_lshlrev_b32 v84, 16, v82
    v_and_b32 v85, s92, v82
    v_lshlrev_b32 v86, 16, v83
    v_and_b32 v87, s92, v83
    v_add_f32 v76, v76, v84
    v_add_f32 v77, v77, v85
    v_add_f32 v78, v78, v86
    v_add_f32 v79, v79, v87
    v_cvt_pk_bf16_f32 v80, v76, v77
    v_cvt_pk_bf16_f32 v81, v78, v79
    ds_write_b64 v7, v[80:81] offset:512
    v_lshlrev_b32 v64, 16, v52
    v_and_b32 v65, s92, v52
    v_lshlrev_b32 v66, 16, v53
    v_and_b32 v67, s92, v53
    v_mul_f32 v64, s74, v64
    v_mul_f32 v65, s74, v65
    v_mul_f32 v66, s74, v66
    v_mul_f32 v67, s74, v67
    v_cvt_pk_bf16_f32 v68, v64, v65
    v_cvt_pk_bf16_f32 v69, v66, v67
    v_cvt_pk_bf16_f32 v70, v24, v25
    v_cvt_pk_bf16_f32 v71, v26, v27
    v_lshlrev_b32 v64, 16, v68
    v_and_b32 v65, s92, v68
    v_lshlrev_b32 v66, 16, v69
    v_and_b32 v67, s92, v69
    v_lshlrev_b32 v72, 16, v70
    v_and_b32 v73, s92, v70
    v_lshlrev_b32 v74, 16, v71
    v_and_b32 v75, s92, v71
    v_add_f32 v64, v64, v72
    v_add_f32 v65, v65, v73
    v_add_f32 v66, v66, v74
    v_add_f32 v67, v67, v75
    v_cvt_pk_bf16_f32 v68, v64, v65
    v_cvt_pk_bf16_f32 v69, v66, v67
    ds_write_b64 v7, v[68:69] offset:1024
    v_lshlrev_b32 v76, 16, v54
    v_and_b32 v77, s92, v54
    v_lshlrev_b32 v78, 16, v55
    v_and_b32 v79, s92, v55
    v_mul_f32 v76, s74, v76
    v_mul_f32 v77, s74, v77
    v_mul_f32 v78, s74, v78
    v_mul_f32 v79, s74, v79
    v_cvt_pk_bf16_f32 v80, v76, v77
    v_cvt_pk_bf16_f32 v81, v78, v79
    v_cvt_pk_bf16_f32 v82, v28, v29
    v_cvt_pk_bf16_f32 v83, v30, v31
    v_lshlrev_b32 v76, 16, v80
    v_and_b32 v77, s92, v80
    v_lshlrev_b32 v78, 16, v81
    v_and_b32 v79, s92, v81
    v_lshlrev_b32 v84, 16, v82
    v_and_b32 v85, s92, v82
    v_lshlrev_b32 v86, 16, v83
    v_and_b32 v87, s92, v83
    v_add_f32 v76, v76, v84
    v_add_f32 v77, v77, v85
    v_add_f32 v78, v78, v86
    v_add_f32 v79, v79, v87
    v_cvt_pk_bf16_f32 v80, v76, v77
    v_cvt_pk_bf16_f32 v81, v78, v79
    ds_write_b64 v7, v[80:81] offset:1536
    v_lshlrev_b32 v64, 16, v56
    v_and_b32 v65, s92, v56
    v_lshlrev_b32 v66, 16, v57
    v_and_b32 v67, s92, v57
    v_mul_f32 v64, s74, v64
    v_mul_f32 v65, s74, v65
    v_mul_f32 v66, s74, v66
    v_mul_f32 v67, s74, v67
    v_cvt_pk_bf16_f32 v68, v64, v65
    v_cvt_pk_bf16_f32 v69, v66, v67
    v_cvt_pk_bf16_f32 v70, v32, v33
    v_cvt_pk_bf16_f32 v71, v34, v35
    v_lshlrev_b32 v64, 16, v68
    v_and_b32 v65, s92, v68
    v_lshlrev_b32 v66, 16, v69
    v_and_b32 v67, s92, v69
    v_lshlrev_b32 v72, 16, v70
    v_and_b32 v73, s92, v70
    v_lshlrev_b32 v74, 16, v71
    v_and_b32 v75, s92, v71
    v_add_f32 v64, v64, v72
    v_add_f32 v65, v65, v73
    v_add_f32 v66, v66, v74
    v_add_f32 v67, v67, v75
    v_cvt_pk_bf16_f32 v68, v64, v65
    v_cvt_pk_bf16_f32 v69, v66, v67
    ds_write_b64 v7, v[68:69] offset:2048
    v_lshlrev_b32 v76, 16, v58
    v_and_b32 v77, s92, v58
    v_lshlrev_b32 v78, 16, v59
    v_and_b32 v79, s92, v59
    v_mul_f32 v76, s74, v76
    v_mul_f32 v77, s74, v77
    v_mul_f32 v78, s74, v78
    v_mul_f32 v79, s74, v79
    v_cvt_pk_bf16_f32 v80, v76, v77
    v_cvt_pk_bf16_f32 v81, v78, v79
    v_cvt_pk_bf16_f32 v82, v36, v37
    v_cvt_pk_bf16_f32 v83, v38, v39
    v_lshlrev_b32 v76, 16, v80
    v_and_b32 v77, s92, v80
    v_lshlrev_b32 v78, 16, v81
    v_and_b32 v79, s92, v81
    v_lshlrev_b32 v84, 16, v82
    v_and_b32 v85, s92, v82
    v_lshlrev_b32 v86, 16, v83
    v_and_b32 v87, s92, v83
    v_add_f32 v76, v76, v84
    v_add_f32 v77, v77, v85
    v_add_f32 v78, v78, v86
    v_add_f32 v79, v79, v87
    v_cvt_pk_bf16_f32 v80, v76, v77
    v_cvt_pk_bf16_f32 v81, v78, v79
    ds_write_b64 v7, v[80:81] offset:2560
    v_lshlrev_b32 v64, 16, v60
    v_and_b32 v65, s92, v60
    v_lshlrev_b32 v66, 16, v61
    v_and_b32 v67, s92, v61
    v_mul_f32 v64, s74, v64
    v_mul_f32 v65, s74, v65
    v_mul_f32 v66, s74, v66
    v_mul_f32 v67, s74, v67
    v_cvt_pk_bf16_f32 v68, v64, v65
    v_cvt_pk_bf16_f32 v69, v66, v67
    v_cvt_pk_bf16_f32 v70, v40, v41
    v_cvt_pk_bf16_f32 v71, v42, v43
    v_lshlrev_b32 v64, 16, v68
    v_and_b32 v65, s92, v68
    v_lshlrev_b32 v66, 16, v69
    v_and_b32 v67, s92, v69
    v_lshlrev_b32 v72, 16, v70
    v_and_b32 v73, s92, v70
    v_lshlrev_b32 v74, 16, v71
    v_and_b32 v75, s92, v71
    v_add_f32 v64, v64, v72
    v_add_f32 v65, v65, v73
    v_add_f32 v66, v66, v74
    v_add_f32 v67, v67, v75
    v_cvt_pk_bf16_f32 v68, v64, v65
    v_cvt_pk_bf16_f32 v69, v66, v67
    ds_write_b64 v7, v[68:69] offset:3072
    v_lshlrev_b32 v76, 16, v62
    v_and_b32 v77, s92, v62
    v_lshlrev_b32 v78, 16, v63
    v_and_b32 v79, s92, v63
    v_mul_f32 v76, s74, v76
    v_mul_f32 v77, s74, v77
    v_mul_f32 v78, s74, v78
    v_mul_f32 v79, s74, v79
    v_cvt_pk_bf16_f32 v80, v76, v77
    v_cvt_pk_bf16_f32 v81, v78, v79
    v_cvt_pk_bf16_f32 v82, v44, v45
    v_cvt_pk_bf16_f32 v83, v46, v47
    v_lshlrev_b32 v76, 16, v80
    v_and_b32 v77, s92, v80
    v_lshlrev_b32 v78, 16, v81
    v_and_b32 v79, s92, v81
    v_lshlrev_b32 v84, 16, v82
    v_and_b32 v85, s92, v82
    v_lshlrev_b32 v86, 16, v83
    v_and_b32 v87, s92, v83
    v_add_f32 v76, v76, v84
    v_add_f32 v77, v77, v85
    v_add_f32 v78, v78, v86
    v_add_f32 v79, v79, v87
    v_cvt_pk_bf16_f32 v80, v76, v77
    v_cvt_pk_bf16_f32 v81, v78, v79
    ds_write_b64 v7, v[80:81] offset:3584
    v_lshrrev_b32 v11, 4, v0
    v_mul_u32_u24 v11, 20480, v11
    v_and_b32 v12, 15, v0
    v_lshl_add_u32 v3, v12, 3, v11
    s_lshr_b32 s64, s57, 3
    s_lshl_b32 s64, s64, 10
    s_lshr_b32 s65, s57, 1
    s_and_b32 s65, s65, 3
    s_lshl_b32 s65, s65, 7
    s_add_u32 s64, s64, s65
    s_and_b32 s65, s57, 1
    s_lshl_b32 s65, s65, 9
    s_add_u32 s64, s64, s65
    v_lshlrev_b32 v8, 1, v0
    v_add_u32 v8, 133632, v8
    s_waitcnt lgkmcnt(0)
    s_barrier
    ds_read_u16 v16, v8 offset:0
    ds_read_u16 v17, v8 offset:4608
    ds_read_u16 v18, v8 offset:9216
    ds_read_u16 v19, v8 offset:13824
    ds_read_u16 v20, v8 offset:512
    ds_read_u16 v21, v8 offset:5120
    ds_read_u16 v22, v8 offset:9728
    ds_read_u16 v23, v8 offset:14336
    ds_read_u16 v24, v8 offset:1024
    ds_read_u16 v25, v8 offset:5632
    ds_read_u16 v26, v8 offset:10240
    ds_read_u16 v27, v8 offset:14848
    ds_read_u16 v28, v8 offset:1536
    ds_read_u16 v29, v8 offset:6144
    ds_read_u16 v30, v8 offset:10752
    ds_read_u16 v31, v8 offset:15360
    ds_read_u16 v32, v8 offset:2048
    ds_read_u16 v33, v8 offset:6656
    ds_read_u16 v34, v8 offset:11264
    ds_read_u16 v35, v8 offset:15872
    ds_read_u16 v36, v8 offset:2560
    ds_read_u16 v37, v8 offset:7168
    ds_read_u16 v38, v8 offset:11776
    ds_read_u16 v39, v8 offset:16384
    ds_read_u16 v40, v8 offset:3072
    ds_read_u16 v41, v8 offset:7680
    ds_read_u16 v42, v8 offset:12288
    ds_read_u16 v43, v8 offset:16896
    ds_read_u16 v44, v8 offset:3584
    ds_read_u16 v45, v8 offset:8192
    ds_read_u16 v46, v8 offset:12800
    ds_read_u16 v47, v8 offset:17408
    s_waitcnt lgkmcnt(0)
    v_lshl_or_b32 v48, v17, 16, v16
    v_lshl_or_b32 v49, v19, 16, v18
    buffer_store_dwordx2 v[48:49], v3, s[52:55], s64 offen sc1
    s_add_u32 s64, s64, 327680
    v_lshl_or_b32 v50, v21, 16, v20
    v_lshl_or_b32 v51, v23, 16, v22
    buffer_store_dwordx2 v[50:51], v3, s[52:55], s64 offen sc1
    s_add_u32 s64, s64, 327680
    v_lshl_or_b32 v52, v25, 16, v24
    v_lshl_or_b32 v53, v27, 16, v26
    buffer_store_dwordx2 v[52:53], v3, s[52:55], s64 offen sc1
    s_add_u32 s64, s64, 327680
    v_lshl_or_b32 v54, v29, 16, v28
    v_lshl_or_b32 v55, v31, 16, v30
    buffer_store_dwordx2 v[54:55], v3, s[52:55], s64 offen sc1
    s_add_u32 s64, s64, 327680
    v_lshl_or_b32 v56, v33, 16, v32
    v_lshl_or_b32 v57, v35, 16, v34
    buffer_store_dwordx2 v[56:57], v3, s[52:55], s64 offen sc1
    s_add_u32 s64, s64, 327680
    v_lshl_or_b32 v58, v37, 16, v36
    v_lshl_or_b32 v59, v39, 16, v38
    buffer_store_dwordx2 v[58:59], v3, s[52:55], s64 offen sc1
    s_add_u32 s64, s64, 327680
    v_lshl_or_b32 v60, v41, 16, v40
    v_lshl_or_b32 v61, v43, 16, v42
    buffer_store_dwordx2 v[60:61], v3, s[52:55], s64 offen sc1
    s_add_u32 s64, s64, 327680
    v_lshl_or_b32 v62, v45, 16, v44
    v_lshl_or_b32 v63, v47, 16, v46
    buffer_store_dwordx2 v[62:63], v3, s[52:55], s64 offen sc1
    s_add_u32 s64, s64, 327680
    s_endpgm
k1_jobs:
    s_waitcnt lgkmcnt(0)
    s_cmp_ge_u32 s2, 187
    s_cbranch_scc1 k1_n1
    v_and_b32 v9, 7, v2
    v_lshrrev_b32 v10, 3, v2
    v_and_b32 v11, 3, v10
    v_lshrrev_b32 v12, 2, v10
    s_mov_b32 s40, s30
    s_mov_b32 s41, s31
    s_mov_b32 s42, 0x21c000
    s_mov_b32 s43, 0x00020000
    s_add_u32 s44, s38, 0x1000000
    s_addc_u32 s45, s39, 0
    s_mov_b32 s46, 0x21c000
    s_mov_b32 s47, 0x00020000
    s_add_u32 s48, s38, 0xc90000
    s_addc_u32 s49, s39, 0
    s_mov_b32 s50, 0x1b00
    s_mov_b32 s51, 0x00020000
    s_sub_u32 s4, s2, 160
    s_mov_b32 s5, s3
    v_mul_u32_u24 v13, 27648, v10
    v_lshl_add_u32 v13, v9, 4, v13
    s_lshl_b32 s6, s4, 7
    s_mul_i32 s8, s5, 221184
    s_add_u32 s8, s8, s6
    s_add_u32 s9, s8, 0
    buffer_load_dwordx4 v[32:35], v13, s[40:43], s9 offen
    s_add_u32 s9, s8, 3456
    buffer_load_dwordx4 v[36:39], v13, s[40:43], s9 offen
    s_add_u32 s9, s8, 6912
    buffer_load_dwordx4 v[40:43], v13, s[40:43], s9 offen
    s_add_u32 s9, s8, 10368
    buffer_load_dwordx4 v[44:47], v13, s[40:43], s9 offen
    s_add_u32 s9, s8, 13824
    buffer_load_dwordx4 v[48:51], v13, s[40:43], s9 offen
    s_add_u32 s9, s8, 17280
    buffer_load_dwordx4 v[52:55], v13, s[40:43], s9 offen
    s_add_u32 s9, s8, 20736
    buffer_load_dwordx4 v[56:59], v13, s[40:43], s9 offen
    s_add_u32 s9, s8, 24192
    buffer_load_dwordx4 v[60:63], v13, s[40:43], s9 offen
    s_add_u32 s9, s8, 884736
    buffer_load_dwordx4 v[64:67], v13, s[40:43], s9 offen
    s_add_u32 s9, s8, 888192
    buffer_load_dwordx4 v[68:71], v13, s[40:43], s9 offen
    s_add_u32 s9, s8, 891648
    buffer_load_dwordx4 v[72:75], v13, s[40:43], s9 offen
    s_add_u32 s9, s8, 895104
    buffer_load_dwordx4 v[76:79], v13, s[40:43], s9 offen
    s_add_u32 s9, s8, 898560
    buffer_load_dwordx4 v[80:83], v13, s[40:43], s9 offen
    s_add_u32 s9, s8, 902016
    buffer_load_dwordx4 v[84:87], v13, s[40:43], s9 offen
    s_add_u32 s9, s8, 905472
    buffer_load_dwordx4 v[88:91], v13, s[40:43], s9 offen
    s_add_u32 s9, s8, 908928
    buffer_load_dwordx4 v[92:95], v13, s[40:43], s9 offen
    s_add_u32 s9, s8, 1769472
    buffer_load_dwordx4 v[96:99], v13, s[40:43], s9 offen
    s_add_u32 s9, s8, 1772928
    buffer_load_dwordx4 v[100:103], v13, s[40:43], s9 offen
    s_add_u32 s9, s8, 1776384
    buffer_load_dwordx4 v[104:107], v13, s[40:43], s9 offen
    s_add_u32 s9, s8, 1779840
    buffer_load_dwordx4 v[108:111], v13, s[40:43], s9 offen
    s_add_u32 s9, s8, 1783296
    buffer_load_dwordx4 v[112:115], v13, s[40:43], s9 offen
    s_add_u32 s9, s8, 1786752
    buffer_load_dwordx4 v[116:119], v13, s[40:43], s9 offen
    s_add_u32 s9, s8, 1790208
    buffer_load_dwordx4 v[120:123], v13, s[40:43], s9 offen
    s_add_u32 s9, s8, 1793664
    buffer_load_dwordx4 v[124:127], v13, s[40:43], s9 offen
    v_lshrrev_b32 v14, 1, v9
    v_lshl_add_u32 v14, v14, 1, v12
    v_mul_u32_u24 v14, 1040, v14
    v_lshl_add_u32 v14, v11, 8, v14
    v_and_b32 v15, 1, v9
    v_lshl_add_u32 v14, v15, 7, v14
    s_mul_i32 s11, s3, 8448
    v_add_u32 v14, s11, v14
    v_lshlrev_b32 v15, 4, v2
    v_add_u32 v18, s11, v15
    s_mul_i32 s10, s4, 81920
    s_lshl_b32 s11, s5, 11
    s_add_u32 s10, s10, s11
    s_mov_b32 s12, 0x05040100
    s_mov_b32 s13, 0x07060302
    v_mov_b32 v16, 0x3f803f80
    v_mov_b32 v160, 0
    v_mov_b32 v161, 0
    v_mov_b32 v162, 0
    v_mov_b32 v163, 0
    v_mov_b32 v164, 0
    v_mov_b32 v165, 0
    v_mov_b32 v166, 0
    v_mov_b32 v167, 0
    s_waitcnt vmcnt(16)
    v_perm_b32 v128, v36, v32, s12
    v_perm_b32 v129, v44, v40, s12
    v_perm_b32 v130, v52, v48, s12
    v_perm_b32 v131, v60, v56, s12
    ds_write_b128 v14, v[128:131] offset:0
    v_perm_b32 v132, v36, v32, s13
    v_perm_b32 v133, v44, v40, s13
    v_perm_b32 v134, v52, v48, s13
    v_perm_b32 v135, v60, v56, s13
    ds_write_b128 v14, v[132:135] offset:16
    v_perm_b32 v136, v37, v33, s12
    v_perm_b32 v137, v45, v41, s12
    v_perm_b32 v138, v53, v49, s12
    v_perm_b32 v139, v61, v57, s12
    ds_write_b128 v14, v[136:139] offset:32
    v_perm_b32 v140, v37, v33, s13
    v_perm_b32 v141, v45, v41, s13
    v_perm_b32 v142, v53, v49, s13
    v_perm_b32 v143, v61, v57, s13
    ds_write_b128 v14, v[140:143] offset:48
    v_perm_b32 v144, v38, v34, s12
    v_perm_b32 v145, v46, v42, s12
    v_perm_b32 v146, v54, v50, s12
    v_perm_b32 v147, v62, v58, s12
    ds_write_b128 v14, v[144:147] offset:64
    v_perm_b32 v148, v38, v34, s13
    v_perm_b32 v149, v46, v42, s13
    v_perm_b32 v150, v54, v50, s13
    v_perm_b32 v151, v62, v58, s13
    ds_write_b128 v14, v[148:151] offset:80
    v_perm_b32 v152, v39, v35, s12
    v_perm_b32 v153, v47, v43, s12
    v_perm_b32 v154, v55, v51, s12
    v_perm_b32 v155, v63, v59, s12
    ds_write_b128 v14, v[152:155] offset:96
    v_perm_b32 v156, v39, v35, s13
    v_perm_b32 v157, v47, v43, s13
    v_perm_b32 v158, v55, v51, s13
    v_perm_b32 v159, v63, v59, s13
    ds_write_b128 v14, v[156:159] offset:112
    v_dot2_f32_bf16 v160, v128, v16, v160
    v_dot2_f32_bf16 v161, v132, v16, v161
    v_dot2_f32_bf16 v162, v136, v16, v162
    v_dot2_f32_bf16 v163, v140, v16, v163
    v_dot2_f32_bf16 v164, v144, v16, v164
    v_dot2_f32_bf16 v165, v148, v16, v165
    v_dot2_f32_bf16 v166, v152, v16, v166
    v_dot2_f32_bf16 v167, v156, v16, v167
    v_dot2_f32_bf16 v160, v129, v16, v160
    v_dot2_f32_bf16 v161, v133, v16, v161
    v_dot2_f32_bf16 v162, v137, v16, v162
    v_dot2_f32_bf16 v163, v141, v16, v163
    v_dot2_f32_bf16 v164, v145, v16, v164
    v_dot2_f32_bf16 v165, v149, v16, v165
    v_dot2_f32_bf16 v166, v153, v16, v166
    v_dot2_f32_bf16 v167, v157, v16, v167
    v_dot2_f32_bf16 v160, v130, v16, v160
    v_dot2_f32_bf16 v161, v134, v16, v161
    v_dot2_f32_bf16 v162, v138, v16, v162
    v_dot2_f32_bf16 v163, v142, v16, v163
    v_dot2_f32_bf16 v164, v146, v16, v164
    v_dot2_f32_bf16 v165, v150, v16, v165
    v_dot2_f32_bf16 v166, v154, v16, v166
    v_dot2_f32_bf16 v167, v158, v16, v167
    v_dot2_f32_bf16 v160, v131, v16, v160
    v_dot2_f32_bf16 v161, v135, v16, v161
    v_dot2_f32_bf16 v162, v139, v16, v162
    v_dot2_f32_bf16 v163, v143, v16, v163
    v_dot2_f32_bf16 v164, v147, v16, v164
    v_dot2_f32_bf16 v165, v151, v16, v165
    v_dot2_f32_bf16 v166, v155, v16, v166
    v_dot2_f32_bf16 v167, v159, v16, v167
    s_waitcnt lgkmcnt(0)
    ds_read_b128 v[32:35], v18 offset:0
    ds_read_b128 v[36:39], v18 offset:1040
    ds_read_b128 v[40:43], v18 offset:2080
    ds_read_b128 v[44:47], v18 offset:3120
    ds_read_b128 v[48:51], v18 offset:4160
    ds_read_b128 v[52:55], v18 offset:5200
    ds_read_b128 v[56:59], v18 offset:6240
    ds_read_b128 v[60:63], v18 offset:7280
    s_waitcnt lgkmcnt(0)
    s_add_u32 s9, s10, 0
    buffer_store_dwordx4 v[32:35], v15, s[44:47], s9 offen sc1
    s_add_u32 s9, s10, 1024
    buffer_store_dwordx4 v[36:39], v15, s[44:47], s9 offen sc1
    s_add_u32 s9, s10, 20480
    buffer_store_dwordx4 v[40:43], v15, s[44:47], s9 offen sc1
    s_add_u32 s9, s10, 21504
    buffer_store_dwordx4 v[44:47], v15, s[44:47], s9 offen sc1
    s_add_u32 s9, s10, 40960
    buffer_store_dwordx4 v[48:51], v15, s[44:47], s9 offen sc1
    s_add_u32 s9, s10, 41984
    buffer_store_dwordx4 v[52:55], v15, s[44:47], s9 offen sc1
    s_add_u32 s9, s10, 61440
    buffer_store_dwordx4 v[56:59], v15, s[44:47], s9 offen sc1
    s_add_u32 s9, s10, 62464
    buffer_store_dwordx4 v[60:63], v15, s[44:47], s9 offen sc1
    s_add_u32 s10, s10, 8192
    s_waitcnt vmcnt(16)
    v_perm_b32 v128, v68, v64, s12
    v_perm_b32 v129, v76, v72, s12
    v_perm_b32 v130, v84, v80, s12
    v_perm_b32 v131, v92, v88, s12
    ds_write_b128 v14, v[128:131] offset:0
    v_perm_b32 v132, v68, v64, s13
    v_perm_b32 v133, v76, v72, s13
    v_perm_b32 v134, v84, v80, s13
    v_perm_b32 v135, v92, v88, s13
    ds_write_b128 v14, v[132:135] offset:16
    v_perm_b32 v136, v69, v65, s12
    v_perm_b32 v137, v77, v73, s12
    v_perm_b32 v138, v85, v81, s12
    v_perm_b32 v139, v93, v89, s12
    ds_write_b128 v14, v[136:139] offset:32
    v_perm_b32 v140, v69, v65, s13
    v_perm_b32 v141, v77, v73, s13
    v_perm_b32 v142, v85, v81, s13
    v_perm_b32 v143, v93, v89, s13
    ds_write_b128 v14, v[140:143] offset:48
    v_perm_b32 v144, v70, v66, s12
    v_perm_b32 v145, v78, v74, s12
    v_perm_b32 v146, v86, v82, s12
    v_perm_b32 v147, v94, v90, s12
    ds_write_b128 v14, v[144:147] offset:64
    v_perm_b32 v148, v70, v66, s13
    v_perm_b32 v149, v78, v74, s13
    v_perm_b32 v150, v86, v82, s13
    v_perm_b32 v151, v94, v90, s13
    ds_write_b128 v14, v[148:151] offset:80
    v_perm_b32 v152, v71, v67, s12
    v_perm_b32 v153, v79, v75, s12
    v_perm_b32 v154, v87, v83, s12
    v_perm_b32 v155, v95, v91, s12
    ds_write_b128 v14, v[152:155] offset:96
    v_perm_b32 v156, v71, v67, s13
    v_perm_b32 v157, v79, v75, s13
    v_perm_b32 v158, v87, v83, s13
    v_perm_b32 v159, v95, v91, s13
    ds_write_b128 v14, v[156:159] offset:112
    v_dot2_f32_bf16 v160, v128, v16, v160
    v_dot2_f32_bf16 v161, v132, v16, v161
    v_dot2_f32_bf16 v162, v136, v16, v162
    v_dot2_f32_bf16 v163, v140, v16, v163
    v_dot2_f32_bf16 v164, v144, v16, v164
    v_dot2_f32_bf16 v165, v148, v16, v165
    v_dot2_f32_bf16 v166, v152, v16, v166
    v_dot2_f32_bf16 v167, v156, v16, v167
    v_dot2_f32_bf16 v160, v129, v16, v160
    v_dot2_f32_bf16 v161, v133, v16, v161
    v_dot2_f32_bf16 v162, v137, v16, v162
    v_dot2_f32_bf16 v163, v141, v16, v163
    v_dot2_f32_bf16 v164, v145, v16, v164
    v_dot2_f32_bf16 v165, v149, v16, v165
    v_dot2_f32_bf16 v166, v153, v16, v166
    v_dot2_f32_bf16 v167, v157, v16, v167
    v_dot2_f32_bf16 v160, v130, v16, v160
    v_dot2_f32_bf16 v161, v134, v16, v161
    v_dot2_f32_bf16 v162, v138, v16, v162
    v_dot2_f32_bf16 v163, v142, v16, v163
    v_dot2_f32_bf16 v164, v146, v16, v164
    v_dot2_f32_bf16 v165, v150, v16, v165
    v_dot2_f32_bf16 v166, v154, v16, v166
    v_dot2_f32_bf16 v167, v158, v16, v167
    v_dot2_f32_bf16 v160, v131, v16, v160
    v_dot2_f32_bf16 v161, v135, v16, v161
    v_dot2_f32_bf16 v162, v139, v16, v162
    v_dot2_f32_bf16 v163, v143, v16, v163
    v_dot2_f32_bf16 v164, v147, v16, v164
    v_dot2_f32_bf16 v165, v151, v16, v165
    v_dot2_f32_bf16 v166, v155, v16, v166
    v_dot2_f32_bf16 v167, v159, v16, v167
    s_waitcnt lgkmcnt(0)
    ds_read_b128 v[64:67], v18 offset:0
    ds_read_b128 v[68:71], v18 offset:1040
    ds_read_b128 v[72:75], v18 offset:2080
    ds_read_b128 v[76:79], v18 offset:3120
    ds_read_b128 v[80:83], v18 offset:4160
    ds_read_b128 v[84:87], v18 offset:5200
    ds_read_b128 v[88:91], v18 offset:6240
    ds_read_b128 v[92:95], v18 offset:7280
    s_waitcnt lgkmcnt(0)
    s_add_u32 s9, s10, 0
    buffer_store_dwordx4 v[64:67], v15, s[44:47], s9 offen sc1
    s_add_u32 s9, s10, 1024
    buffer_store_dwordx4 v[68:71], v15, s[44:47], s9 offen sc1
    s_add_u32 s9, s10, 20480
    buffer_store_dwordx4 v[72:75], v15, s[44:47], s9 offen sc1
    s_add_u32 s9, s10, 21504
    buffer_store_dwordx4 v[76:79], v15, s[44:47], s9 offen sc1
    s_add_u32 s9, s10, 40960
    buffer_store_dwordx4 v[80:83], v15, s[44:47], s9 offen sc1
    s_add_u32 s9, s10, 41984
    buffer_store_dwordx4 v[84:87], v15, s[44:47], s9 offen sc1
    s_add_u32 s9, s10, 61440
    buffer_store_dwordx4 v[88:91], v15, s[44:47], s9 offen sc1
    s_add_u32 s9, s10, 62464
    buffer_store_dwordx4 v[92:95], v15, s[44:47], s9 offen sc1
    s_add_u32 s10, s10, 8192
    s_cmp_ge_u32 s3, 2
    s_cbranch_scc1 k1_w1_red
    s_waitcnt vmcnt(16)
    v_perm_b32 v128, v100, v96, s12
    v_perm_b32 v129, v108, v104, s12
    v_perm_b32 v130, v116, v112, s12
    v_perm_b32 v131, v124, v120, s12
    ds_write_b128 v14, v[128:131] offset:0
    v_perm_b32 v132, v100, v96, s13
    v_perm_b32 v133, v108, v104, s13
    v_perm_b32 v134, v116, v112, s13
    v_perm_b32 v135, v124, v120, s13
    ds_write_b128 v14, v[132:135] offset:16
    v_perm_b32 v136, v101, v97, s12
    v_perm_b32 v137, v109, v105, s12
    v_perm_b32 v138, v117, v113, s12
    v_perm_b32 v139, v125, v121, s12
    ds_write_b128 v14, v[136:139] offset:32
    v_perm_b32 v140, v101, v97, s13
    v_perm_b32 v141, v109, v105, s13
    v_perm_b32 v142, v117, v113, s13
    v_perm_b32 v143, v125, v121, s13
    ds_write_b128 v14, v[140:143] offset:48
    v_perm_b32 v144, v102, v98, s12
    v_perm_b32 v145, v110, v106, s12
    v_perm_b32 v146, v118, v114, s12
    v_perm_b32 v147, v126, v122, s12
    ds_write_b128 v14, v[144:147] offset:64
    v_perm_b32 v148, v102, v98, s13
    v_perm_b32 v149, v110, v106, s13
    v_perm_b32 v150, v118, v114, s13
    v_perm_b32 v151, v126, v122, s13
    ds_write_b128 v14, v[148:151] offset:80
    v_perm_b32 v152, v103, v99, s12
    v_perm_b32 v153, v111, v107, s12
    v_perm_b32 v154, v119, v115, s12
    v_perm_b32 v155, v127, v123, s12
    ds_write_b128 v14, v[152:155] offset:96
    v_perm_b32 v156, v103, v99, s13
    v_perm_b32 v157, v111, v107, s13
    v_perm_b32 v158, v119, v115, s13
    v_perm_b32 v159, v127, v123, s13
    ds_write_b128 v14, v[156:159] offset:112
    v_dot2_f32_bf16 v160, v128, v16, v160
    v_dot2_f32_bf16 v161, v132, v16, v161
    v_dot2_f32_bf16 v162, v136, v16, v162
    v_dot2_f32_bf16 v163, v140, v16, v163
    v_dot2_f32_bf16 v164, v144, v16, v164
    v_dot2_f32_bf16 v165, v148, v16, v165
    v_dot2_f32_bf16 v166, v152, v16, v166
    v_dot2_f32_bf16 v167, v156, v16, v167
    v_dot2_f32_bf16 v160, v129, v16, v160
    v_dot2_f32_bf16 v161, v133, v16, v161
    v_dot2_f32_bf16 v162, v137, v16, v162
    v_dot2_f32_bf16 v163, v141, v16, v163
    v_dot2_f32_bf16 v164, v145, v16, v164
    v_dot2_f32_bf16 v165, v149, v16, v165
    v_dot2_f32_bf16 v166, v153, v16, v166
    v_dot2_f32_bf16 v167, v157, v16, v167
    v_dot2_f32_bf16 v160, v130, v16, v160
    v_dot2_f32_bf16 v161, v134, v16, v161
    v_dot2_f32_bf16 v162, v138, v16, v162
    v_dot2_f32_bf16 v163, v142, v16, v163
    v_dot2_f32_bf16 v164, v146, v16, v164
    v_dot2_f32_bf16 v165, v150, v16, v165
    v_dot2_f32_bf16 v166, v154, v16, v166
    v_dot2_f32_bf16 v167, v158, v16, v167
    v_dot2_f32_bf16 v160, v131, v16, v160
    v_dot2_f32_bf16 v161, v135, v16, v161
    v_dot2_f32_bf16 v162, v139, v16, v162
    v_dot2_f32_bf16 v163, v143, v16, v163
    v_dot2_f32_bf16 v164, v147, v16, v164
    v_dot2_f32_bf16 v165, v151, v16, v165
    v_dot2_f32_bf16 v166, v155, v16, v166
    v_dot2_f32_bf16 v167, v159, v16, v167
    s_waitcnt lgkmcnt(0)
    ds_read_b128 v[96:99], v18 offset:0
    ds_read_b128 v[100:103], v18 offset:1040
    ds_read_b128 v[104:107], v18 offset:2080
    ds_read_b128 v[108:111], v18 offset:3120
    ds_read_b128 v[112:115], v18 offset:4160
    ds_read_b128 v[116:119], v18 offset:5200
    ds_read_b128 v[120:123], v18 offset:6240
    ds_read_b128 v[124:127], v18 offset:7280
    s_waitcnt lgkmcnt(0)
    s_add_u32 s9, s10, 0
    buffer_store_dwordx4 v[96:99], v15, s[44:47], s9 offen sc1
    s_add_u32 s9, s10, 1024
    buffer_store_dwordx4 v[100:103], v15, s[44:47], s9 offen sc1
    s_add_u32 s9, s10, 20480
    buffer_store_dwordx4 v[104:107], v15, s[44:47], s9 offen sc1
    s_add_u32 s9, s10, 21504
    buffer_store_dwordx4 v[108:111], v15, s[44:47], s9 offen sc1
    s_add_u32 s9, s10, 40960
    buffer_store_dwordx4 v[112:115], v15, s[44:47], s9 offen sc1
    s_add_u32 s9, s10, 41984
    buffer_store_dwordx4 v[116:119], v15, s[44:47], s9 offen sc1
    s_add_u32 s9, s10, 61440
    buffer_store_dwordx4 v[120:123], v15, s[44:47], s9 offen sc1
    s_add_u32 s9, s10, 62464
    buffer_store_dwordx4 v[124:127], v15, s[44:47], s9 offen sc1
k1_w1_red:
    s_nop 4
    v_lshlrev_b32 v17, 5, v0
    ds_write_b128 v17, v[160:163] offset:40960
    ds_write_b128 v17, v[164:167] offset:40976
    s_waitcnt lgkmcnt(0)
    s_barrier
    s_cmp_lg_u32 s3, 0
    s_cbranch_scc1 k1_w1_done
    v_lshlrev_b32 v17, 2, v2
    ds_read_b32 v32, v17 offset:40960
    ds_read_b32 v33, v17 offset:41216
    ds_read_b32 v34, v17 offset:41472
    ds_read_b32 v35, v17 offset:41728
    ds_read_b32 v36, v17 offset:41984
    ds_read_b32 v37, v17 offset:42240
    ds_read_b32 v38, v17 offset:42496
    ds_read_b32 v39, v17 offset:42752
    ds_read_b32 v40, v17 offset:43008
    ds_read_b32 v41, v17 offset:43264
    ds_read_b32 v42, v17 offset:43520
    ds_read_b32 v43, v17 offset:43776
    ds_read_b32 v44, v17 offset:44032
    ds_read_b32 v45, v17 offset:44288
    ds_read_b32 v46, v17 offset:44544
    ds_read_b32 v47, v17 offset:44800
    ds_read_b32 v48, v17 offset:45056
    ds_read_b32 v49, v17 offset:45312
    ds_read_b32 v50, v17 offset:45568
    ds_read_b32 v51, v17 offset:45824
    ds_read_b32 v52, v17 offset:46080
    ds_read_b32 v53, v17 offset:46336
    ds_read_b32 v54, v17 offset:46592
    ds_read_b32 v55, v17 offset:46848
    ds_read_b32 v56, v17 offset:47104
    ds_read_b32 v57, v17 offset:47360
    ds_read_b32 v58, v17 offset:47616
    ds_read_b32 v59, v17 offset:47872
    ds_read_b32 v60, v17 offset:48128
    ds_read_b32 v61, v17 offset:48384
    ds_read_b32 v62, v17 offset:48640
    ds_read_b32 v63, v17 offset:48896
    s_waitcnt lgkmcnt(0)
    v_add_f32 v32, v32, v48
    v_add_f32 v33, v33, v49
    v_add_f32 v34, v34, v50
    v_add_f32 v35, v35, v51
    v_add_f32 v36, v36, v52
    v_add_f32 v37, v37, v53
    v_add_f32 v38, v38, v54
    v_add_f32 v39, v39, v55
    v_add_f32 v40, v40, v56
    v_add_f32 v41, v41, v57
    v_add_f32 v42, v42, v58
    v_add_f32 v43, v43, v59
    v_add_f32 v44, v44, v60
    v_add_f32 v45, v45, v61
    v_add_f32 v46, v46, v62
    v_add_f32 v47, v47, v63
    v_add_f32 v32, v32, v40
    v_add_f32 v33, v33, v41
    v_add_f32 v34, v34, v42
    v_add_f32 v35, v35, v43
    v_add_f32 v36, v36, v44
    v_add_f32 v37, v37, v45
    v_add_f32 v38, v38, v46
    v_add_f32 v39, v39, v47
    v_add_f32 v32, v32, v36
    v_add_f32 v33, v33, v37
    v_add_f32 v34, v34, v38
    v_add_f32 v35, v35, v39
    v_add_f32 v32, v32, v34
    v_add_f32 v33, v33, v35
    v_add_f32 v32, v32, v33
    s_lshl_b32 s6, s4, 8
    buffer_store_dword v32, v17, s[48:51], s6 offen sc1
k1_w1_done:
    s_endpgm
k1_n1:
    s_cmp_ge_u32 s2, 210
    s_cbranch_scc1 k1_n2
    v_and_b32 v9, 7, v2
    v_lshrrev_b32 v10, 3, v2
    v_and_b32 v11, 3, v10
    v_lshrrev_b32 v12, 2, v10
    s_mov_b32 s40, s32
    s_mov_b32 s41, s33
    s_mov_b32 s42, 0x21c000
    s_mov_b32 s43, 0x00020000
    s_add_u32 s44, s38, 0x1400000
    s_addc_u32 s45, s39, 0
    s_mov_b32 s46, 0x21c000
    s_mov_b32 s47, 0x00020000
    s_sub_u32 s7, s2, 187
    s_lshl_b32 s7, s7, 2
    s_add_u32 s7, s7, s3
    s_cmp_ge_u32 s7, 90
    s_cbranch_scc1 k1_exit
    s_mul_hi_u32 s4, s7, 0x1c71c71d
    s_mul_i32 s5, s4, 9
    s_sub_u32 s5, s7, s5
    s_mul_i32 s5, s5, 3
    v_mul_u32_u24 v13, 40960, v12
    v_mul_u32_u24 v14, 5120, v11
    v_add_u32 v13, v13, v14
    v_lshl_add_u32 v13, v9, 4, v13
    s_lshl_b32 s6, s4, 7
    s_mul_i32 s8, s5, 81920
    s_add_u32 s8, s8, s6
    s_add_u32 s9, s8, 0
    buffer_load_dwordx4 v[32:35], v13, s[40:43], s9 offen
    s_add_u32 s9, s8, 1280
    buffer_load_dwordx4 v[36:39], v13, s[40:43], s9 offen
    s_add_u32 s9, s8, 2560
    buffer_load_dwordx4 v[40:43], v13, s[40:43], s9 offen
    s_add_u32 s9, s8, 3840
    buffer_load_dwordx4 v[44:47], v13, s[40:43], s9 offen
    s_add_u32 s9, s8, 20480
    buffer_load_dwordx4 v[48:51], v13, s[40:43], s9 offen
    s_add_u32 s9, s8, 21760
    buffer_load_dwordx4 v[52:55], v13, s[40:43], s9 offen
    s_add_u32 s9, s8, 23040
    buffer_load_dwordx4 v[56:59], v13, s[40:43], s9 offen
    s_add_u32 s9, s8, 24320
    buffer_load_dwordx4 v[60:63], v13, s[40:43], s9 offen
    s_add_u32 s9, s8, 81920
    buffer_load_dwordx4 v[64:67], v13, s[40:43], s9 offen
    s_add_u32 s9, s8, 83200
    buffer_load_dwordx4 v[68:71], v13, s[40:43], s9 offen
    s_add_u32 s9, s8, 84480
    buffer_load_dwordx4 v[72:75], v13, s[40:43], s9 offen
    s_add_u32 s9, s8, 85760
    buffer_load_dwordx4 v[76:79], v13, s[40:43], s9 offen
    s_add_u32 s9, s8, 102400
    buffer_load_dwordx4 v[80:83], v13, s[40:43], s9 offen
    s_add_u32 s9, s8, 103680
    buffer_load_dwordx4 v[84:87], v13, s[40:43], s9 offen
    s_add_u32 s9, s8, 104960
    buffer_load_dwordx4 v[88:91], v13, s[40:43], s9 offen
    s_add_u32 s9, s8, 106240
    buffer_load_dwordx4 v[92:95], v13, s[40:43], s9 offen
    s_add_u32 s9, s8, 163840
    buffer_load_dwordx4 v[96:99], v13, s[40:43], s9 offen
    s_add_u32 s9, s8, 165120
    buffer_load_dwordx4 v[100:103], v13, s[40:43], s9 offen
    s_add_u32 s9, s8, 166400
    buffer_load_dwordx4 v[104:107], v13, s[40:43], s9 offen
    s_add_u32 s9, s8, 167680
    buffer_load_dwordx4 v[108:111], v13, s[40:43], s9 offen
    s_add_u32 s9, s8, 184320
    buffer_load_dwordx4 v[112:115], v13, s[40:43], s9 offen
    s_add_u32 s9, s8, 185600
    buffer_load_dwordx4 v[116:119], v13, s[40:43], s9 offen
    s_add_u32 s9, s8, 186880
    buffer_load_dwordx4 v[120:123], v13, s[40:43], s9 offen
    s_add_u32 s9, s8, 188160
    buffer_load_dwordx4 v[124:127], v13, s[40:43], s9 offen
    v_lshrrev_b32 v14, 1, v9
    v_lshl_add_u32 v14, v14, 1, v12
    v_mul_u32_u24 v14, 1040, v14
    v_lshl_add_u32 v14, v11, 8, v14
    v_and_b32 v15, 1, v9
    v_lshl_add_u32 v14, v15, 7, v14
    s_mul_i32 s11, s3, 8448
    v_add_u32 v14, s11, v14
    v_lshlrev_b32 v15, 4, v2
    v_add_u32 v18, s11, v15
    s_mul_i32 s10, s4, 221184
    s_lshl_b32 s11, s5, 11
    s_add_u32 s10, s10, s11
    s_mov_b32 s12, 0x05040100
    s_mov_b32 s13, 0x07060302
    s_waitcnt vmcnt(16)
    v_perm_b32 v128, v36, v32, s12
    v_perm_b32 v129, v44, v40, s12
    v_perm_b32 v130, v52, v48, s12
    v_perm_b32 v131, v60, v56, s12
    ds_write_b128 v14, v[128:131] offset:0
    v_perm_b32 v132, v36, v32, s13
    v_perm_b32 v133, v44, v40, s13
    v_perm_b32 v134, v52, v48, s13
    v_perm_b32 v135, v60, v56, s13
    ds_write_b128 v14, v[132:135] offset:16
    v_perm_b32 v136, v37, v33, s12
    v_perm_b32 v137, v45, v41, s12
    v_perm_b32 v138, v53, v49, s12
    v_perm_b32 v139, v61, v57, s12
    ds_write_b128 v14, v[136:139] offset:32
    v_perm_b32 v140, v37, v33, s13
    v_perm_b32 v141, v45, v41, s13
    v_perm_b32 v142, v53, v49, s13
    v_perm_b32 v143, v61, v57, s13
    ds_write_b128 v14, v[140:143] offset:48
    v_perm_b32 v144, v38, v34, s12
    v_perm_b32 v145, v46, v42, s12
    v_perm_b32 v146, v54, v50, s12
    v_perm_b32 v147, v62, v58, s12
    ds_write_b128 v14, v[144:147] offset:64
    v_perm_b32 v148, v38, v34, s13
    v_perm_b32 v149, v46, v42, s13
    v_perm_b32 v150, v54, v50, s13
    v_perm_b32 v151, v62, v58, s13
    ds_write_b128 v14, v[148:151] offset:80
    v_perm_b32 v152, v39, v35, s12
    v_perm_b32 v153, v47, v43, s12
    v_perm_b32 v154, v55, v51, s12
    v_perm_b32 v155, v63, v59, s12
    ds_write_b128 v14, v[152:155] offset:96
    v_perm_b32 v156, v39, v35, s13
    v_perm_b32 v157, v47, v43, s13
    v_perm_b32 v158, v55, v51, s13
    v_perm_b32 v159, v63, v59, s13
    ds_write_b128 v14, v[156:159] offset:112
    s_waitcnt lgkmcnt(0)
    ds_read_b128 v[32:35], v18 offset:0
    ds_read_b128 v[36:39], v18 offset:1040
    ds_read_b128 v[40:43], v18 offset:2080
    ds_read_b128 v[44:47], v18 offset:3120
    ds_read_b128 v[48:51], v18 offset:4160
    ds_read_b128 v[52:55], v18 offset:5200
    ds_read_b128 v[56:59], v18 offset:6240
    ds_read_b128 v[60:63], v18 offset:7280
    s_waitcnt lgkmcnt(0)
    s_add_u32 s9, s10, 0
    buffer_store_dwordx4 v[32:35], v15, s[44:47], s9 offen sc1
    s_add_u32 s9, s10, 1024
    buffer_store_dwordx4 v[36:39], v15, s[44:47], s9 offen sc1
    s_add_u32 s9, s10, 55296
    buffer_store_dwordx4 v[40:43], v15, s[44:47], s9 offen sc1
    s_add_u32 s9, s10, 56320
    buffer_store_dwordx4 v[44:47], v15, s[44:47], s9 offen sc1
    s_add_u32 s9, s10, 110592
    buffer_store_dwordx4 v[48:51], v15, s[44:47], s9 offen sc1
    s_add_u32 s9, s10, 111616
    buffer_store_dwordx4 v[52:55], v15, s[44:47], s9 offen sc1
    s_add_u32 s9, s10, 165888
    buffer_store_dwordx4 v[56:59], v15, s[44:47], s9 offen sc1
    s_add_u32 s9, s10, 166912
    buffer_store_dwordx4 v[60:63], v15, s[44:47], s9 offen sc1
    s_add_u32 s10, s10, 2048
    s_waitcnt vmcnt(16)
    v_perm_b32 v128, v68, v64, s12
    v_perm_b32 v129, v76, v72, s12
    v_perm_b32 v130, v84, v80, s12
    v_perm_b32 v131, v92, v88, s12
    ds_write_b128 v14, v[128:131] offset:0
    v_perm_b32 v132, v68, v64, s13
    v_perm_b32 v133, v76, v72, s13
    v_perm_b32 v134, v84, v80, s13
    v_perm_b32 v135, v92, v88, s13
    ds_write_b128 v14, v[132:135] offset:16
    v_perm_b32 v136, v69, v65, s12
    v_perm_b32 v137, v77, v73, s12
    v_perm_b32 v138, v85, v81, s12
    v_perm_b32 v139, v93, v89, s12
    ds_write_b128 v14, v[136:139] offset:32
    v_perm_b32 v140, v69, v65, s13
    v_perm_b32 v141, v77, v73, s13
    v_perm_b32 v142, v85, v81, s13
    v_perm_b32 v143, v93, v89, s13
    ds_write_b128 v14, v[140:143] offset:48
    v_perm_b32 v144, v70, v66, s12
    v_perm_b32 v145, v78, v74, s12
    v_perm_b32 v146, v86, v82, s12
    v_perm_b32 v147, v94, v90, s12
    ds_write_b128 v14, v[144:147] offset:64
    v_perm_b32 v148, v70, v66, s13
    v_perm_b32 v149, v78, v74, s13
    v_perm_b32 v150, v86, v82, s13
    v_perm_b32 v151, v94, v90, s13
    ds_write_b128 v14, v[148:151] offset:80
    v_perm_b32 v152, v71, v67, s12
    v_perm_b32 v153, v79, v75, s12
    v_perm_b32 v154, v87, v83, s12
    v_perm_b32 v155, v95, v91, s12
    ds_write_b128 v14, v[152:155] offset:96
    v_perm_b32 v156, v71, v67, s13
    v_perm_b32 v157, v79, v75, s13
    v_perm_b32 v158, v87, v83, s13
    v_perm_b32 v159, v95, v91, s13
    ds_write_b128 v14, v[156:159] offset:112
    s_waitcnt lgkmcnt(0)
    ds_read_b128 v[64:67], v18 offset:0
    ds_read_b128 v[68:71], v18 offset:1040
    ds_read_b128 v[72:75], v18 offset:2080
    ds_read_b128 v[76:79], v18 offset:3120
    ds_read_b128 v[80:83], v18 offset:4160
    ds_read_b128 v[84:87], v18 offset:5200
    ds_read_b128 v[88:91], v18 offset:6240
    ds_read_b128 v[92:95], v18 offset:7280
    s_waitcnt lgkmcnt(0)
    s_add_u32 s9, s10, 0
    buffer_store_dwordx4 v[64:67], v15, s[44:47], s9 offen sc1
    s_add_u32 s9, s10, 1024
    buffer_store_dwordx4 v[68:71], v15, s[44:47], s9 offen sc1
    s_add_u32 s9, s10, 55296
    buffer_store_dwordx4 v[72:75], v15, s[44:47], s9 offen sc1
    s_add_u32 s9, s10, 56320
    buffer_store_dwordx4 v[76:79], v15, s[44:47], s9 offen sc1
    s_add_u32 s9, s10, 110592
    buffer_store_dwordx4 v[80:83], v15, s[44:47], s9 offen sc1
    s_add_u32 s9, s10, 111616
    buffer_store_dwordx4 v[84:87], v15, s[44:47], s9 offen sc1
    s_add_u32 s9, s10, 165888
    buffer_store_dwordx4 v[88:91], v15, s[44:47], s9 offen sc1
    s_add_u32 s9, s10, 166912
    buffer_store_dwordx4 v[92:95], v15, s[44:47], s9 offen sc1
    s_add_u32 s10, s10, 2048
    s_waitcnt vmcnt(16)
    v_perm_b32 v128, v100, v96, s12
    v_perm_b32 v129, v108, v104, s12
    v_perm_b32 v130, v116, v112, s12
    v_perm_b32 v131, v124, v120, s12
    ds_write_b128 v14, v[128:131] offset:0
    v_perm_b32 v132, v100, v96, s13
    v_perm_b32 v133, v108, v104, s13
    v_perm_b32 v134, v116, v112, s13
    v_perm_b32 v135, v124, v120, s13
    ds_write_b128 v14, v[132:135] offset:16
    v_perm_b32 v136, v101, v97, s12
    v_perm_b32 v137, v109, v105, s12
    v_perm_b32 v138, v117, v113, s12
    v_perm_b32 v139, v125, v121, s12
    ds_write_b128 v14, v[136:139] offset:32
    v_perm_b32 v140, v101, v97, s13
    v_perm_b32 v141, v109, v105, s13
    v_perm_b32 v142, v117, v113, s13
    v_perm_b32 v143, v125, v121, s13
    ds_write_b128 v14, v[140:143] offset:48
    v_perm_b32 v144, v102, v98, s12
    v_perm_b32 v145, v110, v106, s12
    v_perm_b32 v146, v118, v114, s12
    v_perm_b32 v147, v126, v122, s12
    ds_write_b128 v14, v[144:147] offset:64
    v_perm_b32 v148, v102, v98, s13
    v_perm_b32 v149, v110, v106, s13
    v_perm_b32 v150, v118, v114, s13
    v_perm_b32 v151, v126, v122, s13
    ds_write_b128 v14, v[148:151] offset:80
    v_perm_b32 v152, v103, v99, s12
    v_perm_b32 v153, v111, v107, s12
    v_perm_b32 v154, v119, v115, s12
    v_perm_b32 v155, v127, v123, s12
    ds_write_b128 v14, v[152:155] offset:96
    v_perm_b32 v156, v103, v99, s13
    v_perm_b32 v157, v111, v107, s13
    v_perm_b32 v158, v119, v115, s13
    v_perm_b32 v159, v127, v123, s13
    ds_write_b128 v14, v[156:159] offset:112
    s_waitcnt lgkmcnt(0)
    ds_read_b128 v[96:99], v18 offset:0
    ds_read_b128 v[100:103], v18 offset:1040
    ds_read_b128 v[104:107], v18 offset:2080
    ds_read_b128 v[108:111], v18 offset:3120
    ds_read_b128 v[112:115], v18 offset:4160
    ds_read_b128 v[116:119], v18 offset:5200
    ds_read_b128 v[120:123], v18 offset:6240
    ds_read_b128 v[124:127], v18 offset:7280
    s_waitcnt lgkmcnt(0)
    s_add_u32 s9, s10, 0
    buffer_store_dwordx4 v[96:99], v15, s[44:47], s9 offen sc1
    s_add_u32 s9, s10, 1024
    buffer_store_dwordx4 v[100:103], v15, s[44:47], s9 offen sc1
    s_add_u32 s9, s10, 55296
    buffer_store_dwordx4 v[104:107], v15, s[44:47], s9 offen sc1
    s_add_u32 s9, s10, 56320
    buffer_store_dwordx4 v[108:111], v15, s[44:47], s9 offen sc1
    s_add_u32 s9, s10, 110592
    buffer_store_dwordx4 v[112:115], v15, s[44:47], s9 offen sc1
    s_add_u32 s9, s10, 111616
    buffer_store_dwordx4 v[116:119], v15, s[44:47], s9 offen sc1
    s_add_u32 s9, s10, 165888
    buffer_store_dwordx4 v[120:123], v15, s[44:47], s9 offen sc1
    s_add_u32 s9, s10, 166912
    buffer_store_dwordx4 v[124:127], v15, s[44:47], s9 offen sc1
    s_endpgm
k1_n2:
    s_mov_b32 s40, s16
    s_mov_b32 s41, s17
    s_mov_b32 s42, 0x280000
    s_mov_b32 s43, 0x00020000
    s_add_u32 s44, s38, 0x2000000
    s_addc_u32 s45, s39, 0
    s_mov_b32 s46, 0x280000
    s_mov_b32 s47, 0x00020000
    s_add_u32 s48, s38, 0xc00000
    s_addc_u32 s49, s39, 0
    s_mov_b32 s50, 0x20000
    s_mov_b32 s51, 0x00020000
    s_sub_u32 s4, s2, 210
    s_lshl_b32 s4, s4, 2
    s_add_u32 s4, s4, s3
    v_and_b32 v9, 15, v2
    v_lshrrev_b32 v10, 4, v2
    s_lshl_b32 s5, s4, 4
    v_add_u32 v11, s5, v9
    v_mul_u32_u24 v3, 1280, v11
    v_lshl_add_u32 v3, v10, 4, v3
    buffer_load_dwordx4 v[16:19], v3, s[40:43], 0 offen offset:0
    buffer_load_dwordx4 v[20:23], v3, s[40:43], 0 offen offset:64
    buffer_load_dwordx4 v[24:27], v3, s[40:43], 0 offen offset:128
    buffer_load_dwordx4 v[28:31], v3, s[40:43], 0 offen offset:192
    buffer_load_dwordx4 v[32:35], v3, s[40:43], 0 offen offset:256
    buffer_load_dwordx4 v[36:39], v3, s[40:43], 0 offen offset:320
    buffer_load_dwordx4 v[40:43], v3, s[40:43], 0 offen offset:384
    buffer_load_dwordx4 v[44:47], v3, s[40:43], 0 offen offset:448
    buffer_load_dwordx4 v[48:51], v3, s[40:43], 0 offen offset:512
    buffer_load_dwordx4 v[52:55], v3, s[40:43], 0 offen offset:576
    buffer_load_dwordx4 v[56:59], v3, s[40:43], 0 offen offset:640
    buffer_load_dwordx4 v[60:63], v3, s[40:43], 0 offen offset:704
    buffer_load_dwordx4 v[64:67], v3, s[40:43], 0 offen offset:768
    buffer_load_dwordx4 v[68:71], v3, s[40:43], 0 offen offset:832
    buffer_load_dwordx4 v[72:75], v3, s[40:43], 0 offen offset:896
    buffer_load_dwordx4 v[76:79], v3, s[40:43], 0 offen offset:960
    buffer_load_dwordx4 v[80:83], v3, s[40:43], 0 offen offset:1024
    buffer_load_dwordx4 v[84:87], v3, s[40:43], 0 offen offset:1088
    buffer_load_dwordx4 v[88:91], v3, s[40:43], 0 offen offset:1152
    buffer_load_dwordx4 v[92:95], v3, s[40:43], 0 offen offset:1216
    s_mul_i32 s6, s4, 20480
    v_lshlrev_b32 v4, 4, v2
    v_add_u32 v4, s6, v4
    v_lshlrev_b32 v5, 6, v11
    v_lshl_add_u32 v5, v10, 4, v5
    s_mov_b32 s92, 0xffff0000
    s_mov_b32 s7, 0x3c4ccccd
    s_mov_b32 s70, 0
    s_mov_b32 s71, 4096
    s_mov_b32 s72, 8192
    s_mov_b32 s73, 12288
    s_mov_b32 s74, 16384
    s_waitcnt vmcnt(19)
    buffer_store_dwordx4 v[16:19], v4, s[44:47], s70 offen offset:0 sc1
    s_waitcnt vmcnt(19)
    buffer_store_dwordx4 v[20:23], v4, s[44:47], s70 offen offset:1024 sc1
    s_waitcnt vmcnt(19)
    buffer_store_dwordx4 v[24:27], v4, s[44:47], s70 offen offset:2048 sc1
    s_waitcnt vmcnt(19)
    buffer_store_dwordx4 v[28:31], v4, s[44:47], s70 offen offset:3072 sc1
    s_waitcnt vmcnt(19)
    buffer_store_dwordx4 v[32:35], v4, s[44:47], s71 offen offset:0 sc1
    s_waitcnt vmcnt(19)
    buffer_store_dwordx4 v[36:39], v4, s[44:47], s71 offen offset:1024 sc1
    s_waitcnt vmcnt(19)
    buffer_store_dwordx4 v[40:43], v4, s[44:47], s71 offen offset:2048 sc1
    s_waitcnt vmcnt(19)
    buffer_store_dwordx4 v[44:47], v4, s[44:47], s71 offen offset:3072 sc1
    s_waitcnt vmcnt(19)
    buffer_store_dwordx4 v[48:51], v4, s[44:47], s72 offen offset:0 sc1
    s_waitcnt vmcnt(19)
    buffer_store_dwordx4 v[52:55], v4, s[44:47], s72 offen offset:1024 sc1
    s_waitcnt vmcnt(19)
    buffer_store_dwordx4 v[56:59], v4, s[44:47], s72 offen offset:2048 sc1
    s_waitcnt vmcnt(19)
    buffer_store_dwordx4 v[60:63], v4, s[44:47], s72 offen offset:3072 sc1
    s_waitcnt vmcnt(19)
    buffer_store_dwordx4 v[64:67], v4, s[44:47], s73 offen offset:0 sc1
    s_waitcnt vmcnt(19)
    buffer_store_dwordx4 v[68:71], v4, s[44:47], s73 offen offset:1024 sc1
    s_waitcnt vmcnt(19)
    buffer_store_dwordx4 v[72:75], v4, s[44:47], s73 offen offset:2048 sc1
    s_waitcnt vmcnt(19)
    buffer_store_dwordx4 v[76:79], v4, s[44:47], s73 offen offset:3072 sc1
    s_waitcnt vmcnt(19)
    buffer_store_dwordx4 v[80:83], v4, s[44:47], s74 offen offset:0 sc1
    s_waitcnt vmcnt(19)
    buffer_store_dwordx4 v[84:87], v4, s[44:47], s74 offen offset:1024 sc1
    s_waitcnt vmcnt(19)
    buffer_store_dwordx4 v[88:91], v4, s[44:47], s74 offen offset:2048 sc1
    s_waitcnt vmcnt(19)
    buffer_store_dwordx4 v[92:95], v4, s[44:47], s74 offen offset:3072 sc1
    v_mov_b32 v6, 0x3f803f80
    v_mov_b32 v96, 0
    v_mov_b32 v97, 0
    v_mov_b32 v98, 0
    v_mov_b32 v99, 0
    v_mov_b32 v100, 0
    v_mov_b32 v101, 0
    v_mov_b32 v102, 0
    v_mov_b32 v103, 0
    v_dot2_f32_bf16 v96, v16, v6, v96
    v_dot2_f32_bf16 v100, v16, v16, v100
    v_dot2_f32_bf16 v97, v17, v6, v97
    v_dot2_f32_bf16 v101, v17, v17, v101
    v_dot2_f32_bf16 v98, v18, v6, v98
    v_dot2_f32_bf16 v102, v18, v18, v102
    v_dot2_f32_bf16 v99, v19, v6, v99
    v_dot2_f32_bf16 v103, v19, v19, v103
    v_dot2_f32_bf16 v96, v20, v6, v96
    v_dot2_f32_bf16 v100, v20, v20, v100
    v_dot2_f32_bf16 v97, v21, v6, v97
    v_dot2_f32_bf16 v101, v21, v21, v101
    v_dot2_f32_bf16 v98, v22, v6, v98
    v_dot2_f32_bf16 v102, v22, v22, v102
    v_dot2_f32_bf16 v99, v23, v6, v99
    v_dot2_f32_bf16 v103, v23, v23, v103
    v_dot2_f32_bf16 v96, v24, v6, v96
    v_dot2_f32_bf16 v100, v24, v24, v100
    v_dot2_f32_bf16 v97, v25, v6, v97
    v_dot2_f32_bf16 v101, v25, v25, v101
    v_dot2_f32_bf16 v98, v26, v6, v98
    v_dot2_f32_bf16 v102, v26, v26, v102
    v_dot2_f32_bf16 v99, v27, v6, v99
    v_dot2_f32_bf16 v103, v27, v27, v103
    v_dot2_f32_bf16 v96, v28, v6, v96
    v_dot2_f32_bf16 v100, v28, v28, v100
    v_dot2_f32_bf16 v97, v29, v6, v97
    v_dot2_f32_bf16 v101, v29, v29, v101
    v_dot2_f32_bf16 v98, v30, v6, v98
    v_dot2_f32_bf16 v102, v30, v30, v102
    v_dot2_f32_bf16 v99, v31, v6, v99
    v_dot2_f32_bf16 v103, v31, v31, v103
    v_dot2_f32_bf16 v96, v32, v6, v96
    v_dot2_f32_bf16 v100, v32, v32, v100
    v_dot2_f32_bf16 v97, v33, v6, v97
    v_dot2_f32_bf16 v101, v33, v33, v101
    v_dot2_f32_bf16 v98, v34, v6, v98
    v_dot2_f32_bf16 v102, v34, v34, v102
    v_dot2_f32_bf16 v99, v35, v6, v99
    v_dot2_f32_bf16 v103, v35, v35, v103
    v_dot2_f32_bf16 v96, v36, v6, v96
    v_dot2_f32_bf16 v100, v36, v36, v100
    v_dot2_f32_bf16 v97, v37, v6, v97
    v_dot2_f32_bf16 v101, v37, v37, v101
    v_dot2_f32_bf16 v98, v38, v6, v98
    v_dot2_f32_bf16 v102, v38, v38, v102
    v_dot2_f32_bf16 v99, v39, v6, v99
    v_dot2_f32_bf16 v103, v39, v39, v103
    v_dot2_f32_bf16 v96, v40, v6, v96
    v_dot2_f32_bf16 v100, v40, v40, v100
    v_dot2_f32_bf16 v97, v41, v6, v97
    v_dot2_f32_bf16 v101, v41, v41, v101
    v_dot2_f32_bf16 v98, v42, v6, v98
    v_dot2_f32_bf16 v102, v42, v42, v102
    v_dot2_f32_bf16 v99, v43, v6, v99
    v_dot2_f32_bf16 v103, v43, v43, v103
    v_dot2_f32_bf16 v96, v44, v6, v96
    v_dot2_f32_bf16 v100, v44, v44, v100
    v_dot2_f32_bf16 v97, v45, v6, v97
    v_dot2_f32_bf16 v101, v45, v45, v101
    v_dot2_f32_bf16 v98, v46, v6, v98
    v_dot2_f32_bf16 v102, v46, v46, v102
    v_dot2_f32_bf16 v99, v47, v6, v99
    v_dot2_f32_bf16 v103, v47, v47, v103
    v_dot2_f32_bf16 v96, v48, v6, v96
    v_dot2_f32_bf16 v100, v48, v48, v100
    v_dot2_f32_bf16 v97, v49, v6, v97
    v_dot2_f32_bf16 v101, v49, v49, v101
    v_dot2_f32_bf16 v98, v50, v6, v98
    v_dot2_f32_bf16 v102, v50, v50, v102
    v_dot2_f32_bf16 v99, v51, v6, v99
    v_dot2_f32_bf16 v103, v51, v51, v103
    v_dot2_f32_bf16 v96, v52, v6, v96
    v_dot2_f32_bf16 v100, v52, v52, v100
    v_dot2_f32_bf16 v97, v53, v6, v97
    v_dot2_f32_bf16 v101, v53, v53, v101
    v_dot2_f32_bf16 v98, v54, v6, v98
    v_dot2_f32_bf16 v102, v54, v54, v102
    v_dot2_f32_bf16 v99, v55, v6, v99
    v_dot2_f32_bf16 v103, v55, v55, v103
    s_nop 4
    v_add_f32 v96, v96, v97
    v_add_f32 v98, v98, v99
    v_add_f32 v100, v100, v101
    v_add_f32 v102, v102, v103
    v_add_f32 v180, v96, v98
    v_add_f32 v100, v100, v102
    v_mul_f32 v97, s7, v180
    v_fma_f32 v181, -v97, v180, v100
    v_max_f32 v181, 0, v181
    v_mov_b32 v96, 0
    v_mov_b32 v97, 0
    v_mov_b32 v98, 0
    v_mov_b32 v99, 0
    v_mov_b32 v100, 0
    v_mov_b32 v101, 0
    v_mov_b32 v102, 0
    v_mov_b32 v103, 0
    v_dot2_f32_bf16 v96, v56, v6, v96
    v_dot2_f32_bf16 v100, v56, v56, v100
    v_dot2_f32_bf16 v97, v57, v6, v97
    v_dot2_f32_bf16 v101, v57, v57, v101
    v_dot2_f32_bf16 v98, v58, v6, v98
    v_dot2_f32_bf16 v102, v58, v58, v102
    v_dot2_f32_bf16 v99, v59, v6, v99
    v_dot2_f32_bf16 v103, v59, v59, v103
    v_dot2_f32_bf16 v96, v60, v6, v96
    v_dot2_f32_bf16 v100, v60, v60, v100
    v_dot2_f32_bf16 v97, v61, v6, v97
    v_dot2_f32_bf16 v101, v61, v61, v101
    v_dot2_f32_bf16 v98, v62, v6, v98
    v_dot2_f32_bf16 v102, v62, v62, v102
    v_dot2_f32_bf16 v99, v63, v6, v99
    v_dot2_f32_bf16 v103, v63, v63, v103
    v_dot2_f32_bf16 v96, v64, v6, v96
    v_dot2_f32_bf16 v100, v64, v64, v100
    v_dot2_f32_bf16 v97, v65, v6, v97
    v_dot2_f32_bf16 v101, v65, v65, v101
    v_dot2_f32_bf16 v98, v66, v6, v98
    v_dot2_f32_bf16 v102, v66, v66, v102
    v_dot2_f32_bf16 v99, v67, v6, v99
    v_dot2_f32_bf16 v103, v67, v67, v103
    v_dot2_f32_bf16 v96, v68, v6, v96
    v_dot2_f32_bf16 v100, v68, v68, v100
    v_dot2_f32_bf16 v97, v69, v6, v97
    v_dot2_f32_bf16 v101, v69, v69, v101
    v_dot2_f32_bf16 v98, v70, v6, v98
    v_dot2_f32_bf16 v102, v70, v70, v102
    v_dot2_f32_bf16 v99, v71, v6, v99
    v_dot2_f32_bf16 v103, v71, v71, v103
    v_dot2_f32_bf16 v96, v72, v6, v96
    v_dot2_f32_bf16 v100, v72, v72, v100
    v_dot2_f32_bf16 v97, v73, v6, v97
    v_dot2_f32_bf16 v101, v73, v73, v101
    v_dot2_f32_bf16 v98, v74, v6, v98
    v_dot2_f32_bf16 v102, v74, v74, v102
    v_dot2_f32_bf16 v99, v75, v6, v99
    v_dot2_f32_bf16 v103, v75, v75, v103
    v_dot2_f32_bf16 v96, v76, v6, v96
    v_dot2_f32_bf16 v100, v76, v76, v100
    v_dot2_f32_bf16 v97, v77, v6, v97
    v_dot2_f32_bf16 v101, v77, v77, v101
    v_dot2_f32_bf16 v98, v78, v6, v98
    v_dot2_f32_bf16 v102, v78, v78, v102
    v_dot2_f32_bf16 v99, v79, v6, v99
    v_dot2_f32_bf16 v103, v79, v79, v103
    v_dot2_f32_bf16 v96, v80, v6, v96
    v_dot2_f32_bf16 v100, v80, v80, v100
    v_dot2_f32_bf16 v97, v81, v6, v97
    v_dot2_f32_bf16 v101, v81, v81, v101
    v_dot2_f32_bf16 v98, v82, v6, v98
    v_dot2_f32_bf16 v102, v82, v82, v102
    v_dot2_f32_bf16 v99, v83, v6, v99
    v_dot2_f32_bf16 v103, v83, v83, v103
    v_dot2_f32_bf16 v96, v84, v6, v96
    v_dot2_f32_bf16 v100, v84, v84, v100
    v_dot2_f32_bf16 v97, v85, v6, v97
    v_dot2_f32_bf16 v101, v85, v85, v101
    v_dot2_f32_bf16 v98, v86, v6, v98
    v_dot2_f32_bf16 v102, v86, v86, v102
    v_dot2_f32_bf16 v99, v87, v6, v99
    v_dot2_f32_bf16 v103, v87, v87, v103
    v_dot2_f32_bf16 v96, v88, v6, v96
    v_dot2_f32_bf16 v100, v88, v88, v100
    v_dot2_f32_bf16 v97, v89, v6, v97
    v_dot2_f32_bf16 v101, v89, v89, v101
    v_dot2_f32_bf16 v98, v90, v6, v98
    v_dot2_f32_bf16 v102, v90, v90, v102
    v_dot2_f32_bf16 v99, v91, v6, v99
    v_dot2_f32_bf16 v103, v91, v91, v103
    v_dot2_f32_bf16 v96, v92, v6, v96
    v_dot2_f32_bf16 v100, v92, v92, v100
    v_dot2_f32_bf16 v97, v93, v6, v97
    v_dot2_f32_bf16 v101, v93, v93, v101
    v_dot2_f32_bf16 v98, v94, v6, v98
    v_dot2_f32_bf16 v102, v94, v94, v102
    v_dot2_f32_bf16 v99, v95, v6, v99
    v_dot2_f32_bf16 v103, v95, v95, v103
    s_nop 4
    v_add_f32 v96, v96, v97
    v_add_f32 v98, v98, v99
    v_add_f32 v100, v100, v101
    v_add_f32 v102, v102, v103
    v_add_f32 v182, v96, v98
    v_add_f32 v100, v100, v102
    v_mul_f32 v97, s7, v182
    v_fma_f32 v183, -v97, v182, v100
    v_max_f32 v183, 0, v183
    buffer_store_dwordx4 v[180:183], v5, s[48:51], 0 offen sc1
    s_endpgm
k1_exit:
    s_endpgm
.p2align 8
.globl g1b_kernel
.type g1b_kernel,@function
g1b_kernel:
    s_mov_b32 s94, 1
    s_branch g1_body
.p2align 8
.globl g1a_kernel
.type g1a_kernel,@function
g1a_kernel:
    s_mov_b32 s94, 0
g1_body:
    s_cmp_ge_u32 s2, 256
    s_cbranch_scc1 g1_exit
    s_load_dwordx16 s[16:31], s[0:1], 0
    s_load_dwordx8 s[32:39], s[0:1], 64
    v_lshrrev_b32 v1, 6, v0
    v_and_b32 v2, 63, v0
    v_readfirstlane_b32 s3, v1
    s_lshr_b32 s82, s3, 2
    s_and_b32 s3, s3, 3
    s_and_b32 s4, s2, 7
    s_lshr_b32 s5, s2, 3
    s_lshr_b32 s6, s4, 1
    s_lshl_b32 s6, s6, 3
    s_and_b32 s7, s5, 7
    s_add_u32 s6, s6, s7
    s_and_b32 s7, s4, 1
    s_lshl_b32 s7, s7, 2
    s_lshr_b32 s8, s5, 3
    s_add_u32 s7, s7, s8
    v_and_b32 v6, 15, v2
    v_lshrrev_b32 v7, 4, v2
    v_lshlrev_b32 v4, 4, v2
    s_mov_b32 s70, 0
    s_mov_b32 s71, 4096
    s_mov_b32 s72, 8192
    s_mov_b32 s73, 12288
    s_mov_b32 s74, 16384
    s_mov_b32 s75, 20480
    s_mov_b32 s92, 0xffff0000
    s_cmp_eq_u32 s82, 1
    s_cbranch_scc1 g1_prod
    s_mul_i32 s8, s7, 14
    s_min_u32 s8, s8, 94
    s_lshl_b32 s9, s3, 2
    s_add_u32 s8, s8, s9
    v_add_u32 v13, 0xa000, v4
    s_mul_i32 s13, s8, 20480
    v_add_u32 v9, s13, v4
    v_add_u32 v10, 0x5000, v9
    v_add_u32 v11, 0xa000, v9
    v_add_u32 v12, 0xf000, v9
    s_lshl_b32 s83, s8, 6
    v_lshlrev_b32 v15, 4, v7
    s_waitcnt lgkmcnt(0)
    s_add_u32 s52, s38, 0x1000000
    s_addc_u32 s53, s39, 0
    s_mov_b32 s54, 0x21c000
    s_mov_b32 s55, 0x00020000
    s_cmp_eq_u32 s3, 3
    s_cbranch_scc1 g1_w3
    buffer_load_dwordx4 a[64:67], v9, s[52:55], s70 offen offset:0
    buffer_load_dwordx4 a[68:71], v10, s[52:55], s70 offen offset:0
    buffer_load_dwordx4 a[72:75], v11, s[52:55], s70 offen offset:0
    buffer_load_dwordx4 a[76:79], v12, s[52:55], s70 offen offset:0
    v_accvgpr_write_b32 a0, 0
    v_accvgpr_write_b32 a1, 0
    v_accvgpr_write_b32 a2, 0
    v_accvgpr_write_b32 a3, 0
    v_accvgpr_write_b32 a4, 0
    v_accvgpr_write_b32 a5, 0
    v_accvgpr_write_b32 a6, 0
    v_accvgpr_write_b32 a7, 0
    v_accvgpr_write_b32 a8, 0
    v_accvgpr_write_b32 a9, 0
    v_accvgpr_write_b32 a10, 0
    v_accvgpr_write_b32 a11, 0
    v_accvgpr_write_b32 a12, 0
    v_accvgpr_write_b32 a13, 0
    v_accvgpr_write_b32 a14, 0
    v_accvgpr_write_b32 a15, 0
    v_accvgpr_write_b32 a16, 0
    v_accvgpr_write_b32 a17, 0
    v_accvgpr_write_b32 a18, 0
    v_accvgpr_write_b32 a19, 0
    v_accvgpr_write_b32 a20, 0
    v_accvgpr_write_b32 a21, 0
    v_accvgpr_write_b32 a22, 0
    v_accvgpr_write_b32 a23, 0
    v_accvgpr_write_b32 a24, 0
    v_accvgpr_write_b32 a25, 0
    v_accvgpr_write_b32 a26, 0
    v_accvgpr_write_b32 a27, 0
    v_accvgpr_write_b32 a28, 0
    v_accvgpr_write_b32 a29, 0
    v_accvgpr_write_b32 a30, 0
    v_accvgpr_write_b32 a31, 0
    v_accvgpr_write_b32 a32, 0
    v_accvgpr_write_b32 a33, 0
    v_accvgpr_write_b32 a34, 0
    v_accvgpr_write_b32 a35, 0
    v_accvgpr_write_b32 a36, 0
    v_accvgpr_write_b32 a37, 0
    v_accvgpr_write_b32 a38, 0
    v_accvgpr_write_b32 a39, 0
    v_accvgpr_write_b32 a40, 0
    v_accvgpr_write_b32 a41, 0
    v_accvgpr_write_b32 a42, 0
    v_accvgpr_write_b32 a43, 0
    v_accvgpr_write_b32 a44, 0
    v_accvgpr_write_b32 a45, 0
    v_accvgpr_write_b32 a46, 0
    v_accvgpr_write_b32 a47, 0
    v_accvgpr_write_b32 a48, 0
    v_accvgpr_write_b32 a49, 0
    v_accvgpr_write_b32 a50, 0
    v_accvgpr_write_b32 a51, 0
    v_accvgpr_write_b32 a52, 0
    v_accvgpr_write_b32 a53, 0
    v_accvgpr_write_b32 a54, 0
    v_accvgpr_write_b32 a55, 0
    v_accvgpr_write_b32 a56, 0
    v_accvgpr_write_b32 a57, 0
    v_accvgpr_write_b32 a58, 0
    v_accvgpr_write_b32 a59, 0
    v_accvgpr_write_b32 a60, 0
    v_accvgpr_write_b32 a61, 0
    v_accvgpr_write_b32 a62, 0
    v_accvgpr_write_b32 a63, 0
    s_barrier
    buffer_load_dwordx4 a[80:83], v9, s[52:55], s70 offen offset:1024
    buffer_load_dwordx4 a[84:87], v10, s[52:55], s70 offen offset:1024
    buffer_load_dwordx4 a[88:91], v11, s[52:55], s70 offen offset:1024
    buffer_load_dwordx4 a[92:95], v12, s[52:55], s70 offen offset:1024
    buffer_load_dwordx4 a[96:99], v9, s[52:55], s70 offen offset:2048
    buffer_load_dwordx4 a[100:103], v10, s[52:55], s70 offen offset:2048
    buffer_load_dwordx4 a[104:107], v11, s[52:55], s70 offen offset:2048
    buffer_load_dwordx4 a[108:111], v12, s[52:55], s70 offen offset:2048
    buffer_load_dwordx4 a[112:115], v9, s[52:55], s70 offen offset:3072
    buffer_load_dwordx4 a[116:119], v10, s[52:55], s70 offen offset:3072
    buffer_load_dwordx4 a[120:123], v11, s[52:55], s70 offen offset:3072
    buffer_load_dwordx4 a[124:127], v12, s[52:55], s70 offen offset:3072
    buffer_load_dwordx4 a[128:131], v9, s[52:55], s71 offen offset:0
    buffer_load_dwordx4 a[132:135], v10, s[52:55], s71 offen offset:0
    buffer_load_dwordx4 a[136:139], v11, s[52:55], s71 offen offset:0
    buffer_load_dwordx4 a[140:143], v12, s[52:55], s71 offen offset:0
    buffer_load_dwordx4 a[144:147], v9, s[52:55], s71 offen offset:1024
    buffer_load_dwordx4 a[148:151], v10, s[52:55], s71 offen offset:1024
    s_add_u32 s64, s38, 0xc90000
    s_addc_u32 s65, s39, 0
    s_mov_b32 s66, 0x1b00
    s_mov_b32 s67, 0x00020000
    buffer_load_dwordx4 v[16:19], v15, s[64:67], s83 offen offset:0
    buffer_load_dwordx4 v[20:23], v15, s[64:67], s83 offen offset:64
    buffer_load_dwordx4 v[24:27], v15, s[64:67], s83 offen offset:128
    buffer_load_dwordx4 v[28:31], v15, s[64:67], s83 offen offset:192
    s_add_u32 s60, s38, 0x1800000
    s_addc_u32 s61, s39, 0
    s_mov_b32 s62, 0x6c0000
    s_mov_b32 s63, 0x00020000
    s_mov_b32 s93, 0xbfb8aa3b
    v_lshlrev_b32 v14, 3, v6
    v_add_u32 v14, 81920, v14
    s_lshl_b32 s14, s6, 2
    s_mul_i32 s14, s14, 54
    s_lshr_b32 s15, s8, 1
    s_add_u32 s14, s14, s15
    s_lshl_b32 s14, s14, 10
    s_barrier
    ds_read_b128 v[32:35], v4 offset:0
    ds_read_b128 v[36:39], v4 offset:1024
    ds_read_b128 v[40:43], v4 offset:2048
    ds_read_b128 v[44:47], v4 offset:3072
    ds_read_b128 v[48:51], v4 offset:4096
    ds_read_b128 v[52:55], v4 offset:5120
    ds_read_b128 v[56:59], v4 offset:6144
    ds_read_b128 v[60:63], v4 offset:7168
    s_waitcnt lgkmcnt(4)
    s_waitcnt vmcnt(25)
    v_mfma_f32_16x16x32_bf16 a[0:3], a[64:67], v[32:35], a[0:3]
    v_mfma_f32_16x16x32_bf16 a[4:7], a[64:67], v[36:39], a[4:7]
    v_mfma_f32_16x16x32_bf16 a[8:11], a[64:67], v[40:43], a[8:11]
    v_mfma_f32_16x16x32_bf16 a[12:15], a[64:67], v[44:47], a[12:15]
    buffer_load_dwordx4 a[64:67], v11, s[52:55], s71 offen offset:1024
    s_waitcnt vmcnt(25)
    v_mfma_f32_16x16x32_bf16 a[16:19], a[68:71], v[32:35], a[16:19]
    v_mfma_f32_16x16x32_bf16 a[20:23], a[68:71], v[36:39], a[20:23]
    v_mfma_f32_16x16x32_bf16 a[24:27], a[68:71], v[40:43], a[24:27]
    v_mfma_f32_16x16x32_bf16 a[28:31], a[68:71], v[44:47], a[28:31]
    buffer_load_dwordx4 a[68:71], v12, s[52:55], s71 offen offset:1024
    s_waitcnt vmcnt(25)
    v_mfma_f32_16x16x32_bf16 a[32:35], a[72:75], v[32:35], a[32:35]
    v_mfma_f32_16x16x32_bf16 a[36:39], a[72:75], v[36:39], a[36:39]
    v_mfma_f32_16x16x32_bf16 a[40:43], a[72:75], v[40:43], a[40:43]
    v_mfma_f32_16x16x32_bf16 a[44:47], a[72:75], v[44:47], a[44:47]
    buffer_load_dwordx4 a[72:75], v9, s[52:55], s71 offen offset:2048
    s_waitcnt vmcnt(25)
    v_mfma_f32_16x16x32_bf16 a[48:51], a[76:79], v[32:35], a[48:51]
    v_mfma_f32_16x16x32_bf16 a[52:55], a[76:79], v[36:39], a[52:55]
    v_mfma_f32_16x16x32_bf16 a[56:59], a[76:79], v[40:43], a[56:59]
    v_mfma_f32_16x16x32_bf16 a[60:63], a[76:79], v[44:47], a[60:63]
    buffer_load_dwordx4 a[76:79], v10, s[52:55], s71 offen offset:2048
    ds_read_b128 v[32:35], v4 offset:8192
    ds_read_b128 v[36:39], v4 offset:9216
    ds_read_b128 v[40:43], v4 offset:10240
    ds_read_b128 v[44:47], v4 offset:11264
    s_waitcnt lgkmcnt(4)
    s_waitcnt vmcnt(25)
    v_mfma_f32_16x16x32_bf16 a[0:3], a[80:83], v[48:51], a[0:3]
    v_mfma_f32_16x16x32_bf16 a[4:7], a[80:83], v[52:55], a[4:7]
    v_mfma_f32_16x16x32_bf16 a[8:11], a[80:83], v[56:59], a[8:11]
    v_mfma_f32_16x16x32_bf16 a[12:15], a[80:83], v[60:63], a[12:15]
    buffer_load_dwordx4 a[80:83], v11, s[52:55], s71 offen offset:2048
    s_waitcnt vmcnt(25)
    v_mfma_f32_16x16x32_bf16 a[16:19], a[84:87], v[48:51], a[16:19]
    v_mfma_f32_16x16x32_bf16 a[20:23], a[84:87], v[52:55], a[20:23]
    v_mfma_f32_16x16x32_bf16 a[24:27], a[84:87], v[56:59], a[24:27]
    v_mfma_f32_16x16x32_bf16 a[28:31], a[84:87], v[60:63], a[28:31]
    buffer_load_dwordx4 a[84:87], v12, s[52:55], s71 offen offset:2048
    s_waitcnt vmcnt(25)
    v_mfma_f32_16x16x32_bf16 a[32:35], a[88:91], v[48:51], a[32:35]
    v_mfma_f32_16x16x32_bf16 a[36:39], a[88:91], v[52:55], a[36:39]
    v_mfma_f32_16x16x32_bf16 a[40:43], a[88:91], v[56:59], a[40:43]
    v_mfma_f32_16x16x32_bf16 a[44:47], a[88:91], v[60:63], a[44:47]
    buffer_load_dwordx4 a[88:91], v9, s[52:55], s71 offen offset:3072
    s_waitcnt vmcnt(25)
    v_mfma_f32_16x16x32_bf16 a[48:51], a[92:95], v[48:51], a[48:51]
    v_mfma_f32_16x16x32_bf16 a[52:55], a[92:95], v[52:55], a[52:55]
    v_mfma_f32_16x16x32_bf16 a[56:59], a[92:95], v[56:59], a[56:59]
    v_mfma_f32_16x16x32_bf16 a[60:63], a[92:95], v[60:63], a[60:63]
    buffer_load_dwordx4 a[92:95], v10, s[52:55], s71 offen offset:3072
    s_barrier
    ds_read_b128 v[48:51], v4 offset:12288
    ds_read_b128 v[52:55], v4 offset:13312
    ds_read_b128 v[56:59], v4 offset:14336
    ds_read_b128 v[60:63], v4 offset:15360
    s_waitcnt lgkmcnt(4)
    s_waitcnt vmcnt(25)
    v_mfma_f32_16x16x32_bf16 a[0:3], a[96:99], v[32:35], a[0:3]
    v_mfma_f32_16x16x32_bf16 a[4:7], a[96:99], v[36:39], a[4:7]
    v_mfma_f32_16x16x32_bf16 a[8:11], a[96:99], v[40:43], a[8:11]
    v_mfma_f32_16x16x32_bf16 a[12:15], a[96:99], v[44:47], a[12:15]
    buffer_load_dwordx4 a[96:99], v11, s[52:55], s71 offen offset:3072
    s_waitcnt vmcnt(25)
    v_mfma_f32_16x16x32_bf16 a[16:19], a[100:103], v[32:35], a[16:19]
    v_mfma_f32_16x16x32_bf16 a[20:23], a[100:103], v[36:39], a[20:23]
    v_mfma_f32_16x16x32_bf16 a[24:27], a[100:103], v[40:43], a[24:27]
    v_mfma_f32_16x16x32_bf16 a[28:31], a[100:103], v[44:47], a[28:31]
    buffer_load_dwordx4 a[100:103], v12, s[52:55], s71 offen offset:3072
    s_waitcnt vmcnt(25)
    v_mfma_f32_16x16x32_bf16 a[32:35], a[104:107], v[32:35], a[32:35]
    v_mfma_f32_16x16x32_bf16 a[36:39], a[104:107], v[36:39], a[36:39]
    v_mfma_f32_16x16x32_bf16 a[40:43], a[104:107], v[40:43], a[40:43]
    v_mfma_f32_16x16x32_bf16 a[44:47], a[104:107], v[44:47], a[44:47]
    buffer_load_dwordx4 a[104:107], v9, s[52:55], s72 offen offset:0
    s_waitcnt vmcnt(25)
    v_mfma_f32_16x16x32_bf16 a[48:51], a[108:111], v[32:35], a[48:51]
    v_mfma_f32_16x16x32_bf16 a[52:55], a[108:111], v[36:39], a[52:55]
    v_mfma_f32_16x16x32_bf16 a[56:59], a[108:111], v[40:43], a[56:59]
    v_mfma_f32_16x16x32_bf16 a[60:63], a[108:111], v[44:47], a[60:63]
    buffer_load_dwordx4 a[108:111], v10, s[52:55], s72 offen offset:0
    ds_read_b128 v[32:35], v4 offset:16384
    ds_read_b128 v[36:39], v4 offset:17408
    ds_read_b128 v[40:43], v4 offset:18432
    ds_read_b128 v[44:47], v4 offset:19456
    s_waitcnt lgkmcnt(4)
    s_waitcnt vmcnt(25)
    v_mfma_f32_16x16x32_bf16 a[0:3], a[112:115], v[48:51], a[0:3]
    v_mfma_f32_16x16x32_bf16 a[4:7], a[112:115], v[52:55], a[4:7]
    v_mfma_f32_16x16x32_bf16 a[8:11], a[112:115], v[56:59], a[8:11]
    v_mfma_f32_16x16x32_bf16 a[12:15], a[112:115], v[60:63], a[12:15]
    buffer_load_dwordx4 a[112:115], v11, s[52:55], s72 offen offset:0
    s_waitcnt vmcnt(25)
    v_mfma_f32_16x16x32_bf16 a[16:19], a[116:119], v[48:51], a[16:19]
    v_mfma_f32_16x16x32_bf16 a[20:23], a[116:119], v[52:55], a[20:23]
    v_mfma_f32_16x16x32_bf16 a[24:27], a[116:119], v[56:59], a[24:27]
    v_mfma_f32_16x16x32_bf16 a[28:31], a[116:119], v[60:63], a[28:31]
    buffer_load_dwordx4 a[116:119], v12, s[52:55], s72 offen offset:0
    s_waitcnt vmcnt(25)
    v_mfma_f32_16x16x32_bf16 a[32:35], a[120:123], v[48:51], a[32:35]
    v_mfma_f32_16x16x32_bf16 a[36:39], a[120:123], v[52:55], a[36:39]
    v_mfma_f32_16x16x32_bf16 a[40:43], a[120:123], v[56:59], a[40:43]
    v_mfma_f32_16x16x32_bf16 a[44:47], a[120:123], v[60:63], a[44:47]
    buffer_load_dwordx4 a[120:123], v9, s[52:55], s72 offen offset:1024
    s_waitcnt vmcnt(25)
    v_mfma_f32_16x16x32_bf16 a[48:51], a[124:127], v[48:51], a[48:51]
    v_mfma_f32_16x16x32_bf16 a[52:55], a[124:127], v[52:55], a[52:55]
    v_mfma_f32_16x16x32_bf16 a[56:59], a[124:127], v[56:59], a[56:59]
    v_mfma_f32_16x16x32_bf16 a[60:63], a[124:127], v[60:63], a[60:63]
    buffer_load_dwordx4 a[124:127], v10, s[52:55], s72 offen offset:1024
    s_barrier
    ds_read_b128 v[48:51], v4 offset:20480
    ds_read_b128 v[52:55], v4 offset:21504
    ds_read_b128 v[56:59], v4 offset:22528
    ds_read_b128 v[60:63], v4 offset:23552
    s_waitcnt lgkmcnt(4)
    s_waitcnt vmcnt(25)
    v_mfma_f32_16x16x32_bf16 a[0:3], a[128:131], v[32:35], a[0:3]
    v_mfma_f32_16x16x32_bf16 a[4:7], a[128:131], v[36:39], a[4:7]
    v_mfma_f32_16x16x32_bf16 a[8:11], a[128:131], v[40:43], a[8:11]
    v_mfma_f32_16x16x32_bf16 a[12:15], a[128:131], v[44:47], a[12:15]
    buffer_load_dwordx4 a[128:131], v11, s[52:55], s72 offen offset:1024
    s_waitcnt vmcnt(25)
    v_mfma_f32_16x16x32_bf16 a[16:19], a[132:135], v[32:35], a[16:19]
    v_mfma_f32_16x16x32_bf16 a[20:23], a[132:135], v[36:39], a[20:23]
    v_mfma_f32_16x16x32_bf16 a[24:27], a[132:135], v[40:43], a[24:27]
    v_mfma_f32_16x16x32_bf16 a[28:31], a[132:135], v[44:47], a[28:31]
    buffer_load_dwordx4 a[132:135], v12, s[52:55], s72 offen offset:1024
    s_waitcnt vmcnt(25)
    v_mfma_f32_16x16x32_bf16 a[32:35], a[136:139], v[32:35], a[32:35]
    v_mfma_f32_16x16x32_bf16 a[36:39], a[136:139], v[36:39], a[36:39]
    v_mfma_f32_16x16x32_bf16 a[40:43], a[136:139], v[40:43], a[40:43]
    v_mfma_f32_16x16x32_bf16 a[44:47], a[136:139], v[44:47], a[44:47]
    buffer_load_dwordx4 a[136:139], v9, s[52:55], s72 offen offset:2048
    s_waitcnt vmcnt(25)
    v_mfma_f32_16x16x32_bf16 a[48:51], a[140:143], v[32:35], a[48:51]
    v_mfma_f32_16x16x32_bf16 a[52:55], a[140:143], v[36:39], a[52:55]
    v_mfma_f32_16x16x32_bf16 a[56:59], a[140:143], v[40:43], a[56:59]
    v_mfma_f32_16x16x32_bf16 a[60:63], a[140:143], v[44:47], a[60:63]
    buffer_load_dwordx4 a[140:143], v10, s[52:55], s72 offen offset:2048
    ds_read_b128 v[32:35], v4 offset:24576
    ds_read_b128 v[36:39], v4 offset:25600
    ds_read_b128 v[40:43], v4 offset:26624
    ds_read_b128 v[44:47], v4 offset:27648
    s_waitcnt lgkmcnt(4)
    s_waitcnt vmcnt(25)
    v_mfma_f32_16x16x32_bf16 a[0:3], a[144:147], v[48:51], a[0:3]
    v_mfma_f32_16x16x32_bf16 a[4:7], a[144:147], v[52:55], a[4:7]
    v_mfma_f32_16x16x32_bf16 a[8:11], a[144:147], v[56:59], a[8:11]
    v_mfma_f32_16x16x32_bf16 a[12:15], a[144:147], v[60:63], a[12:15]
    buffer_load_dwordx4 a[144:147], v11, s[52:55], s72 offen offset:2048
    s_waitcnt vmcnt(25)
    v_mfma_f32_16x16x32_bf16 a[16:19], a[148:151], v[48:51], a[16:19]
    v_mfma_f32_16x16x32_bf16 a[20:23], a[148:151], v[52:55], a[20:23]
    v_mfma_f32_16x16x32_bf16 a[24:27], a[148:151], v[56:59], a[24:27]
    v_mfma_f32_16x16x32_bf16 a[28:31], a[148:151], v[60:63], a[28:31]
    buffer_load_dwordx4 a[148:151], v12, s[52:55], s72 offen offset:2048
    s_waitcnt vmcnt(21)
    v_mfma_f32_16x16x32_bf16 a[32:35], a[64:67], v[48:51], a[32:35]
    v_mfma_f32_16x16x32_bf16 a[36:39], a[64:67], v[52:55], a[36:39]
    v_mfma_f32_16x16x32_bf16 a[40:43], a[64:67], v[56:59], a[40:43]
    v_mfma_f32_16x16x32_bf16 a[44:47], a[64:67], v[60:63], a[44:47]
    buffer_load_dwordx4 a[64:67], v9, s[52:55], s72 offen offset:3072
    s_waitcnt vmcnt(21)
    v_mfma_f32_16x16x32_bf16 a[48:51], a[68:71], v[48:51], a[48:51]
    v_mfma_f32_16x16x32_bf16 a[52:55], a[68:71], v[52:55], a[52:55]
    v_mfma_f32_16x16x32_bf16 a[56:59], a[68:71], v[56:59], a[56:59]
    v_mfma_f32_16x16x32_bf16 a[60:63], a[68:71], v[60:63], a[60:63]
    buffer_load_dwordx4 a[68:71], v10, s[52:55], s72 offen offset:3072
    s_barrier
    ds_read_b128 v[48:51], v4 offset:28672
    ds_read_b128 v[52:55], v4 offset:29696
    ds_read_b128 v[56:59], v4 offset:30720
    ds_read_b128 v[60:63], v4 offset:31744
    s_waitcnt lgkmcnt(4)
    s_waitcnt vmcnt(21)
    v_mfma_f32_16x16x32_bf16 a[0:3], a[72:75], v[32:35], a[0:3]
    v_mfma_f32_16x16x32_bf16 a[4:7], a[72:75], v[36:39], a[4:7]
    v_mfma_f32_16x16x32_bf16 a[8:11], a[72:75], v[40:43], a[8:11]
    v_mfma_f32_16x16x32_bf16 a[12:15], a[72:75], v[44:47], a[12:15]
    buffer_load_dwordx4 a[72:75], v11, s[52:55], s72 offen offset:3072
    s_waitcnt vmcnt(21)
    v_mfma_f32_16x16x32_bf16 a[16:19], a[76:79], v[32:35], a[16:19]
    v_mfma_f32_16x16x32_bf16 a[20:23], a[76:79], v[36:39], a[20:23]
    v_mfma_f32_16x16x32_bf16 a[24:27], a[76:79], v[40:43], a[24:27]
    v_mfma_f32_16x16x32_bf16 a[28:31], a[76:79], v[44:47], a[28:31]
    buffer_load_dwordx4 a[76:79], v12, s[52:55], s72 offen offset:3072
    s_waitcnt vmcnt(21)
    v_mfma_f32_16x16x32_bf16 a[32:35], a[80:83], v[32:35], a[32:35]
    v_mfma_f32_16x16x32_bf16 a[36:39], a[80:83], v[36:39], a[36:39]
    v_mfma_f32_16x16x32_bf16 a[40:43], a[80:83], v[40:43], a[40:43]
    v_mfma_f32_16x16x32_bf16 a[44:47], a[80:83], v[44:47], a[44:47]
    buffer_load_dwordx4 a[80:83], v9, s[52:55], s73 offen offset:0
    s_waitcnt vmcnt(21)
    v_mfma_f32_16x16x32_bf16 a[48:51], a[84:87], v[32:35], a[48:51]
    v_mfma_f32_16x16x32_bf16 a[52:55], a[84:87], v[36:39], a[52:55]
    v_mfma_f32_16x16x32_bf16 a[56:59], a[84:87], v[40:43], a[56:59]
    v_mfma_f32_16x16x32_bf16 a[60:63], a[84:87], v[44:47], a[60:63]
    buffer_load_dwordx4 a[84:87], v10, s[52:55], s73 offen offset:0
    ds_read_b128 v[32:35], v4 offset:32768
    ds_read_b128 v[36:39], v4 offset:33792
    ds_read_b128 v[40:43], v4 offset:34816
    ds_read_b128 v[44:47], v4 offset:35840
    s_waitcnt lgkmcnt(4)
    s_waitcnt vmcnt(21)
    v_mfma_f32_16x16x32_bf16 a[0:3], a[88:91], v[48:51], a[0:3]
    v_mfma_f32_16x16x32_bf16 a[4:7], a[88:91], v[52:55], a[4:7]
    v_mfma_f32_16x16x32_bf16 a[8:11], a[88:91], v[56:59], a[8:11]
    v_mfma_f32_16x16x32_bf16 a[12:15], a[88:91], v[60:63], a[12:15]
    buffer_load_dwordx4 a[88:91], v11, s[52:55], s73 offen offset:0
    s_waitcnt vmcnt(21)
    v_mfma_f32_16x16x32_bf16 a[16:19], a[92:95], v[48:51], a[16:19]
    v_mfma_f32_16x16x32_bf16 a[20:23], a[92:95], v[52:55], a[20:23]
    v_mfma_f32_16x16x32_bf16 a[24:27], a[92:95], v[56:59], a[24:27]
    v_mfma_f32_16x16x32_bf16 a[28:31], a[92:95], v[60:63], a[28:31]
    buffer_load_dwordx4 a[92:95], v12, s[52:55], s73 offen offset:0
    s_waitcnt vmcnt(21)
    v_mfma_f32_16x16x32_bf16 a[32:35], a[96:99], v[48:51], a[32:35]
    v_mfma_f32_16x16x32_bf16 a[36:39], a[96:99], v[52:55], a[36:39]
    v_mfma_f32_16x16x32_bf16 a[40:43], a[96:99], v[56:59], a[40:43]
    v_mfma_f32_16x16x32_bf16 a[44:47], a[96:99], v[60:63], a[44:47]
    buffer_load_dwordx4 a[96:99], v9, s[52:55], s73 offen offset:1024
    s_waitcnt vmcnt(21)
    v_mfma_f32_16x16x32_bf16 a[48:51], a[100:103], v[48:51], a[48:51]
    v_mfma_f32_16x16x32_bf16 a[52:55], a[100:103], v[52:55], a[52:55]
    v_mfma_f32_16x16x32_bf16 a[56:59], a[100:103], v[56:59], a[56:59]
    v_mfma_f32_16x16x32_bf16 a[60:63], a[100:103], v[60:63], a[60:63]
    buffer_load_dwordx4 a[100:103], v10, s[52:55], s73 offen offset:1024
    s_barrier
    ds_read_b128 v[48:51], v4 offset:36864
    ds_read_b128 v[52:55], v4 offset:37888
    ds_read_b128 v[56:59], v4 offset:38912
    ds_read_b128 v[60:63], v4 offset:39936
    s_waitcnt lgkmcnt(4)
    s_waitcnt vmcnt(21)
    v_mfma_f32_16x16x32_bf16 a[0:3], a[104:107], v[32:35], a[0:3]
    v_mfma_f32_16x16x32_bf16 a[4:7], a[104:107], v[36:39], a[4:7]
    v_mfma_f32_16x16x32_bf16 a[8:11], a[104:107], v[40:43], a[8:11]
    v_mfma_f32_16x16x32_bf16 a[12:15], a[104:107], v[44:47], a[12:15]
    buffer_load_dwordx4 a[104:107], v11, s[52:55], s73 offen offset:1024
    s_waitcnt vmcnt(21)
    v_mfma_f32_16x16x32_bf16 a[16:19], a[108:111], v[32:35], a[16:19]
    v_mfma_f32_16x16x32_bf16 a[20:23], a[108:111], v[36:39], a[20:23]
    v_mfma_f32_16x16x32_bf16 a[24:27], a[108:111], v[40:43], a[24:27]
    v_mfma_f32_16x16x32_bf16 a[28:31], a[108:111], v[44:47], a[28:31]
    buffer_load_dwordx4 a[108:111], v12, s[52:55], s73 offen offset:1024
    s_waitcnt vmcnt(21)
    v_mfma_f32_16x16x32_bf16 a[32:35], a[112:115], v[32:35], a[32:35]
    v_mfma_f32_16x16x32_bf16 a[36:39], a[112:115], v[36:39], a[36:39]
    v_mfma_f32_16x16x32_bf16 a[40:43], a[112:115], v[40:43], a[40:43]
    v_mfma_f32_16x16x32_bf16 a[44:47], a[112:115], v[44:47], a[44:47]
    buffer_load_dwordx4 a[112:115], v9, s[52:55], s73 offen offset:2048
    s_waitcnt vmcnt(21)
    v_mfma_f32_16x16x32_bf16 a[48:51], a[116:119], v[32:35], a[48:51]
    v_mfma_f32_16x16x32_bf16 a[52:55], a[116:119], v[36:39], a[52:55]
    v_mfma_f32_16x16x32_bf16 a[56:59], a[116:119], v[40:43], a[56:59]
    v_mfma_f32_16x16x32_bf16 a[60:63], a[116:119], v[44:47], a[60:63]
    buffer_load_dwordx4 a[116:119], v10, s[52:55], s73 offen offset:2048
    ds_read_b128 v[32:35], v13 offset:0
    ds_read_b128 v[36:39], v13 offset:1024
    ds_read_b128 v[40:43], v13 offset:2048
    ds_read_b128 v[44:47], v13 offset:3072
    s_waitcnt lgkmcnt(4)
    s_waitcnt vmcnt(21)
    v_mfma_f32_16x16x32_bf16 a[0:3], a[120:123], v[48:51], a[0:3]
    v_mfma_f32_16x16x32_bf16 a[4:7], a[120:123], v[52:55], a[4:7]
    v_mfma_f32_16x16x32_bf16 a[8:11], a[120:123], v[56:59], a[8:11]
    v_mfma_f32_16x16x32_bf16 a[12:15], a[120:123], v[60:63], a[12:15]
    buffer_load_dwordx4 a[120:123], v11, s[52:55], s73 offen offset:2048
    s_waitcnt vmcnt(21)
    v_mfma_f32_16x16x32_bf16 a[16:19], a[124:127], v[48:51], a[16:19]
    v_mfma_f32_16x16x32_bf16 a[20:23], a[124:127], v[52:55], a[20:23]
    v_mfma_f32_16x16x32_bf16 a[24:27], a[124:127], v[56:59], a[24:27]
    v_mfma_f32_16x16x32_bf16 a[28:31], a[124:127], v[60:63], a[28:31]
    buffer_load_dwordx4 a[124:127], v12, s[52:55], s73 offen offset:2048
    s_waitcnt vmcnt(21)
    v_mfma_f32_16x16x32_bf16 a[32:35], a[128:131], v[48:51], a[32:35]
    v_mfma_f32_16x16x32_bf16 a[36:39], a[128:131], v[52:55], a[36:39]
    v_mfma_f32_16x16x32_bf16 a[40:43], a[128:131], v[56:59], a[40:43]
    v_mfma_f32_16x16x32_bf16 a[44:47], a[128:131], v[60:63], a[44:47]
    buffer_load_dwordx4 a[128:131], v9, s[52:55], s73 offen offset:3072
    s_waitcnt vmcnt(21)
    v_mfma_f32_16x16x32_bf16 a[48:51], a[132:135], v[48:51], a[48:51]
    v_mfma_f32_16x16x32_bf16 a[52:55], a[132:135], v[52:55], a[52:55]
    v_mfma_f32_16x16x32_bf16 a[56:59], a[132:135], v[56:59], a[56:59]
    v_mfma_f32_16x16x32_bf16 a[60:63], a[132:135], v[60:63], a[60:63]
    buffer_load_dwordx4 a[132:135], v10, s[52:55], s73 offen offset:3072
    s_barrier
    ds_read_b128 v[48:51], v13 offset:4096
    ds_read_b128 v[52:55], v13 offset:5120
    ds_read_b128 v[56:59], v13 offset:6144
    ds_read_b128 v[60:63], v13 offset:7168
    s_waitcnt lgkmcnt(4)
    s_waitcnt vmcnt(21)
    v_mfma_f32_16x16x32_bf16 a[0:3], a[136:139], v[32:35], a[0:3]
    v_mfma_f32_16x16x32_bf16 a[4:7], a[136:139], v[36:39], a[4:7]
    v_mfma_f32_16x16x32_bf16 a[8:11], a[136:139], v[40:43], a[8:11]
    v_mfma_f32_16x16x32_bf16 a[12:15], a[136:139], v[44:47], a[12:15]
    buffer_load_dwordx4 a[136:139], v11, s[52:55], s73 offen offset:3072
    s_waitcnt vmcnt(21)
    v_mfma_f32_16x16x32_bf16 a[16:19], a[140:143], v[32:35], a[16:19]
    v_mfma_f32_16x16x32_bf16 a[20:23], a[140:143], v[36:39], a[20:23]
    v_mfma_f32_16x16x32_bf16 a[24:27], a[140:143], v[40:43], a[24:27]
    v_mfma_f32_16x16x32_bf16 a[28:31], a[140:143], v[44:47], a[28:31]
    buffer_load_dwordx4 a[140:143], v12, s[52:55], s73 offen offset:3072
    s_waitcnt vmcnt(21)
    v_mfma_f32_16x16x32_bf16 a[32:35], a[144:147], v[32:35], a[32:35]
    v_mfma_f32_16x16x32_bf16 a[36:39], a[144:147], v[36:39], a[36:39]
    v_mfma_f32_16x16x32_bf16 a[40:43], a[144:147], v[40:43], a[40:43]
    v_mfma_f32_16x16x32_bf16 a[44:47], a[144:147], v[44:47], a[44:47]
    buffer_load_dwordx4 a[144:147], v9, s[52:55], s74 offen offset:0
    s_waitcnt vmcnt(21)
    v_mfma_f32_16x16x32_bf16 a[48:51], a[148:151], v[32:35], a[48:51]
    v_mfma_f32_16x16x32_bf16 a[52:55], a[148:151], v[36:39], a[52:55]
    v_mfma_f32_16x16x32_bf16 a[56:59], a[148:151], v[40:43], a[56:59]
    v_mfma_f32_16x16x32_bf16 a[60:63], a[148:151], v[44:47], a[60:63]
    buffer_load_dwordx4 a[148:151], v10, s[52:55], s74 offen offset:0
    ds_read_b128 v[32:35], v13 offset:8192
    ds_read_b128 v[36:39], v13 offset:9216
    ds_read_b128 v[40:43], v13 offset:10240
    ds_read_b128 v[44:47], v13 offset:11264
    s_waitcnt lgkmcnt(4)
    s_waitcnt vmcnt(21)
    v_mfma_f32_16x16x32_bf16 a[0:3], a[64:67], v[48:51], a[0:3]
    v_mfma_f32_16x16x32_bf16 a[4:7], a[64:67], v[52:55], a[4:7]
    v_mfma_f32_16x16x32_bf16 a[8:11], a[64:67], v[56:59], a[8:11]
    v_mfma_f32_16x16x32_bf16 a[12:15], a[64:67], v[60:63], a[12:15]
    buffer_load_dwordx4 a[64:67], v11, s[52:55], s74 offen offset:0
    s_waitcnt vmcnt(21)
    v_mfma_f32_16x16x32_bf16 a[16:19], a[68:71], v[48:51], a[16:19]
    v_mfma_f32_16x16x32_bf16 a[20:23], a[68:71], v[52:55], a[20:23]
    v_mfma_f32_16x16x32_bf16 a[24:27], a[68:71], v[56:59], a[24:27]
    v_mfma_f32_16x16x32_bf16 a[28:31], a[68:71], v[60:63], a[28:31]
    buffer_load_dwordx4 a[68:71], v12, s[52:55], s74 offen offset:0
    s_waitcnt vmcnt(21)
    v_mfma_f32_16x16x32_bf16 a[32:35], a[72:75], v[48:51], a[32:35]
    v_mfma_f32_16x16x32_bf16 a[36:39], a[72:75], v[52:55], a[36:39]
    v_mfma_f32_16x16x32_bf16 a[40:43], a[72:75], v[56:59], a[40:43]
    v_mfma_f32_16x16x32_bf16 a[44:47], a[72:75], v[60:63], a[44:47]
    buffer_load_dwordx4 a[72:75], v9, s[52:55], s74 offen offset:1024
    s_waitcnt vmcnt(21)
    v_mfma_f32_16x16x32_bf16 a[48:51], a[76:79], v[48:51], a[48:51]
    v_mfma_f32_16x16x32_bf16 a[52:55], a[76:79], v[52:55], a[52:55]
    v_mfma_f32_16x16x32_bf16 a[56:59], a[76:79], v[56:59], a[56:59]
    v_mfma_f32_16x16x32_bf16 a[60:63], a[76:79], v[60:63], a[60:63]
    buffer_load_dwordx4 a[76:79], v10, s[52:55], s74 offen offset:1024
    s_barrier
    ds_read_b128 v[48:51], v13 offset:12288
    ds_read_b128 v[52:55], v13 offset:13312
    ds_read_b128 v[56:59], v13 offset:14336
    ds_read_b128 v[60:63], v13 offset:15360
    s_waitcnt lgkmcnt(4)
    s_waitcnt vmcnt(21)
    v_mfma_f32_16x16x32_bf16 a[0:3], a[80:83], v[32:35], a[0:3]
    v_mfma_f32_16x16x32_bf16 a[4:7], a[80:83], v[36:39], a[4:7]
    v_mfma_f32_16x16x32_bf16 a[8:11], a[80:83], v[40:43], a[8:11]
    v_mfma_f32_16x16x32_bf16 a[12:15], a[80:83], v[44:47], a[12:15]
    buffer_load_dwordx4 a[80:83], v11, s[52:55], s74 offen offset:1024
    s_waitcnt vmcnt(21)
    v_mfma_f32_16x16x32_bf16 a[16:19], a[84:87], v[32:35], a[16:19]
    v_mfma_f32_16x16x32_bf16 a[20:23], a[84:87], v[36:39], a[20:23]
    v_mfma_f32_16x16x32_bf16 a[24:27], a[84:87], v[40:43], a[24:27]
    v_mfma_f32_16x16x32_bf16 a[28:31], a[84:87], v[44:47], a[28:31]
    buffer_load_dwordx4 a[84:87], v12, s[52:55], s74 offen offset:1024
    s_waitcnt vmcnt(21)
    v_mfma_f32_16x16x32_bf16 a[32:35], a[88:91], v[32:35], a[32:35]
    v_mfma_f32_16x16x32_bf16 a[36:39], a[88:91], v[36:39], a[36:39]
    v_mfma_f32_16x16x32_bf16 a[40:43], a[88:91], v[40:43], a[40:43]
    v_mfma_f32_16x16x32_bf16 a[44:47], a[88:91], v[44:47], a[44:47]
    buffer_load_dwordx4 a[88:91], v9, s[52:55], s74 offen offset:2048
    s_waitcnt vmcnt(21)
    v_mfma_f32_16x16x32_bf16 a[48:51], a[92:95], v[32:35], a[48:51]
    v_mfma_f32_16x16x32_bf16 a[52:55], a[92:95], v[36:39], a[52:55]
    v_mfma_f32_16x16x32_bf16 a[56:59], a[92:95], v[40:43], a[56:59]
    v_mfma_f32_16x16x32_bf16 a[60:63], a[92:95], v[44:47], a[60:63]
    buffer_load_dwordx4 a[92:95], v10, s[52:55], s74 offen offset:2048
    ds_read_b128 v[32:35], v13 offset:16384
    ds_read_b128 v[36:39], v13 offset:17408
    ds_read_b128 v[40:43], v13 offset:18432
    ds_read_b128 v[44:47], v13 offset:19456
    s_waitcnt lgkmcnt(4)
    s_waitcnt vmcnt(21)
    v_mfma_f32_16x16x32_bf16 a[0:3], a[96:99], v[48:51], a[0:3]
    v_mfma_f32_16x16x32_bf16 a[4:7], a[96:99], v[52:55], a[4:7]
    v_mfma_f32_16x16x32_bf16 a[8:11], a[96:99], v[56:59], a[8:11]
    v_mfma_f32_16x16x32_bf16 a[12:15], a[96:99], v[60:63], a[12:15]
    buffer_load_dwordx4 a[96:99], v11, s[52:55], s74 offen offset:2048
    s_waitcnt vmcnt(21)
    v_mfma_f32_16x16x32_bf16 a[16:19], a[100:103], v[48:51], a[16:19]
    v_mfma_f32_16x16x32_bf16 a[20:23], a[100:103], v[52:55], a[20:23]
    v_mfma_f32_16x16x32_bf16 a[24:27], a[100:103], v[56:59], a[24:27]
    v_mfma_f32_16x16x32_bf16 a[28:31], a[100:103], v[60:63], a[28:31]
    buffer_load_dwordx4 a[100:103], v12, s[52:55], s74 offen offset:2048
    s_waitcnt vmcnt(21)
    v_mfma_f32_16x16x32_bf16 a[32:35], a[104:107], v[48:51], a[32:35]
    v_mfma_f32_16x16x32_bf16 a[36:39], a[104:107], v[52:55], a[36:39]
    v_mfma_f32_16x16x32_bf16 a[40:43], a[104:107], v[56:59], a[40:43]
    v_mfma_f32_16x16x32_bf16 a[44:47], a[104:107], v[60:63], a[44:47]
    buffer_load_dwordx4 a[104:107], v9, s[52:55], s74 offen offset:3072
    s_waitcnt vmcnt(21)
    v_mfma_f32_16x16x32_bf16 a[48:51], a[108:111], v[48:51], a[48:51]
    v_mfma_f32_16x16x32_bf16 a[52:55], a[108:111], v[52:55], a[52:55]
    v_mfma_f32_16x16x32_bf16 a[56:59], a[108:111], v[56:59], a[56:59]
    v_mfma_f32_16x16x32_bf16 a[60:63], a[108:111], v[60:63], a[60:63]
    buffer_load_dwordx4 a[108:111], v10, s[52:55], s74 offen offset:3072
    s_barrier
    ds_read_b128 v[48:51], v13 offset:20480
    ds_read_b128 v[52:55], v13 offset:21504
    ds_read_b128 v[56:59], v13 offset:22528
    ds_read_b128 v[60:63], v13 offset:23552
    s_waitcnt lgkmcnt(4)
    s_waitcnt vmcnt(21)
    v_mfma_f32_16x16x32_bf16 a[0:3], a[112:115], v[32:35], a[0:3]
    v_mfma_f32_16x16x32_bf16 a[4:7], a[112:115], v[36:39], a[4:7]
    v_mfma_f32_16x16x32_bf16 a[8:11], a[112:115], v[40:43], a[8:11]
    v_mfma_f32_16x16x32_bf16 a[12:15], a[112:115], v[44:47], a[12:15]
    buffer_load_dwordx4 a[112:115], v11, s[52:55], s74 offen offset:3072
    s_waitcnt vmcnt(21)
    v_mfma_f32_16x16x32_bf16 a[16:19], a[116:119], v[32:35], a[16:19]
    v_mfma_f32_16x16x32_bf16 a[20:23], a[116:119], v[36:39], a[20:23]
    v_mfma_f32_16x16x32_bf16 a[24:27], a[116:119], v[40:43], a[24:27]
    v_mfma_f32_16x16x32_bf16 a[28:31], a[116:119], v[44:47], a[28:31]
    buffer_load_dwordx4 a[116:119], v12, s[52:55], s74 offen offset:3072
    s_waitcnt vmcnt(21)
    v_mfma_f32_16x16x32_bf16 a[32:35], a[120:123], v[32:35], a[32:35]
    v_mfma_f32_16x16x32_bf16 a[36:39], a[120:123], v[36:39], a[36:39]
    v_mfma_f32_16x16x32_bf16 a[40:43], a[120:123], v[40:43], a[40:43]
    v_mfma_f32_16x16x32_bf16 a[44:47], a[120:123], v[44:47], a[44:47]
    s_waitcnt vmcnt(20)
    v_mfma_f32_16x16x32_bf16 a[48:51], a[124:127], v[32:35], a[48:51]
    v_mfma_f32_16x16x32_bf16 a[52:55], a[124:127], v[36:39], a[52:55]
    v_mfma_f32_16x16x32_bf16 a[56:59], a[124:127], v[40:43], a[56:59]
    v_mfma_f32_16x16x32_bf16 a[60:63], a[124:127], v[44:47], a[60:63]
    ds_read_b128 v[32:35], v13 offset:24576
    ds_read_b128 v[36:39], v13 offset:25600
    ds_read_b128 v[40:43], v13 offset:26624
    ds_read_b128 v[44:47], v13 offset:27648
    s_waitcnt lgkmcnt(4)
    s_waitcnt vmcnt(19)
    v_mfma_f32_16x16x32_bf16 a[0:3], a[128:131], v[48:51], a[0:3]
    v_mfma_f32_16x16x32_bf16 a[4:7], a[128:131], v[52:55], a[4:7]
    v_mfma_f32_16x16x32_bf16 a[8:11], a[128:131], v[56:59], a[8:11]
    v_mfma_f32_16x16x32_bf16 a[12:15], a[128:131], v[60:63], a[12:15]
    s_waitcnt vmcnt(18)
    v_mfma_f32_16x16x32_bf16 a[16:19], a[132:135], v[48:51], a[16:19]
    v_mfma_f32_16x16x32_bf16 a[20:23], a[132:135], v[52:55], a[20:23]
    v_mfma_f32_16x16x32_bf16 a[24:27], a[132:135], v[56:59], a[24:27]
    v_mfma_f32_16x16x32_bf16 a[28:31], a[132:135], v[60:63], a[28:31]
    s_waitcnt vmcnt(17)
    v_mfma_f32_16x16x32_bf16 a[32:35], a[136:139], v[48:51], a[32:35]
    v_mfma_f32_16x16x32_bf16 a[36:39], a[136:139], v[52:55], a[36:39]
    v_mfma_f32_16x16x32_bf16 a[40:43], a[136:139], v[56:59], a[40:43]
    v_mfma_f32_16x16x32_bf16 a[44:47], a[136:139], v[60:63], a[44:47]
    s_waitcnt vmcnt(16)
    v_mfma_f32_16x16x32_bf16 a[48:51], a[140:143], v[48:51], a[48:51]
    v_mfma_f32_16x16x32_bf16 a[52:55], a[140:143], v[52:55], a[52:55]
    v_mfma_f32_16x16x32_bf16 a[56:59], a[140:143], v[56:59], a[56:59]
    v_mfma_f32_16x16x32_bf16 a[60:63], a[140:143], v[60:63], a[60:63]
    s_barrier
    ds_read_b128 v[48:51], v13 offset:28672
    ds_read_b128 v[52:55], v13 offset:29696
    ds_read_b128 v[56:59], v13 offset:30720
    ds_read_b128 v[60:63], v13 offset:31744
    s_waitcnt lgkmcnt(4)
    s_waitcnt vmcnt(15)
    v_mfma_f32_16x16x32_bf16 a[0:3], a[144:147], v[32:35], a[0:3]
    v_mfma_f32_16x16x32_bf16 a[4:7], a[144:147], v[36:39], a[4:7]
    v_mfma_f32_16x16x32_bf16 a[8:11], a[144:147], v[40:43], a[8:11]
    v_mfma_f32_16x16x32_bf16 a[12:15], a[144:147], v[44:47], a[12:15]
    s_waitcnt vmcnt(14)
    v_mfma_f32_16x16x32_bf16 a[16:19], a[148:151], v[32:35], a[16:19]
    v_mfma_f32_16x16x32_bf16 a[20:23], a[148:151], v[36:39], a[20:23]
    v_mfma_f32_16x16x32_bf16 a[24:27], a[148:151], v[40:43], a[24:27]
    v_mfma_f32_16x16x32_bf16 a[28:31], a[148:151], v[44:47], a[28:31]
    s_waitcnt vmcnt(13)
    v_mfma_f32_16x16x32_bf16 a[32:35], a[64:67], v[32:35], a[32:35]
    v_mfma_f32_16x16x32_bf16 a[36:39], a[64:67], v[36:39], a[36:39]
    v_mfma_f32_16x16x32_bf16 a[40:43], a[64:67], v[40:43], a[40:43]
    v_mfma_f32_16x16x32_bf16 a[44:47], a[64:67], v[44:47], a[44:47]
    s_waitcnt vmcnt(12)
    v_mfma_f32_16x16x32_bf16 a[48:51], a[68:71], v[32:35], a[48:51]
    v_mfma_f32_16x16x32_bf16 a[52:55], a[68:71], v[36:39], a[52:55]
    v_mfma_f32_16x16x32_bf16 a[56:59], a[68:71], v[40:43], a[56:59]
    v_mfma_f32_16x16x32_bf16 a[60:63], a[68:71], v[44:47], a[60:63]
    ds_read_b128 v[32:35], v13 offset:32768
    ds_read_b128 v[36:39], v13 offset:33792
    ds_read_b128 v[40:43], v13 offset:34816
    ds_read_b128 v[44:47], v13 offset:35840
    s_waitcnt lgkmcnt(4)
    s_waitcnt vmcnt(11)
    v_mfma_f32_16x16x32_bf16 a[0:3], a[72:75], v[48:51], a[0:3]
    v_mfma_f32_16x16x32_bf16 a[4:7], a[72:75], v[52:55], a[4:7]
    v_mfma_f32_16x16x32_bf16 a[8:11], a[72:75], v[56:59], a[8:11]
    v_mfma_f32_16x16x32_bf16 a[12:15], a[72:75], v[60:63], a[12:15]
    s_waitcnt vmcnt(10)
    v_mfma_f32_16x16x32_bf16 a[16:19], a[76:79], v[48:51], a[16:19]
    v_mfma_f32_16x16x32_bf16 a[20:23], a[76:79], v[52:55], a[20:23]
    v_mfma_f32_16x16x32_bf16 a[24:27], a[76:79], v[56:59], a[24:27]
    v_mfma_f32_16x16x32_bf16 a[28:31], a[76:79], v[60:63], a[28:31]
    s_waitcnt vmcnt(9)
    v_mfma_f32_16x16x32_bf16 a[32:35], a[80:83], v[48:51], a[32:35]
    v_mfma_f32_16x16x32_bf16 a[36:39], a[80:83], v[52:55], a[36:39]
    v_mfma_f32_16x16x32_bf16 a[40:43], a[80:83], v[56:59], a[40:43]
    v_mfma_f32_16x16x32_bf16 a[44:47], a[80:83], v[60:63], a[44:47]
    s_waitcnt vmcnt(8)
    v_mfma_f32_16x16x32_bf16 a[48:51], a[84:87], v[48:51], a[48:51]
    v_mfma_f32_16x16x32_bf16 a[52:55], a[84:87], v[52:55], a[52:55]
    v_mfma_f32_16x16x32_bf16 a[56:59], a[84:87], v[56:59], a[56:59]
    v_mfma_f32_16x16x32_bf16 a[60:63], a[84:87], v[60:63], a[60:63]
    ds_read_b128 v[48:51], v13 offset:36864
    ds_read_b128 v[52:55], v13 offset:37888
    ds_read_b128 v[56:59], v13 offset:38912
    ds_read_b128 v[60:63], v13 offset:39936
    s_waitcnt lgkmcnt(4)
    s_waitcnt vmcnt(7)
    v_mfma_f32_16x16x32_bf16 a[0:3], a[88:91], v[32:35], a[0:3]
    v_mfma_f32_16x16x32_bf16 a[4:7], a[88:91], v[36:39], a[4:7]
    v_mfma_f32_16x16x32_bf16 a[8:11], a[88:91], v[40:43], a[8:11]
    v_mfma_f32_16x16x32_bf16 a[12:15], a[88:91], v[44:47], a[12:15]
    s_waitcnt vmcnt(6)
    v_mfma_f32_16x16x32_bf16 a[16:19], a[92:95], v[32:35], a[16:19]
    v_mfma_f32_16x16x32_bf16 a[20:23], a[92:95], v[36:39], a[20:23]
    v_mfma_f32_16x16x32_bf16 a[24:27], a[92:95], v[40:43], a[24:27]
    v_mfma_f32_16x16x32_bf16 a[28:31], a[92:95], v[44:47], a[28:31]
    s_waitcnt vmcnt(5)
    v_mfma_f32_16x16x32_bf16 a[32:35], a[96:99], v[32:35], a[32:35]
    v_mfma_f32_16x16x32_bf16 a[36:39], a[96:99], v[36:39], a[36:39]
    v_mfma_f32_16x16x32_bf16 a[40:43], a[96:99], v[40:43], a[40:43]
    v_mfma_f32_16x16x32_bf16 a[44:47], a[96:99], v[44:47], a[44:47]
    s_waitcnt vmcnt(4)
    v_mfma_f32_16x16x32_bf16 a[48:51], a[100:103], v[32:35], a[48:51]
    v_mfma_f32_16x16x32_bf16 a[52:55], a[100:103], v[36:39], a[52:55]
    v_mfma_f32_16x16x32_bf16 a[56:59], a[100:103], v[40:43], a[56:59]
    v_mfma_f32_16x16x32_bf16 a[60:63], a[100:103], v[44:47], a[60:63]
    s_waitcnt lgkmcnt(0)
    s_waitcnt vmcnt(3)
    v_mfma_f32_16x16x32_bf16 a[0:3], a[104:107], v[48:51], a[0:3]
    v_mfma_f32_16x16x32_bf16 a[4:7], a[104:107], v[52:55], a[4:7]
    v_mfma_f32_16x16x32_bf16 a[8:11], a[104:107], v[56:59], a[8:11]
    v_mfma_f32_16x16x32_bf16 a[12:15], a[104:107], v[60:63], a[12:15]
    s_waitcnt vmcnt(2)
    v_mfma_f32_16x16x32_bf16 a[16:19], a[108:111], v[48:51], a[16:19]
    v_mfma_f32_16x16x32_bf16 a[20:23], a[108:111], v[52:55], a[20:23]
    v_mfma_f32_16x16x32_bf16 a[24:27], a[108:111], v[56:59], a[24:27]
    v_mfma_f32_16x16x32_bf16 a[28:31], a[108:111], v[60:63], a[28:31]
    s_waitcnt vmcnt(1)
    v_mfma_f32_16x16x32_bf16 a[32:35], a[112:115], v[48:51], a[32:35]
    v_mfma_f32_16x16x32_bf16 a[36:39], a[112:115], v[52:55], a[36:39]
    v_mfma_f32_16x16x32_bf16 a[40:43], a[112:115], v[56:59], a[40:43]
    v_mfma_f32_16x16x32_bf16 a[44:47], a[112:115], v[60:63], a[44:47]
    s_waitcnt vmcnt(0)
    v_mfma_f32_16x16x32_bf16 a[48:51], a[116:119], v[48:51], a[48:51]
    v_mfma_f32_16x16x32_bf16 a[52:55], a[116:119], v[52:55], a[52:55]
    v_mfma_f32_16x16x32_bf16 a[56:59], a[116:119], v[56:59], a[56:59]
    v_mfma_f32_16x16x32_bf16 a[60:63], a[116:119], v[60:63], a[60:63]
    s_barrier
    ds_read_b64 v[64:65], v14 offset:0
    ds_read_b64 v[66:67], v14 offset:128
    ds_read_b64 v[68:69], v14 offset:256
    ds_read_b64 v[70:71], v14 offset:384
    s_waitcnt lgkmcnt(0)
    v_accvgpr_read_b32 v72, a0
    v_accvgpr_read_b32 v73, a1
    v_accvgpr_read_b32 v74, a2
    v_accvgpr_read_b32 v75, a3
    v_mul_f32 v72, v72, v65
    v_mul_f32 v73, v73, v65
    v_mul_f32 v74, v74, v65
    v_mul_f32 v75, v75, v65
    v_fma_f32 v72, -v64, v16, v72
    v_fma_f32 v73, -v64, v17, v73
    v_fma_f32 v74, -v64, v18, v74
    v_fma_f32 v75, -v64, v19, v75
    v_cvt_pk_bf16_f32 v76, v72, v73
    v_cvt_pk_bf16_f32 v77, v74, v75
    v_lshlrev_b32 v72, 16, v76
    v_and_b32 v73, s92, v76
    v_lshlrev_b32 v74, 16, v77
    v_and_b32 v75, s92, v77
    v_mul_f32 v76, s93, v72
    v_mul_f32 v77, s93, v73
    v_mul_f32 v78, s93, v74
    v_mul_f32 v79, s93, v75
    v_exp_f32 v76, v76
    v_exp_f32 v77, v77
    v_exp_f32 v78, v78
    v_exp_f32 v79, v79
    s_nop 0
    v_add_f32 v76, 1.0, v76
    v_add_f32 v77, 1.0, v77
    v_add_f32 v78, 1.0, v78
    v_add_f32 v79, 1.0, v79
    v_rcp_f32 v76, v76
    v_rcp_f32 v77, v77
    v_rcp_f32 v78, v78
    v_rcp_f32 v79, v79
    s_nop 0
    v_mul_f32 v72, v72, v76
    v_mul_f32 v73, v73, v77
    v_mul_f32 v74, v74, v78
    v_mul_f32 v75, v75, v79
    v_cvt_pk_bf16_f32 v88, v72, v73
    v_cvt_pk_bf16_f32 v89, v74, v75
    v_accvgpr_read_b32 v80, a4
    v_accvgpr_read_b32 v81, a5
    v_accvgpr_read_b32 v82, a6
    v_accvgpr_read_b32 v83, a7
    v_mul_f32 v80, v80, v67
    v_mul_f32 v81, v81, v67
    v_mul_f32 v82, v82, v67
    v_mul_f32 v83, v83, v67
    v_fma_f32 v80, -v66, v16, v80
    v_fma_f32 v81, -v66, v17, v81
    v_fma_f32 v82, -v66, v18, v82
    v_fma_f32 v83, -v66, v19, v83
    v_cvt_pk_bf16_f32 v84, v80, v81
    v_cvt_pk_bf16_f32 v85, v82, v83
    v_lshlrev_b32 v80, 16, v84
    v_and_b32 v81, s92, v84
    v_lshlrev_b32 v82, 16, v85
    v_and_b32 v83, s92, v85
    v_mul_f32 v84, s93, v80
    v_mul_f32 v85, s93, v81
    v_mul_f32 v86, s93, v82
    v_mul_f32 v87, s93, v83
    v_exp_f32 v84, v84
    v_exp_f32 v85, v85
    v_exp_f32 v86, v86
    v_exp_f32 v87, v87
    s_nop 0
    v_add_f32 v84, 1.0, v84
    v_add_f32 v85, 1.0, v85
    v_add_f32 v86, 1.0, v86
    v_add_f32 v87, 1.0, v87
    v_rcp_f32 v84, v84
    v_rcp_f32 v85, v85
    v_rcp_f32 v86, v86
    v_rcp_f32 v87, v87
    s_nop 0
    v_mul_f32 v80, v80, v84
    v_mul_f32 v81, v81, v85
    v_mul_f32 v82, v82, v86
    v_mul_f32 v83, v83, v87
    v_cvt_pk_bf16_f32 v92, v80, v81
    v_cvt_pk_bf16_f32 v93, v82, v83
    v_accvgpr_read_b32 v72, a8
    v_accvgpr_read_b32 v73, a9
    v_accvgpr_read_b32 v74, a10
    v_accvgpr_read_b32 v75, a11
    v_mul_f32 v72, v72, v69
    v_mul_f32 v73, v73, v69
    v_mul_f32 v74, v74, v69
    v_mul_f32 v75, v75, v69
    v_fma_f32 v72, -v68, v16, v72
    v_fma_f32 v73, -v68, v17, v73
    v_fma_f32 v74, -v68, v18, v74
    v_fma_f32 v75, -v68, v19, v75
    v_cvt_pk_bf16_f32 v76, v72, v73
    v_cvt_pk_bf16_f32 v77, v74, v75
    v_lshlrev_b32 v72, 16, v76
    v_and_b32 v73, s92, v76
    v_lshlrev_b32 v74, 16, v77
    v_and_b32 v75, s92, v77
    v_mul_f32 v76, s93, v72
    v_mul_f32 v77, s93, v73
    v_mul_f32 v78, s93, v74
    v_mul_f32 v79, s93, v75
    v_exp_f32 v76, v76
    v_exp_f32 v77, v77
    v_exp_f32 v78, v78
    v_exp_f32 v79, v79
    s_nop 0
    v_add_f32 v76, 1.0, v76
    v_add_f32 v77, 1.0, v77
    v_add_f32 v78, 1.0, v78
    v_add_f32 v79, 1.0, v79
    v_rcp_f32 v76, v76
    v_rcp_f32 v77, v77
    v_rcp_f32 v78, v78
    v_rcp_f32 v79, v79
    s_nop 0
    v_mul_f32 v72, v72, v76
    v_mul_f32 v73, v73, v77
    v_mul_f32 v74, v74, v78
    v_mul_f32 v75, v75, v79
    v_cvt_pk_bf16_f32 v96, v72, v73
    v_cvt_pk_bf16_f32 v97, v74, v75
    v_accvgpr_read_b32 v80, a12
    v_accvgpr_read_b32 v81, a13
    v_accvgpr_read_b32 v82, a14
    v_accvgpr_read_b32 v83, a15
    v_mul_f32 v80, v80, v71
    v_mul_f32 v81, v81, v71
    v_mul_f32 v82, v82, v71
    v_mul_f32 v83, v83, v71
    v_fma_f32 v80, -v70, v16, v80
    v_fma_f32 v81, -v70, v17, v81
    v_fma_f32 v82, -v70, v18, v82
    v_fma_f32 v83, -v70, v19, v83
    v_cvt_pk_bf16_f32 v84, v80, v81
    v_cvt_pk_bf16_f32 v85, v82, v83
    v_lshlrev_b32 v80, 16, v84
    v_and_b32 v81, s92, v84
    v_lshlrev_b32 v82, 16, v85
    v_and_b32 v83, s92, v85
    v_mul_f32 v84, s93, v80
    v_mul_f32 v85, s93, v81
    v_mul_f32 v86, s93, v82
    v_mul_f32 v87, s93, v83
    v_exp_f32 v84, v84
    v_exp_f32 v85, v85
    v_exp_f32 v86, v86
    v_exp_f32 v87, v87
    s_nop 0
    v_add_f32 v84, 1.0, v84
    v_add_f32 v85, 1.0, v85
    v_add_f32 v86, 1.0, v86
    v_add_f32 v87, 1.0, v87
    v_rcp_f32 v84, v84
    v_rcp_f32 v85, v85
    v_rcp_f32 v86, v86
    v_rcp_f32 v87, v87
    s_nop 0
    v_mul_f32 v80, v80, v84
    v_mul_f32 v81, v81, v85
    v_mul_f32 v82, v82, v86
    v_mul_f32 v83, v83, v87
    v_cvt_pk_bf16_f32 v100, v80, v81
    v_cvt_pk_bf16_f32 v101, v82, v83
    v_accvgpr_read_b32 v72, a16
    v_accvgpr_read_b32 v73, a17
    v_accvgpr_read_b32 v74, a18
    v_accvgpr_read_b32 v75, a19
    v_mul_f32 v72, v72, v65
    v_mul_f32 v73, v73, v65
    v_mul_f32 v74, v74, v65
    v_mul_f32 v75, v75, v65
    v_fma_f32 v72, -v64, v20, v72
    v_fma_f32 v73, -v64, v21, v73
    v_fma_f32 v74, -v64, v22, v74
    v_fma_f32 v75, -v64, v23, v75
    v_cvt_pk_bf16_f32 v76, v72, v73
    v_cvt_pk_bf16_f32 v77, v74, v75
    v_lshlrev_b32 v72, 16, v76
    v_and_b32 v73, s92, v76
    v_lshlrev_b32 v74, 16, v77
    v_and_b32 v75, s92, v77
    v_mul_f32 v76, s93, v72
    v_mul_f32 v77, s93, v73
    v_mul_f32 v78, s93, v74
    v_mul_f32 v79, s93, v75
    v_exp_f32 v76, v76
    v_exp_f32 v77, v77
    v_exp_f32 v78, v78
    v_exp_f32 v79, v79
    s_nop 0
    v_add_f32 v76, 1.0, v76
    v_add_f32 v77, 1.0, v77
    v_add_f32 v78, 1.0, v78
    v_add_f32 v79, 1.0, v79
    v_rcp_f32 v76, v76
    v_rcp_f32 v77, v77
    v_rcp_f32 v78, v78
    v_rcp_f32 v79, v79
    s_nop 0
    v_mul_f32 v72, v72, v76
    v_mul_f32 v73, v73, v77
    v_mul_f32 v74, v74, v78
    v_mul_f32 v75, v75, v79
    v_cvt_pk_bf16_f32 v90, v72, v73
    v_cvt_pk_bf16_f32 v91, v74, v75
    s_add_u32 s80, s14, 0
    buffer_store_dwordx4 v[88:91], v4, s[60:63], s80 offen sc1
    v_accvgpr_read_b32 v80, a20
    v_accvgpr_read_b32 v81, a21
    v_accvgpr_read_b32 v82, a22
    v_accvgpr_read_b32 v83, a23
    v_mul_f32 v80, v80, v67
    v_mul_f32 v81, v81, v67
    v_mul_f32 v82, v82, v67
    v_mul_f32 v83, v83, v67
    v_fma_f32 v80, -v66, v20, v80
    v_fma_f32 v81, -v66, v21, v81
    v_fma_f32 v82, -v66, v22, v82
    v_fma_f32 v83, -v66, v23, v83
    v_cvt_pk_bf16_f32 v84, v80, v81
    v_cvt_pk_bf16_f32 v85, v82, v83
    v_lshlrev_b32 v80, 16, v84
    v_and_b32 v81, s92, v84
    v_lshlrev_b32 v82, 16, v85
    v_and_b32 v83, s92, v85
    v_mul_f32 v84, s93, v80
    v_mul_f32 v85, s93, v81
    v_mul_f32 v86, s93, v82
    v_mul_f32 v87, s93, v83
    v_exp_f32 v84, v84
    v_exp_f32 v85, v85
    v_exp_f32 v86, v86
    v_exp_f32 v87, v87
    s_nop 0
    v_add_f32 v84, 1.0, v84
    v_add_f32 v85, 1.0, v85
    v_add_f32 v86, 1.0, v86
    v_add_f32 v87, 1.0, v87
    v_rcp_f32 v84, v84
    v_rcp_f32 v85, v85
    v_rcp_f32 v86, v86
    v_rcp_f32 v87, v87
    s_nop 0
    v_mul_f32 v80, v80, v84
    v_mul_f32 v81, v81, v85
    v_mul_f32 v82, v82, v86
    v_mul_f32 v83, v83, v87
    v_cvt_pk_bf16_f32 v94, v80, v81
    v_cvt_pk_bf16_f32 v95, v82, v83
    s_add_u32 s80, s14, 55296
    buffer_store_dwordx4 v[92:95], v4, s[60:63], s80 offen sc1
    v_accvgpr_read_b32 v72, a24
    v_accvgpr_read_b32 v73, a25
    v_accvgpr_read_b32 v74, a26
    v_accvgpr_read_b32 v75, a27
    v_mul_f32 v72, v72, v69
    v_mul_f32 v73, v73, v69
    v_mul_f32 v74, v74, v69
    v_mul_f32 v75, v75, v69
    v_fma_f32 v72, -v68, v20, v72
    v_fma_f32 v73, -v68, v21, v73
    v_fma_f32 v74, -v68, v22, v74
    v_fma_f32 v75, -v68, v23, v75
    v_cvt_pk_bf16_f32 v76, v72, v73
    v_cvt_pk_bf16_f32 v77, v74, v75
    v_lshlrev_b32 v72, 16, v76
    v_and_b32 v73, s92, v76
    v_lshlrev_b32 v74, 16, v77
    v_and_b32 v75, s92, v77
    v_mul_f32 v76, s93, v72
    v_mul_f32 v77, s93, v73
    v_mul_f32 v78, s93, v74
    v_mul_f32 v79, s93, v75
    v_exp_f32 v76, v76
    v_exp_f32 v77, v77
    v_exp_f32 v78, v78
    v_exp_f32 v79, v79
    s_nop 0
    v_add_f32 v76, 1.0, v76
    v_add_f32 v77, 1.0, v77
    v_add_f32 v78, 1.0, v78
    v_add_f32 v79, 1.0, v79
    v_rcp_f32 v76, v76
    v_rcp_f32 v77, v77
    v_rcp_f32 v78, v78
    v_rcp_f32 v79, v79
    s_nop 0
    v_mul_f32 v72, v72, v76
    v_mul_f32 v73, v73, v77
    v_mul_f32 v74, v74, v78
    v_mul_f32 v75, v75, v79
    v_cvt_pk_bf16_f32 v98, v72, v73
    v_cvt_pk_bf16_f32 v99, v74, v75
    s_add_u32 s80, s14, 110592
    buffer_store_dwordx4 v[96:99], v4, s[60:63], s80 offen sc1
    v_accvgpr_read_b32 v80, a28
    v_accvgpr_read_b32 v81, a29
    v_accvgpr_read_b32 v82, a30
    v_accvgpr_read_b32 v83, a31
    v_mul_f32 v80, v80, v71
    v_mul_f32 v81, v81, v71
    v_mul_f32 v82, v82, v71
    v_mul_f32 v83, v83, v71
    v_fma_f32 v80, -v70, v20, v80
    v_fma_f32 v81, -v70, v21, v81
    v_fma_f32 v82, -v70, v22, v82
    v_fma_f32 v83, -v70, v23, v83
    v_cvt_pk_bf16_f32 v84, v80, v81
    v_cvt_pk_bf16_f32 v85, v82, v83
    v_lshlrev_b32 v80, 16, v84
    v_and_b32 v81, s92, v84
    v_lshlrev_b32 v82, 16, v85
    v_and_b32 v83, s92, v85
    v_mul_f32 v84, s93, v80
    v_mul_f32 v85, s93, v81
    v_mul_f32 v86, s93, v82
    v_mul_f32 v87, s93, v83
    v_exp_f32 v84, v84
    v_exp_f32 v85, v85
    v_exp_f32 v86, v86
    v_exp_f32 v87, v87
    s_nop 0
    v_add_f32 v84, 1.0, v84
    v_add_f32 v85, 1.0, v85
    v_add_f32 v86, 1.0, v86
    v_add_f32 v87, 1.0, v87
    v_rcp_f32 v84, v84
    v_rcp_f32 v85, v85
    v_rcp_f32 v86, v86
    v_rcp_f32 v87, v87
    s_nop 0
    v_mul_f32 v80, v80, v84
    v_mul_f32 v81, v81, v85
    v_mul_f32 v82, v82, v86
    v_mul_f32 v83, v83, v87
    v_cvt_pk_bf16_f32 v102, v80, v81
    v_cvt_pk_bf16_f32 v103, v82, v83
    s_add_u32 s80, s14, 165888
    buffer_store_dwordx4 v[100:103], v4, s[60:63], s80 offen sc1
    v_accvgpr_read_b32 v72, a32
    v_accvgpr_read_b32 v73, a33
    v_accvgpr_read_b32 v74, a34
    v_accvgpr_read_b32 v75, a35
    v_mul_f32 v72, v72, v65
    v_mul_f32 v73, v73, v65
    v_mul_f32 v74, v74, v65
    v_mul_f32 v75, v75, v65
    v_fma_f32 v72, -v64, v24, v72
    v_fma_f32 v73, -v64, v25, v73
    v_fma_f32 v74, -v64, v26, v74
    v_fma_f32 v75, -v64, v27, v75
    v_cvt_pk_bf16_f32 v76, v72, v73
    v_cvt_pk_bf16_f32 v77, v74, v75
    v_lshlrev_b32 v72, 16, v76
    v_and_b32 v73, s92, v76
    v_lshlrev_b32 v74, 16, v77
    v_and_b32 v75, s92, v77
    v_mul_f32 v76, s93, v72
    v_mul_f32 v77, s93, v73
    v_mul_f32 v78, s93, v74
    v_mul_f32 v79, s93, v75
    v_exp_f32 v76, v76
    v_exp_f32 v77, v77
    v_exp_f32 v78, v78
    v_exp_f32 v79, v79
    s_nop 0
    v_add_f32 v76, 1.0, v76
    v_add_f32 v77, 1.0, v77
    v_add_f32 v78, 1.0, v78
    v_add_f32 v79, 1.0, v79
    v_rcp_f32 v76, v76
    v_rcp_f32 v77, v77
    v_rcp_f32 v78, v78
    v_rcp_f32 v79, v79
    s_nop 0
    v_mul_f32 v72, v72, v76
    v_mul_f32 v73, v73, v77
    v_mul_f32 v74, v74, v78
    v_mul_f32 v75, v75, v79
    v_cvt_pk_bf16_f32 v88, v72, v73
    v_cvt_pk_bf16_f32 v89, v74, v75
    v_accvgpr_read_b32 v80, a36
    v_accvgpr_read_b32 v81, a37
    v_accvgpr_read_b32 v82, a38
    v_accvgpr_read_b32 v83, a39
    v_mul_f32 v80, v80, v67
    v_mul_f32 v81, v81, v67
    v_mul_f32 v82, v82, v67
    v_mul_f32 v83, v83, v67
    v_fma_f32 v80, -v66, v24, v80
    v_fma_f32 v81, -v66, v25, v81
    v_fma_f32 v82, -v66, v26, v82
    v_fma_f32 v83, -v66, v27, v83
    v_cvt_pk_bf16_f32 v84, v80, v81
    v_cvt_pk_bf16_f32 v85, v82, v83
    v_lshlrev_b32 v80, 16, v84
    v_and_b32 v81, s92, v84
    v_lshlrev_b32 v82, 16, v85
    v_and_b32 v83, s92, v85
    v_mul_f32 v84, s93, v80
    v_mul_f32 v85, s93, v81
    v_mul_f32 v86, s93, v82
    v_mul_f32 v87, s93, v83
    v_exp_f32 v84, v84
    v_exp_f32 v85, v85
    v_exp_f32 v86, v86
    v_exp_f32 v87, v87
    s_nop 0
    v_add_f32 v84, 1.0, v84
    v_add_f32 v85, 1.0, v85
    v_add_f32 v86, 1.0, v86
    v_add_f32 v87, 1.0, v87
    v_rcp_f32 v84, v84
    v_rcp_f32 v85, v85
    v_rcp_f32 v86, v86
    v_rcp_f32 v87, v87
    s_nop 0
    v_mul_f32 v80, v80, v84
    v_mul_f32 v81, v81, v85
    v_mul_f32 v82, v82, v86
    v_mul_f32 v83, v83, v87
    v_cvt_pk_bf16_f32 v92, v80, v81
    v_cvt_pk_bf16_f32 v93, v82, v83
    v_accvgpr_read_b32 v72, a40
    v_accvgpr_read_b32 v73, a41
    v_accvgpr_read_b32 v74, a42
    v_accvgpr_read_b32 v75, a43
    v_mul_f32 v72, v72, v69
    v_mul_f32 v73, v73, v69
    v_mul_f32 v74, v74, v69
    v_mul_f32 v75, v75, v69
    v_fma_f32 v72, -v68, v24, v72
    v_fma_f32 v73, -v68, v25, v73
    v_fma_f32 v74, -v68, v26, v74
    v_fma_f32 v75, -v68, v27, v75
    v_cvt_pk_bf16_f32 v76, v72, v73
    v_cvt_pk_bf16_f32 v77, v74, v75
    v_lshlrev_b32 v72, 16, v76
    v_and_b32 v73, s92, v76
    v_lshlrev_b32 v74, 16, v77
    v_and_b32 v75, s92, v77
    v_mul_f32 v76, s93, v72
    v_mul_f32 v77, s93, v73
    v_mul_f32 v78, s93, v74
    v_mul_f32 v79, s93, v75
    v_exp_f32 v76, v76
    v_exp_f32 v77, v77
    v_exp_f32 v78, v78
    v_exp_f32 v79, v79
    s_nop 0
    v_add_f32 v76, 1.0, v76
    v_add_f32 v77, 1.0, v77
    v_add_f32 v78, 1.0, v78
    v_add_f32 v79, 1.0, v79
    v_rcp_f32 v76, v76
    v_rcp_f32 v77, v77
    v_rcp_f32 v78, v78
    v_rcp_f32 v79, v79
    s_nop 0
    v_mul_f32 v72, v72, v76
    v_mul_f32 v73, v73, v77
    v_mul_f32 v74, v74, v78
    v_mul_f32 v75, v75, v79
    v_cvt_pk_bf16_f32 v96, v72, v73
    v_cvt_pk_bf16_f32 v97, v74, v75
    v_accvgpr_read_b32 v80, a44
    v_accvgpr_read_b32 v81, a45
    v_accvgpr_read_b32 v82, a46
    v_accvgpr_read_b32 v83, a47
    v_mul_f32 v80, v80, v71
    v_mul_f32 v81, v81, v71
    v_mul_f32 v82, v82, v71
    v_mul_f32 v83, v83, v71
    v_fma_f32 v80, -v70, v24, v80
    v_fma_f32 v81, -v70, v25, v81
    v_fma_f32 v82, -v70, v26, v82
    v_fma_f32 v83, -v70, v27, v83
    v_cvt_pk_bf16_f32 v84, v80, v81
    v_cvt_pk_bf16_f32 v85, v82, v83
    v_lshlrev_b32 v80, 16, v84
    v_and_b32 v81, s92, v84
    v_lshlrev_b32 v82, 16, v85
    v_and_b32 v83, s92, v85
    v_mul_f32 v84, s93, v80
    v_mul_f32 v85, s93, v81
    v_mul_f32 v86, s93, v82
    v_mul_f32 v87, s93, v83
    v_exp_f32 v84, v84
    v_exp_f32 v85, v85
    v_exp_f32 v86, v86
    v_exp_f32 v87, v87
    s_nop 0
    v_add_f32 v84, 1.0, v84
    v_add_f32 v85, 1.0, v85
    v_add_f32 v86, 1.0, v86
    v_add_f32 v87, 1.0, v87
    v_rcp_f32 v84, v84
    v_rcp_f32 v85, v85
    v_rcp_f32 v86, v86
    v_rcp_f32 v87, v87
    s_nop 0
    v_mul_f32 v80, v80, v84
    v_mul_f32 v81, v81, v85
    v_mul_f32 v82, v82, v86
    v_mul_f32 v83, v83, v87
    v_cvt_pk_bf16_f32 v100, v80, v81
    v_cvt_pk_bf16_f32 v101, v82, v83
    v_accvgpr_read_b32 v72, a48
    v_accvgpr_read_b32 v73, a49
    v_accvgpr_read_b32 v74, a50
    v_accvgpr_read_b32 v75, a51
    v_mul_f32 v72, v72, v65
    v_mul_f32 v73, v73, v65
    v_mul_f32 v74, v74, v65
    v_mul_f32 v75, v75, v65
    v_fma_f32 v72, -v64, v28, v72
    v_fma_f32 v73, -v64, v29, v73
    v_fma_f32 v74, -v64, v30, v74
    v_fma_f32 v75, -v64, v31, v75
    v_cvt_pk_bf16_f32 v76, v72, v73
    v_cvt_pk_bf16_f32 v77, v74, v75
    v_lshlrev_b32 v72, 16, v76
    v_and_b32 v73, s92, v76
    v_lshlrev_b32 v74, 16, v77
    v_and_b32 v75, s92, v77
    v_mul_f32 v76, s93, v72
    v_mul_f32 v77, s93, v73
    v_mul_f32 v78, s93, v74
    v_mul_f32 v79, s93, v75
    v_exp_f32 v76, v76
    v_exp_f32 v77, v77
    v_exp_f32 v78, v78
    v_exp_f32 v79, v79
    s_nop 0
    v_add_f32 v76, 1.0, v76
    v_add_f32 v77, 1.0, v77
    v_add_f32 v78, 1.0, v78
    v_add_f32 v79, 1.0, v79
    v_rcp_f32 v76, v76
    v_rcp_f32 v77, v77
    v_rcp_f32 v78, v78
    v_rcp_f32 v79, v79
    s_nop 0
    v_mul_f32 v72, v72, v76
    v_mul_f32 v73, v73, v77
    v_mul_f32 v74, v74, v78
    v_mul_f32 v75, v75, v79
    v_cvt_pk_bf16_f32 v90, v72, v73
    v_cvt_pk_bf16_f32 v91, v74, v75
    s_add_u32 s80, s14, 1024
    buffer_store_dwordx4 v[88:91], v4, s[60:63], s80 offen sc1
    v_accvgpr_read_b32 v80, a52
    v_accvgpr_read_b32 v81, a53
    v_accvgpr_read_b32 v82, a54
    v_accvgpr_read_b32 v83, a55
    v_mul_f32 v80, v80, v67
    v_mul_f32 v81, v81, v67
    v_mul_f32 v82, v82, v67
    v_mul_f32 v83, v83, v67
    v_fma_f32 v80, -v66, v28, v80
    v_fma_f32 v81, -v66, v29, v81
    v_fma_f32 v82, -v66, v30, v82
    v_fma_f32 v83, -v66, v31, v83
    v_cvt_pk_bf16_f32 v84, v80, v81
    v_cvt_pk_bf16_f32 v85, v82, v83
    v_lshlrev_b32 v80, 16, v84
    v_and_b32 v81, s92, v84
    v_lshlrev_b32 v82, 16, v85
    v_and_b32 v83, s92, v85
    v_mul_f32 v84, s93, v80
    v_mul_f32 v85, s93, v81
    v_mul_f32 v86, s93, v82
    v_mul_f32 v87, s93, v83
    v_exp_f32 v84, v84
    v_exp_f32 v85, v85
    v_exp_f32 v86, v86
    v_exp_f32 v87, v87
    s_nop 0
    v_add_f32 v84, 1.0, v84
    v_add_f32 v85, 1.0, v85
    v_add_f32 v86, 1.0, v86
    v_add_f32 v87, 1.0, v87
    v_rcp_f32 v84, v84
    v_rcp_f32 v85, v85
    v_rcp_f32 v86, v86
    v_rcp_f32 v87, v87
    s_nop 0
    v_mul_f32 v80, v80, v84
    v_mul_f32 v81, v81, v85
    v_mul_f32 v82, v82, v86
    v_mul_f32 v83, v83, v87
    v_cvt_pk_bf16_f32 v94, v80, v81
    v_cvt_pk_bf16_f32 v95, v82, v83
    s_add_u32 s80, s14, 56320
    buffer_store_dwordx4 v[92:95], v4, s[60:63], s80 offen sc1
    v_accvgpr_read_b32 v72, a56
    v_accvgpr_read_b32 v73, a57
    v_accvgpr_read_b32 v74, a58
    v_accvgpr_read_b32 v75, a59
    v_mul_f32 v72, v72, v69
    v_mul_f32 v73, v73, v69
    v_mul_f32 v74, v74, v69
    v_mul_f32 v75, v75, v69
    v_fma_f32 v72, -v68, v28, v72
    v_fma_f32 v73, -v68, v29, v73
    v_fma_f32 v74, -v68, v30, v74
    v_fma_f32 v75, -v68, v31, v75
    v_cvt_pk_bf16_f32 v76, v72, v73
    v_cvt_pk_bf16_f32 v77, v74, v75
    v_lshlrev_b32 v72, 16, v76
    v_and_b32 v73, s92, v76
    v_lshlrev_b32 v74, 16, v77
    v_and_b32 v75, s92, v77
    v_mul_f32 v76, s93, v72
    v_mul_f32 v77, s93, v73
    v_mul_f32 v78, s93, v74
    v_mul_f32 v79, s93, v75
    v_exp_f32 v76, v76
    v_exp_f32 v77, v77
    v_exp_f32 v78, v78
    v_exp_f32 v79, v79
    s_nop 0
    v_add_f32 v76, 1.0, v76
    v_add_f32 v77, 1.0, v77
    v_add_f32 v78, 1.0, v78
    v_add_f32 v79, 1.0, v79
    v_rcp_f32 v76, v76
    v_rcp_f32 v77, v77
    v_rcp_f32 v78, v78
    v_rcp_f32 v79, v79
    s_nop 0
    v_mul_f32 v72, v72, v76
    v_mul_f32 v73, v73, v77
    v_mul_f32 v74, v74, v78
    v_mul_f32 v75, v75, v79
    v_cvt_pk_bf16_f32 v98, v72, v73
    v_cvt_pk_bf16_f32 v99, v74, v75
    s_add_u32 s80, s14, 111616
    buffer_store_dwordx4 v[96:99], v4, s[60:63], s80 offen sc1
    v_accvgpr_read_b32 v80, a60
    v_accvgpr_read_b32 v81, a61
    v_accvgpr_read_b32 v82, a62
    v_accvgpr_read_b32 v83, a63
    v_mul_f32 v80, v80, v71
    v_mul_f32 v81, v81, v71
    v_mul_f32 v82, v82, v71
    v_mul_f32 v83, v83, v71
    v_fma_f32 v80, -v70, v28, v80
    v_fma_f32 v81, -v70, v29, v81
    v_fma_f32 v82, -v70, v30, v82
    v_fma_f32 v83, -v70, v31, v83
    v_cvt_pk_bf16_f32 v84, v80, v81
    v_cvt_pk_bf16_f32 v85, v82, v83
    v_lshlrev_b32 v80, 16, v84
    v_and_b32 v81, s92, v84
    v_lshlrev_b32 v82, 16, v85
    v_and_b32 v83, s92, v85
    v_mul_f32 v84, s93, v80
    v_mul_f32 v85, s93, v81
    v_mul_f32 v86, s93, v82
    v_mul_f32 v87, s93, v83
    v_exp_f32 v84, v84
    v_exp_f32 v85, v85
    v_exp_f32 v86, v86
    v_exp_f32 v87, v87
    s_nop 0
    v_add_f32 v84, 1.0, v84
    v_add_f32 v85, 1.0, v85
    v_add_f32 v86, 1.0, v86
    v_add_f32 v87, 1.0, v87
    v_rcp_f32 v84, v84
    v_rcp_f32 v85, v85
    v_rcp_f32 v86, v86
    v_rcp_f32 v87, v87
    s_nop 0
    v_mul_f32 v80, v80, v84
    v_mul_f32 v81, v81, v85
    v_mul_f32 v82, v82, v86
    v_mul_f32 v83, v83, v87
    v_cvt_pk_bf16_f32 v102, v80, v81
    v_cvt_pk_bf16_f32 v103, v82, v83
    s_add_u32 s80, s14, 166912
    buffer_store_dwordx4 v[100:103], v4, s[60:63], s80 offen sc1
    s_endpgm
g1_w3:
    buffer_load_dwordx4 a[64:67], v9, s[52:55], s70 offen offset:0
    buffer_load_dwordx4 a[68:71], v10, s[52:55], s70 offen offset:0
    buffer_load_dwordx4 a[72:75], v9, s[52:55], s70 offen offset:1024
    buffer_load_dwordx4 a[76:79], v10, s[52:55], s70 offen offset:1024
    v_accvgpr_write_b32 a0, 0
    v_accvgpr_write_b32 a1, 0
    v_accvgpr_write_b32 a2, 0
    v_accvgpr_write_b32 a3, 0
    v_accvgpr_write_b32 a4, 0
    v_accvgpr_write_b32 a5, 0
    v_accvgpr_write_b32 a6, 0
    v_accvgpr_write_b32 a7, 0
    v_accvgpr_write_b32 a8, 0
    v_accvgpr_write_b32 a9, 0
    v_accvgpr_write_b32 a10, 0
    v_accvgpr_write_b32 a11, 0
    v_accvgpr_write_b32 a12, 0
    v_accvgpr_write_b32 a13, 0
    v_accvgpr_write_b32 a14, 0
    v_accvgpr_write_b32 a15, 0
    v_accvgpr_write_b32 a16, 0
    v_accvgpr_write_b32 a17, 0
    v_accvgpr_write_b32 a18, 0
    v_accvgpr_write_b32 a19, 0
    v_accvgpr_write_b32 a20, 0
    v_accvgpr_write_b32 a21, 0
    v_accvgpr_write_b32 a22, 0
    v_accvgpr_write_b32 a23, 0
    v_accvgpr_write_b32 a24, 0
    v_accvgpr_write_b32 a25, 0
    v_accvgpr_write_b32 a26, 0
    v_accvgpr_write_b32 a27, 0
    v_accvgpr_write_b32 a28, 0
    v_accvgpr_write_b32 a29, 0
    v_accvgpr_write_b32 a30, 0
    v_accvgpr_write_b32 a31, 0
    s_barrier
    buffer_load_dwordx4 a[80:83], v9, s[52:55], s70 offen offset:2048
    buffer_load_dwordx4 a[84:87], v10, s[52:55], s70 offen offset:2048
    buffer_load_dwordx4 a[88:91], v9, s[52:55], s70 offen offset:3072
    buffer_load_dwordx4 a[92:95], v10, s[52:55], s70 offen offset:3072
    buffer_load_dwordx4 a[96:99], v9, s[52:55], s71 offen offset:0
    buffer_load_dwordx4 a[100:103], v10, s[52:55], s71 offen offset:0
    buffer_load_dwordx4 a[104:107], v9, s[52:55], s71 offen offset:1024
    buffer_load_dwordx4 a[108:111], v10, s[52:55], s71 offen offset:1024
    buffer_load_dwordx4 a[112:115], v9, s[52:55], s71 offen offset:2048
    buffer_load_dwordx4 a[116:119], v10, s[52:55], s71 offen offset:2048
    buffer_load_dwordx4 a[120:123], v9, s[52:55], s71 offen offset:3072
    buffer_load_dwordx4 a[124:127], v10, s[52:55], s71 offen offset:3072
    buffer_load_dwordx4 a[128:131], v9, s[52:55], s72 offen offset:0
    buffer_load_dwordx4 a[132:135], v10, s[52:55], s72 offen offset:0
    buffer_load_dwordx4 a[136:139], v9, s[52:55], s72 offen offset:1024
    buffer_load_dwordx4 a[140:143], v10, s[52:55], s72 offen offset:1024
    buffer_load_dwordx4 a[144:147], v9, s[52:55], s72 offen offset:2048
    buffer_load_dwordx4 a[148:151], v10, s[52:55], s72 offen offset:2048
    s_add_u32 s64, s38, 0xc90000
    s_addc_u32 s65, s39, 0
    s_mov_b32 s66, 0x1b00
    s_mov_b32 s67, 0x00020000
    buffer_load_dwordx4 v[16:19], v15, s[64:67], s83 offen offset:0
    buffer_load_dwordx4 v[20:23], v15, s[64:67], s83 offen offset:64
    s_add_u32 s60, s38, 0x1800000
    s_addc_u32 s61, s39, 0
    s_mov_b32 s62, 0x6c0000
    s_mov_b32 s63, 0x00020000
    s_mov_b32 s93, 0xbfb8aa3b
    v_lshlrev_b32 v14, 3, v6
    v_add_u32 v14, 81920, v14
    s_lshl_b32 s14, s6, 2
    s_mul_i32 s14, s14, 54
    s_lshr_b32 s15, s8, 1
    s_add_u32 s14, s14, s15
    s_lshl_b32 s14, s14, 10
    s_barrier
    ds_read_b128 v[32:35], v4 offset:0
    ds_read_b128 v[36:39], v4 offset:1024
    ds_read_b128 v[40:43], v4 offset:2048
    ds_read_b128 v[44:47], v4 offset:3072
    ds_read_b128 v[48:51], v4 offset:4096
    ds_read_b128 v[52:55], v4 offset:5120
    ds_read_b128 v[56:59], v4 offset:6144
    ds_read_b128 v[60:63], v4 offset:7168
    s_waitcnt lgkmcnt(4)
    s_waitcnt vmcnt(23)
    v_mfma_f32_16x16x32_bf16 a[0:3], a[64:67], v[32:35], a[0:3]
    v_mfma_f32_16x16x32_bf16 a[4:7], a[64:67], v[36:39], a[4:7]
    v_mfma_f32_16x16x32_bf16 a[8:11], a[64:67], v[40:43], a[8:11]
    v_mfma_f32_16x16x32_bf16 a[12:15], a[64:67], v[44:47], a[12:15]
    buffer_load_dwordx4 a[64:67], v9, s[52:55], s72 offen offset:3072
    s_waitcnt vmcnt(23)
    v_mfma_f32_16x16x32_bf16 a[16:19], a[68:71], v[32:35], a[16:19]
    v_mfma_f32_16x16x32_bf16 a[20:23], a[68:71], v[36:39], a[20:23]
    v_mfma_f32_16x16x32_bf16 a[24:27], a[68:71], v[40:43], a[24:27]
    v_mfma_f32_16x16x32_bf16 a[28:31], a[68:71], v[44:47], a[28:31]
    buffer_load_dwordx4 a[68:71], v10, s[52:55], s72 offen offset:3072
    ds_read_b128 v[32:35], v4 offset:8192
    ds_read_b128 v[36:39], v4 offset:9216
    ds_read_b128 v[40:43], v4 offset:10240
    ds_read_b128 v[44:47], v4 offset:11264
    s_waitcnt lgkmcnt(4)
    s_waitcnt vmcnt(23)
    v_mfma_f32_16x16x32_bf16 a[0:3], a[72:75], v[48:51], a[0:3]
    v_mfma_f32_16x16x32_bf16 a[4:7], a[72:75], v[52:55], a[4:7]
    v_mfma_f32_16x16x32_bf16 a[8:11], a[72:75], v[56:59], a[8:11]
    v_mfma_f32_16x16x32_bf16 a[12:15], a[72:75], v[60:63], a[12:15]
    buffer_load_dwordx4 a[72:75], v9, s[52:55], s73 offen offset:0
    s_waitcnt vmcnt(23)
    v_mfma_f32_16x16x32_bf16 a[16:19], a[76:79], v[48:51], a[16:19]
    v_mfma_f32_16x16x32_bf16 a[20:23], a[76:79], v[52:55], a[20:23]
    v_mfma_f32_16x16x32_bf16 a[24:27], a[76:79], v[56:59], a[24:27]
    v_mfma_f32_16x16x32_bf16 a[28:31], a[76:79], v[60:63], a[28:31]
    buffer_load_dwordx4 a[76:79], v10, s[52:55], s73 offen offset:0
    s_barrier
    ds_read_b128 v[48:51], v4 offset:12288
    ds_read_b128 v[52:55], v4 offset:13312
    ds_read_b128 v[56:59], v4 offset:14336
    ds_read_b128 v[60:63], v4 offset:15360
    s_waitcnt lgkmcnt(4)
    s_waitcnt vmcnt(23)
    v_mfma_f32_16x16x32_bf16 a[0:3], a[80:83], v[32:35], a[0:3]
    v_mfma_f32_16x16x32_bf16 a[4:7], a[80:83], v[36:39], a[4:7]
    v_mfma_f32_16x16x32_bf16 a[8:11], a[80:83], v[40:43], a[8:11]
    v_mfma_f32_16x16x32_bf16 a[12:15], a[80:83], v[44:47], a[12:15]
    buffer_load_dwordx4 a[80:83], v9, s[52:55], s73 offen offset:1024
    s_waitcnt vmcnt(23)
    v_mfma_f32_16x16x32_bf16 a[16:19], a[84:87], v[32:35], a[16:19]
    v_mfma_f32_16x16x32_bf16 a[20:23], a[84:87], v[36:39], a[20:23]
    v_mfma_f32_16x16x32_bf16 a[24:27], a[84:87], v[40:43], a[24:27]
    v_mfma_f32_16x16x32_bf16 a[28:31], a[84:87], v[44:47], a[28:31]
    buffer_load_dwordx4 a[84:87], v10, s[52:55], s73 offen offset:1024
    ds_read_b128 v[32:35], v4 offset:16384
    ds_read_b128 v[36:39], v4 offset:17408
    ds_read_b128 v[40:43], v4 offset:18432
    ds_read_b128 v[44:47], v4 offset:19456
    s_waitcnt lgkmcnt(4)
    s_waitcnt vmcnt(23)
    v_mfma_f32_16x16x32_bf16 a[0:3], a[88:91], v[48:51], a[0:3]
    v_mfma_f32_16x16x32_bf16 a[4:7], a[88:91], v[52:55], a[4:7]
    v_mfma_f32_16x16x32_bf16 a[8:11], a[88:91], v[56:59], a[8:11]
    v_mfma_f32_16x16x32_bf16 a[12:15], a[88:91], v[60:63], a[12:15]
    buffer_load_dwordx4 a[88:91], v9, s[52:55], s73 offen offset:2048
    s_waitcnt vmcnt(23)
    v_mfma_f32_16x16x32_bf16 a[16:19], a[92:95], v[48:51], a[16:19]
    v_mfma_f32_16x16x32_bf16 a[20:23], a[92:95], v[52:55], a[20:23]
    v_mfma_f32_16x16x32_bf16 a[24:27], a[92:95], v[56:59], a[24:27]
    v_mfma_f32_16x16x32_bf16 a[28:31], a[92:95], v[60:63], a[28:31]
    buffer_load_dwordx4 a[92:95], v10, s[52:55], s73 offen offset:2048
    s_barrier
    ds_read_b128 v[48:51], v4 offset:20480
    ds_read_b128 v[52:55], v4 offset:21504
    ds_read_b128 v[56:59], v4 offset:22528
    ds_read_b128 v[60:63], v4 offset:23552
    s_waitcnt lgkmcnt(4)
    s_waitcnt vmcnt(23)
    v_mfma_f32_16x16x32_bf16 a[0:3], a[96:99], v[32:35], a[0:3]
    v_mfma_f32_16x16x32_bf16 a[4:7], a[96:99], v[36:39], a[4:7]
    v_mfma_f32_16x16x32_bf16 a[8:11], a[96:99], v[40:43], a[8:11]
    v_mfma_f32_16x16x32_bf16 a[12:15], a[96:99], v[44:47], a[12:15]
    buffer_load_dwordx4 a[96:99], v9, s[52:55], s73 offen offset:3072
    s_waitcnt vmcnt(23)
    v_mfma_f32_16x16x32_bf16 a[16:19], a[100:103], v[32:35], a[16:19]
    v_mfma_f32_16x16x32_bf16 a[20:23], a[100:103], v[36:39], a[20:23]
    v_mfma_f32_16x16x32_bf16 a[24:27], a[100:103], v[40:43], a[24:27]
    v_mfma_f32_16x16x32_bf16 a[28:31], a[100:103], v[44:47], a[28:31]
    buffer_load_dwordx4 a[100:103], v10, s[52:55], s73 offen offset:3072
    ds_read_b128 v[32:35], v4 offset:24576
    ds_read_b128 v[36:39], v4 offset:25600
    ds_read_b128 v[40:43], v4 offset:26624
    ds_read_b128 v[44:47], v4 offset:27648
    s_waitcnt lgkmcnt(4)
    s_waitcnt vmcnt(23)
    v_mfma_f32_16x16x32_bf16 a[0:3], a[104:107], v[48:51], a[0:3]
    v_mfma_f32_16x16x32_bf16 a[4:7], a[104:107], v[52:55], a[4:7]
    v_mfma_f32_16x16x32_bf16 a[8:11], a[104:107], v[56:59], a[8:11]
    v_mfma_f32_16x16x32_bf16 a[12:15], a[104:107], v[60:63], a[12:15]
    buffer_load_dwordx4 a[104:107], v9, s[52:55], s74 offen offset:0
    s_waitcnt vmcnt(23)
    v_mfma_f32_16x16x32_bf16 a[16:19], a[108:111], v[48:51], a[16:19]
    v_mfma_f32_16x16x32_bf16 a[20:23], a[108:111], v[52:55], a[20:23]
    v_mfma_f32_16x16x32_bf16 a[24:27], a[108:111], v[56:59], a[24:27]
    v_mfma_f32_16x16x32_bf16 a[28:31], a[108:111], v[60:63], a[28:31]
    buffer_load_dwordx4 a[108:111], v10, s[52:55], s74 offen offset:0
    s_barrier
    ds_read_b128 v[48:51], v4 offset:28672
    ds_read_b128 v[52:55], v4 offset:29696
    ds_read_b128 v[56:59], v4 offset:30720
    ds_read_b128 v[60:63], v4 offset:31744
    s_waitcnt lgkmcnt(4)
    s_waitcnt vmcnt(23)
    v_mfma_f32_16x16x32_bf16 a[0:3], a[112:115], v[32:35], a[0:3]
    v_mfma_f32_16x16x32_bf16 a[4:7], a[112:115], v[36:39], a[4:7]
    v_mfma_f32_16x16x32_bf16 a[8:11], a[112:115], v[40:43], a[8:11]
    v_mfma_f32_16x16x32_bf16 a[12:15], a[112:115], v[44:47], a[12:15]
    buffer_load_dwordx4 a[112:115], v9, s[52:55], s74 offen offset:1024
    s_waitcnt vmcnt(23)
    v_mfma_f32_16x16x32_bf16 a[16:19], a[116:119], v[32:35], a[16:19]
    v_mfma_f32_16x16x32_bf16 a[20:23], a[116:119], v[36:39], a[20:23]
    v_mfma_f32_16x16x32_bf16 a[24:27], a[116:119], v[40:43], a[24:27]
    v_mfma_f32_16x16x32_bf16 a[28:31], a[116:119], v[44:47], a[28:31]
    buffer_load_dwordx4 a[116:119], v10, s[52:55], s74 offen offset:1024
    ds_read_b128 v[32:35], v4 offset:32768
    ds_read_b128 v[36:39], v4 offset:33792
    ds_read_b128 v[40:43], v4 offset:34816
    ds_read_b128 v[44:47], v4 offset:35840
    s_waitcnt lgkmcnt(4)
    s_waitcnt vmcnt(23)
    v_mfma_f32_16x16x32_bf16 a[0:3], a[120:123], v[48:51], a[0:3]
    v_mfma_f32_16x16x32_bf16 a[4:7], a[120:123], v[52:55], a[4:7]
    v_mfma_f32_16x16x32_bf16 a[8:11], a[120:123], v[56:59], a[8:11]
    v_mfma_f32_16x16x32_bf16 a[12:15], a[120:123], v[60:63], a[12:15]
    buffer_load_dwordx4 a[120:123], v9, s[52:55], s74 offen offset:2048
    s_waitcnt vmcnt(23)
    v_mfma_f32_16x16x32_bf16 a[16:19], a[124:127], v[48:51], a[16:19]
    v_mfma_f32_16x16x32_bf16 a[20:23], a[124:127], v[52:55], a[20:23]
    v_mfma_f32_16x16x32_bf16 a[24:27], a[124:127], v[56:59], a[24:27]
    v_mfma_f32_16x16x32_bf16 a[28:31], a[124:127], v[60:63], a[28:31]
    buffer_load_dwordx4 a[124:127], v10, s[52:55], s74 offen offset:2048
    s_barrier
    ds_read_b128 v[48:51], v4 offset:36864
    ds_read_b128 v[52:55], v4 offset:37888
    ds_read_b128 v[56:59], v4 offset:38912
    ds_read_b128 v[60:63], v4 offset:39936
    s_waitcnt lgkmcnt(4)
    s_waitcnt vmcnt(23)
    v_mfma_f32_16x16x32_bf16 a[0:3], a[128:131], v[32:35], a[0:3]
    v_mfma_f32_16x16x32_bf16 a[4:7], a[128:131], v[36:39], a[4:7]
    v_mfma_f32_16x16x32_bf16 a[8:11], a[128:131], v[40:43], a[8:11]
    v_mfma_f32_16x16x32_bf16 a[12:15], a[128:131], v[44:47], a[12:15]
    buffer_load_dwordx4 a[128:131], v9, s[52:55], s74 offen offset:3072
    s_waitcnt vmcnt(23)
    v_mfma_f32_16x16x32_bf16 a[16:19], a[132:135], v[32:35], a[16:19]
    v_mfma_f32_16x16x32_bf16 a[20:23], a[132:135], v[36:39], a[20:23]
    v_mfma_f32_16x16x32_bf16 a[24:27], a[132:135], v[40:43], a[24:27]
    v_mfma_f32_16x16x32_bf16 a[28:31], a[132:135], v[44:47], a[28:31]
    buffer_load_dwordx4 a[132:135], v10, s[52:55], s74 offen offset:3072
    ds_read_b128 v[32:35], v13 offset:0
    ds_read_b128 v[36:39], v13 offset:1024
    ds_read_b128 v[40:43], v13 offset:2048
    ds_read_b128 v[44:47], v13 offset:3072
    s_waitcnt lgkmcnt(4)
    s_waitcnt vmcnt(23)
    v_mfma_f32_16x16x32_bf16 a[0:3], a[136:139], v[48:51], a[0:3]
    v_mfma_f32_16x16x32_bf16 a[4:7], a[136:139], v[52:55], a[4:7]
    v_mfma_f32_16x16x32_bf16 a[8:11], a[136:139], v[56:59], a[8:11]
    v_mfma_f32_16x16x32_bf16 a[12:15], a[136:139], v[60:63], a[12:15]
    s_waitcnt vmcnt(22)
    v_mfma_f32_16x16x32_bf16 a[16:19], a[140:143], v[48:51], a[16:19]
    v_mfma_f32_16x16x32_bf16 a[20:23], a[140:143], v[52:55], a[20:23]
    v_mfma_f32_16x16x32_bf16 a[24:27], a[140:143], v[56:59], a[24:27]
    v_mfma_f32_16x16x32_bf16 a[28:31], a[140:143], v[60:63], a[28:31]
    s_barrier
    ds_read_b128 v[48:51], v13 offset:4096
    ds_read_b128 v[52:55], v13 offset:5120
    ds_read_b128 v[56:59], v13 offset:6144
    ds_read_b128 v[60:63], v13 offset:7168
    s_waitcnt lgkmcnt(4)
    s_waitcnt vmcnt(21)
    v_mfma_f32_16x16x32_bf16 a[0:3], a[144:147], v[32:35], a[0:3]
    v_mfma_f32_16x16x32_bf16 a[4:7], a[144:147], v[36:39], a[4:7]
    v_mfma_f32_16x16x32_bf16 a[8:11], a[144:147], v[40:43], a[8:11]
    v_mfma_f32_16x16x32_bf16 a[12:15], a[144:147], v[44:47], a[12:15]
    s_waitcnt vmcnt(20)
    v_mfma_f32_16x16x32_bf16 a[16:19], a[148:151], v[32:35], a[16:19]
    v_mfma_f32_16x16x32_bf16 a[20:23], a[148:151], v[36:39], a[20:23]
    v_mfma_f32_16x16x32_bf16 a[24:27], a[148:151], v[40:43], a[24:27]
    v_mfma_f32_16x16x32_bf16 a[28:31], a[148:151], v[44:47], a[28:31]
    ds_read_b128 v[32:35], v13 offset:8192
    ds_read_b128 v[36:39], v13 offset:9216
    ds_read_b128 v[40:43], v13 offset:10240
    ds_read_b128 v[44:47], v13 offset:11264
    s_waitcnt lgkmcnt(4)
    s_waitcnt vmcnt(17)
    v_mfma_f32_16x16x32_bf16 a[0:3], a[64:67], v[48:51], a[0:3]
    v_mfma_f32_16x16x32_bf16 a[4:7], a[64:67], v[52:55], a[4:7]
    v_mfma_f32_16x16x32_bf16 a[8:11], a[64:67], v[56:59], a[8:11]
    v_mfma_f32_16x16x32_bf16 a[12:15], a[64:67], v[60:63], a[12:15]
    s_waitcnt vmcnt(16)
    v_mfma_f32_16x16x32_bf16 a[16:19], a[68:71], v[48:51], a[16:19]
    v_mfma_f32_16x16x32_bf16 a[20:23], a[68:71], v[52:55], a[20:23]
    v_mfma_f32_16x16x32_bf16 a[24:27], a[68:71], v[56:59], a[24:27]
    v_mfma_f32_16x16x32_bf16 a[28:31], a[68:71], v[60:63], a[28:31]
    s_barrier
    ds_read_b128 v[48:51], v13 offset:12288
    ds_read_b128 v[52:55], v13 offset:13312
    ds_read_b128 v[56:59], v13 offset:14336
    ds_read_b128 v[60:63], v13 offset:15360
    s_waitcnt lgkmcnt(4)
    s_waitcnt vmcnt(15)
    v_mfma_f32_16x16x32_bf16 a[0:3], a[72:75], v[32:35], a[0:3]
    v_mfma_f32_16x16x32_bf16 a[4:7], a[72:75], v[36:39], a[4:7]
    v_mfma_f32_16x16x32_bf16 a[8:11], a[72:75], v[40:43], a[8:11]
    v_mfma_f32_16x16x32_bf16 a[12:15], a[72:75], v[44:47], a[12:15]
    s_waitcnt vmcnt(14)
    v_mfma_f32_16x16x32_bf16 a[16:19], a[76:79], v[32:35], a[16:19]
    v_mfma_f32_16x16x32_bf16 a[20:23], a[76:79], v[36:39], a[20:23]
    v_mfma_f32_16x16x32_bf16 a[24:27], a[76:79], v[40:43], a[24:27]
    v_mfma_f32_16x16x32_bf16 a[28:31], a[76:79], v[44:47], a[28:31]
    ds_read_b128 v[32:35], v13 offset:16384
    ds_read_b128 v[36:39], v13 offset:17408
    ds_read_b128 v[40:43], v13 offset:18432
    ds_read_b128 v[44:47], v13 offset:19456
    s_waitcnt lgkmcnt(4)
    s_waitcnt vmcnt(13)
    v_mfma_f32_16x16x32_bf16 a[0:3], a[80:83], v[48:51], a[0:3]
    v_mfma_f32_16x16x32_bf16 a[4:7], a[80:83], v[52:55], a[4:7]
    v_mfma_f32_16x16x32_bf16 a[8:11], a[80:83], v[56:59], a[8:11]
    v_mfma_f32_16x16x32_bf16 a[12:15], a[80:83], v[60:63], a[12:15]
    s_waitcnt vmcnt(12)
    v_mfma_f32_16x16x32_bf16 a[16:19], a[84:87], v[48:51], a[16:19]
    v_mfma_f32_16x16x32_bf16 a[20:23], a[84:87], v[52:55], a[20:23]
    v_mfma_f32_16x16x32_bf16 a[24:27], a[84:87], v[56:59], a[24:27]
    v_mfma_f32_16x16x32_bf16 a[28:31], a[84:87], v[60:63], a[28:31]
    s_barrier
    ds_read_b128 v[48:51], v13 offset:20480
    ds_read_b128 v[52:55], v13 offset:21504
    ds_read_b128 v[56:59], v13 offset:22528
    ds_read_b128 v[60:63], v13 offset:23552
    s_waitcnt lgkmcnt(4)
    s_waitcnt vmcnt(11)
    v_mfma_f32_16x16x32_bf16 a[0:3], a[88:91], v[32:35], a[0:3]
    v_mfma_f32_16x16x32_bf16 a[4:7], a[88:91], v[36:39], a[4:7]
    v_mfma_f32_16x16x32_bf16 a[8:11], a[88:91], v[40:43], a[8:11]
    v_mfma_f32_16x16x32_bf16 a[12:15], a[88:91], v[44:47], a[12:15]
    s_waitcnt vmcnt(10)
    v_mfma_f32_16x16x32_bf16 a[16:19], a[92:95], v[32:35], a[16:19]
    v_mfma_f32_16x16x32_bf16 a[20:23], a[92:95], v[36:39], a[20:23]
    v_mfma_f32_16x16x32_bf16 a[24:27], a[92:95], v[40:43], a[24:27]
    v_mfma_f32_16x16x32_bf16 a[28:31], a[92:95], v[44:47], a[28:31]
    ds_read_b128 v[32:35], v13 offset:24576
    ds_read_b128 v[36:39], v13 offset:25600
    ds_read_b128 v[40:43], v13 offset:26624
    ds_read_b128 v[44:47], v13 offset:27648
    s_waitcnt lgkmcnt(4)
    s_waitcnt vmcnt(9)
    v_mfma_f32_16x16x32_bf16 a[0:3], a[96:99], v[48:51], a[0:3]
    v_mfma_f32_16x16x32_bf16 a[4:7], a[96:99], v[52:55], a[4:7]
    v_mfma_f32_16x16x32_bf16 a[8:11], a[96:99], v[56:59], a[8:11]
    v_mfma_f32_16x16x32_bf16 a[12:15], a[96:99], v[60:63], a[12:15]
    s_waitcnt vmcnt(8)
    v_mfma_f32_16x16x32_bf16 a[16:19], a[100:103], v[48:51], a[16:19]
    v_mfma_f32_16x16x32_bf16 a[20:23], a[100:103], v[52:55], a[20:23]
    v_mfma_f32_16x16x32_bf16 a[24:27], a[100:103], v[56:59], a[24:27]
    v_mfma_f32_16x16x32_bf16 a[28:31], a[100:103], v[60:63], a[28:31]
    s_barrier
    ds_read_b128 v[48:51], v13 offset:28672
    ds_read_b128 v[52:55], v13 offset:29696
    ds_read_b128 v[56:59], v13 offset:30720
    ds_read_b128 v[60:63], v13 offset:31744
    s_waitcnt lgkmcnt(4)
    s_waitcnt vmcnt(7)
    v_mfma_f32_16x16x32_bf16 a[0:3], a[104:107], v[32:35], a[0:3]
    v_mfma_f32_16x16x32_bf16 a[4:7], a[104:107], v[36:39], a[4:7]
    v_mfma_f32_16x16x32_bf16 a[8:11], a[104:107], v[40:43], a[8:11]
    v_mfma_f32_16x16x32_bf16 a[12:15], a[104:107], v[44:47], a[12:15]
    s_waitcnt vmcnt(6)
    v_mfma_f32_16x16x32_bf16 a[16:19], a[108:111], v[32:35], a[16:19]
    v_mfma_f32_16x16x32_bf16 a[20:23], a[108:111], v[36:39], a[20:23]
    v_mfma_f32_16x16x32_bf16 a[24:27], a[108:111], v[40:43], a[24:27]
    v_mfma_f32_16x16x32_bf16 a[28:31], a[108:111], v[44:47], a[28:31]
    ds_read_b128 v[32:35], v13 offset:32768
    ds_read_b128 v[36:39], v13 offset:33792
    ds_read_b128 v[40:43], v13 offset:34816
    ds_read_b128 v[44:47], v13 offset:35840
    s_waitcnt lgkmcnt(4)
    s_waitcnt vmcnt(5)
    v_mfma_f32_16x16x32_bf16 a[0:3], a[112:115], v[48:51], a[0:3]
    v_mfma_f32_16x16x32_bf16 a[4:7], a[112:115], v[52:55], a[4:7]
    v_mfma_f32_16x16x32_bf16 a[8:11], a[112:115], v[56:59], a[8:11]
    v_mfma_f32_16x16x32_bf16 a[12:15], a[112:115], v[60:63], a[12:15]
    s_waitcnt vmcnt(4)
    v_mfma_f32_16x16x32_bf16 a[16:19], a[116:119], v[48:51], a[16:19]
    v_mfma_f32_16x16x32_bf16 a[20:23], a[116:119], v[52:55], a[20:23]
    v_mfma_f32_16x16x32_bf16 a[24:27], a[116:119], v[56:59], a[24:27]
    v_mfma_f32_16x16x32_bf16 a[28:31], a[116:119], v[60:63], a[28:31]
    ds_read_b128 v[48:51], v13 offset:36864
    ds_read_b128 v[52:55], v13 offset:37888
    ds_read_b128 v[56:59], v13 offset:38912
    ds_read_b128 v[60:63], v13 offset:39936
    s_waitcnt lgkmcnt(4)
    s_waitcnt vmcnt(3)
    v_mfma_f32_16x16x32_bf16 a[0:3], a[120:123], v[32:35], a[0:3]
    v_mfma_f32_16x16x32_bf16 a[4:7], a[120:123], v[36:39], a[4:7]
    v_mfma_f32_16x16x32_bf16 a[8:11], a[120:123], v[40:43], a[8:11]
    v_mfma_f32_16x16x32_bf16 a[12:15], a[120:123], v[44:47], a[12:15]
    s_waitcnt vmcnt(2)
    v_mfma_f32_16x16x32_bf16 a[16:19], a[124:127], v[32:35], a[16:19]
    v_mfma_f32_16x16x32_bf16 a[20:23], a[124:127], v[36:39], a[20:23]
    v_mfma_f32_16x16x32_bf16 a[24:27], a[124:127], v[40:43], a[24:27]
    v_mfma_f32_16x16x32_bf16 a[28:31], a[124:127], v[44:47], a[28:31]
    s_waitcnt lgkmcnt(0)
    s_waitcnt vmcnt(1)
    v_mfma_f32_16x16x32_bf16 a[0:3], a[128:131], v[48:51], a[0:3]
    v_mfma_f32_16x16x32_bf16 a[4:7], a[128:131], v[52:55], a[4:7]
    v_mfma_f32_16x16x32_bf16 a[8:11], a[128:131], v[56:59], a[8:11]
    v_mfma_f32_16x16x32_bf16 a[12:15], a[128:131], v[60:63], a[12:15]
    s_waitcnt vmcnt(0)
    v_mfma_f32_16x16x32_bf16 a[16:19], a[132:135], v[48:51], a[16:19]
    v_mfma_f32_16x16x32_bf16 a[20:23], a[132:135], v[52:55], a[20:23]
    v_mfma_f32_16x16x32_bf16 a[24:27], a[132:135], v[56:59], a[24:27]
    v_mfma_f32_16x16x32_bf16 a[28:31], a[132:135], v[60:63], a[28:31]
    s_barrier
    ds_read_b64 v[64:65], v14 offset:0
    ds_read_b64 v[66:67], v14 offset:128
    ds_read_b64 v[68:69], v14 offset:256
    ds_read_b64 v[70:71], v14 offset:384
    s_waitcnt lgkmcnt(0)
    v_accvgpr_read_b32 v72, a0
    v_accvgpr_read_b32 v73, a1
    v_accvgpr_read_b32 v74, a2
    v_accvgpr_read_b32 v75, a3
    v_mul_f32 v72, v72, v65
    v_mul_f32 v73, v73, v65
    v_mul_f32 v74, v74, v65
    v_mul_f32 v75, v75, v65
    v_fma_f32 v72, -v64, v16, v72
    v_fma_f32 v73, -v64, v17, v73
    v_fma_f32 v74, -v64, v18, v74
    v_fma_f32 v75, -v64, v19, v75
    v_cvt_pk_bf16_f32 v76, v72, v73
    v_cvt_pk_bf16_f32 v77, v74, v75
    v_lshlrev_b32 v72, 16, v76
    v_and_b32 v73, s92, v76
    v_lshlrev_b32 v74, 16, v77
    v_and_b32 v75, s92, v77
    v_mul_f32 v76, s93, v72
    v_mul_f32 v77, s93, v73
    v_mul_f32 v78, s93, v74
    v_mul_f32 v79, s93, v75
    v_exp_f32 v76, v76
    v_exp_f32 v77, v77
    v_exp_f32 v78, v78
    v_exp_f32 v79, v79
    s_nop 0
    v_add_f32 v76, 1.0, v76
    v_add_f32 v77, 1.0, v77
    v_add_f32 v78, 1.0, v78
    v_add_f32 v79, 1.0, v79
    v_rcp_f32 v76, v76
    v_rcp_f32 v77, v77
    v_rcp_f32 v78, v78
    v_rcp_f32 v79, v79
    s_nop 0
    v_mul_f32 v72, v72, v76
    v_mul_f32 v73, v73, v77
    v_mul_f32 v74, v74, v78
    v_mul_f32 v75, v75, v79
    v_cvt_pk_bf16_f32 v88, v72, v73
    v_cvt_pk_bf16_f32 v89, v74, v75
    v_accvgpr_read_b32 v80, a4
    v_accvgpr_read_b32 v81, a5
    v_accvgpr_read_b32 v82, a6
    v_accvgpr_read_b32 v83, a7
    v_mul_f32 v80, v80, v67
    v_mul_f32 v81, v81, v67
    v_mul_f32 v82, v82, v67
    v_mul_f32 v83, v83, v67
    v_fma_f32 v80, -v66, v16, v80
    v_fma_f32 v81, -v66, v17, v81
    v_fma_f32 v82, -v66, v18, v82
    v_fma_f32 v83, -v66, v19, v83
    v_cvt_pk_bf16_f32 v84, v80, v81
    v_cvt_pk_bf16_f32 v85, v82, v83
    v_lshlrev_b32 v80, 16, v84
    v_and_b32 v81, s92, v84
    v_lshlrev_b32 v82, 16, v85
    v_and_b32 v83, s92, v85
    v_mul_f32 v84, s93, v80
    v_mul_f32 v85, s93, v81
    v_mul_f32 v86, s93, v82
    v_mul_f32 v87, s93, v83
    v_exp_f32 v84, v84
    v_exp_f32 v85, v85
    v_exp_f32 v86, v86
    v_exp_f32 v87, v87
    s_nop 0
    v_add_f32 v84, 1.0, v84
    v_add_f32 v85, 1.0, v85
    v_add_f32 v86, 1.0, v86
    v_add_f32 v87, 1.0, v87
    v_rcp_f32 v84, v84
    v_rcp_f32 v85, v85
    v_rcp_f32 v86, v86
    v_rcp_f32 v87, v87
    s_nop 0
    v_mul_f32 v80, v80, v84
    v_mul_f32 v81, v81, v85
    v_mul_f32 v82, v82, v86
    v_mul_f32 v83, v83, v87
    v_cvt_pk_bf16_f32 v92, v80, v81
    v_cvt_pk_bf16_f32 v93, v82, v83
    v_accvgpr_read_b32 v72, a8
    v_accvgpr_read_b32 v73, a9
    v_accvgpr_read_b32 v74, a10
    v_accvgpr_read_b32 v75, a11
    v_mul_f32 v72, v72, v69
    v_mul_f32 v73, v73, v69
    v_mul_f32 v74, v74, v69
    v_mul_f32 v75, v75, v69
    v_fma_f32 v72, -v68, v16, v72
    v_fma_f32 v73, -v68, v17, v73
    v_fma_f32 v74, -v68, v18, v74
    v_fma_f32 v75, -v68, v19, v75
    v_cvt_pk_bf16_f32 v76, v72, v73
    v_cvt_pk_bf16_f32 v77, v74, v75
    v_lshlrev_b32 v72, 16, v76
    v_and_b32 v73, s92, v76
    v_lshlrev_b32 v74, 16, v77
    v_and_b32 v75, s92, v77
    v_mul_f32 v76, s93, v72
    v_mul_f32 v77, s93, v73
    v_mul_f32 v78, s93, v74
    v_mul_f32 v79, s93, v75
    v_exp_f32 v76, v76
    v_exp_f32 v77, v77
    v_exp_f32 v78, v78
    v_exp_f32 v79, v79
    s_nop 0
    v_add_f32 v76, 1.0, v76
    v_add_f32 v77, 1.0, v77
    v_add_f32 v78, 1.0, v78
    v_add_f32 v79, 1.0, v79
    v_rcp_f32 v76, v76
    v_rcp_f32 v77, v77
    v_rcp_f32 v78, v78
    v_rcp_f32 v79, v79
    s_nop 0
    v_mul_f32 v72, v72, v76
    v_mul_f32 v73, v73, v77
    v_mul_f32 v74, v74, v78
    v_mul_f32 v75, v75, v79
    v_cvt_pk_bf16_f32 v96, v72, v73
    v_cvt_pk_bf16_f32 v97, v74, v75
    v_accvgpr_read_b32 v80, a12
    v_accvgpr_read_b32 v81, a13
    v_accvgpr_read_b32 v82, a14
    v_accvgpr_read_b32 v83, a15
    v_mul_f32 v80, v80, v71
    v_mul_f32 v81, v81, v71
    v_mul_f32 v82, v82, v71
    v_mul_f32 v83, v83, v71
    v_fma_f32 v80, -v70, v16, v80
    v_fma_f32 v81, -v70, v17, v81
    v_fma_f32 v82, -v70, v18, v82
    v_fma_f32 v83, -v70, v19, v83
    v_cvt_pk_bf16_f32 v84, v80, v81
    v_cvt_pk_bf16_f32 v85, v82, v83
    v_lshlrev_b32 v80, 16, v84
    v_and_b32 v81, s92, v84
    v_lshlrev_b32 v82, 16, v85
    v_and_b32 v83, s92, v85
    v_mul_f32 v84, s93, v80
    v_mul_f32 v85, s93, v81
    v_mul_f32 v86, s93, v82
    v_mul_f32 v87, s93, v83
    v_exp_f32 v84, v84
    v_exp_f32 v85, v85
    v_exp_f32 v86, v86
    v_exp_f32 v87, v87
    s_nop 0
    v_add_f32 v84, 1.0, v84
    v_add_f32 v85, 1.0, v85
    v_add_f32 v86, 1.0, v86
    v_add_f32 v87, 1.0, v87
    v_rcp_f32 v84, v84
    v_rcp_f32 v85, v85
    v_rcp_f32 v86, v86
    v_rcp_f32 v87, v87
    s_nop 0
    v_mul_f32 v80, v80, v84
    v_mul_f32 v81, v81, v85
    v_mul_f32 v82, v82, v86
    v_mul_f32 v83, v83, v87
    v_cvt_pk_bf16_f32 v100, v80, v81
    v_cvt_pk_bf16_f32 v101, v82, v83
    v_accvgpr_read_b32 v72, a16
    v_accvgpr_read_b32 v73, a17
    v_accvgpr_read_b32 v74, a18
    v_accvgpr_read_b32 v75, a19
    v_mul_f32 v72, v72, v65
    v_mul_f32 v73, v73, v65
    v_mul_f32 v74, v74, v65
    v_mul_f32 v75, v75, v65
    v_fma_f32 v72, -v64, v20, v72
    v_fma_f32 v73, -v64, v21, v73
    v_fma_f32 v74, -v64, v22, v74
    v_fma_f32 v75, -v64, v23, v75
    v_cvt_pk_bf16_f32 v76, v72, v73
    v_cvt_pk_bf16_f32 v77, v74, v75
    v_lshlrev_b32 v72, 16, v76
    v_and_b32 v73, s92, v76
    v_lshlrev_b32 v74, 16, v77
    v_and_b32 v75, s92, v77
    v_mul_f32 v76, s93, v72
    v_mul_f32 v77, s93, v73
    v_mul_f32 v78, s93, v74
    v_mul_f32 v79, s93, v75
    v_exp_f32 v76, v76
    v_exp_f32 v77, v77
    v_exp_f32 v78, v78
    v_exp_f32 v79, v79
    s_nop 0
    v_add_f32 v76, 1.0, v76
    v_add_f32 v77, 1.0, v77
    v_add_f32 v78, 1.0, v78
    v_add_f32 v79, 1.0, v79
    v_rcp_f32 v76, v76
    v_rcp_f32 v77, v77
    v_rcp_f32 v78, v78
    v_rcp_f32 v79, v79
    s_nop 0
    v_mul_f32 v72, v72, v76
    v_mul_f32 v73, v73, v77
    v_mul_f32 v74, v74, v78
    v_mul_f32 v75, v75, v79
    v_cvt_pk_bf16_f32 v90, v72, v73
    v_cvt_pk_bf16_f32 v91, v74, v75
    s_add_u32 s80, s14, 0
    buffer_store_dwordx4 v[88:91], v4, s[60:63], s80 offen sc1
    v_accvgpr_read_b32 v80, a20
    v_accvgpr_read_b32 v81, a21
    v_accvgpr_read_b32 v82, a22
    v_accvgpr_read_b32 v83, a23
    v_mul_f32 v80, v80, v67
    v_mul_f32 v81, v81, v67
    v_mul_f32 v82, v82, v67
    v_mul_f32 v83, v83, v67
    v_fma_f32 v80, -v66, v20, v80
    v_fma_f32 v81, -v66, v21, v81
    v_fma_f32 v82, -v66, v22, v82
    v_fma_f32 v83, -v66, v23, v83
    v_cvt_pk_bf16_f32 v84, v80, v81
    v_cvt_pk_bf16_f32 v85, v82, v83
    v_lshlrev_b32 v80, 16, v84
    v_and_b32 v81, s92, v84
    v_lshlrev_b32 v82, 16, v85
    v_and_b32 v83, s92, v85
    v_mul_f32 v84, s93, v80
    v_mul_f32 v85, s93, v81
    v_mul_f32 v86, s93, v82
    v_mul_f32 v87, s93, v83
    v_exp_f32 v84, v84
    v_exp_f32 v85, v85
    v_exp_f32 v86, v86
    v_exp_f32 v87, v87
    s_nop 0
    v_add_f32 v84, 1.0, v84
    v_add_f32 v85, 1.0, v85
    v_add_f32 v86, 1.0, v86
    v_add_f32 v87, 1.0, v87
    v_rcp_f32 v84, v84
    v_rcp_f32 v85, v85
    v_rcp_f32 v86, v86
    v_rcp_f32 v87, v87
    s_nop 0
    v_mul_f32 v80, v80, v84
    v_mul_f32 v81, v81, v85
    v_mul_f32 v82, v82, v86
    v_mul_f32 v83, v83, v87
    v_cvt_pk_bf16_f32 v94, v80, v81
    v_cvt_pk_bf16_f32 v95, v82, v83
    s_add_u32 s80, s14, 55296
    buffer_store_dwordx4 v[92:95], v4, s[60:63], s80 offen sc1
    v_accvgpr_read_b32 v72, a24
    v_accvgpr_read_b32 v73, a25
    v_accvgpr_read_b32 v74, a26
    v_accvgpr_read_b32 v75, a27
    v_mul_f32 v72, v72, v69
    v_mul_f32 v73, v73, v69
    v_mul_f32 v74, v74, v69
    v_mul_f32 v75, v75, v69
    v_fma_f32 v72, -v68, v20, v72
    v_fma_f32 v73, -v68, v21, v73
    v_fma_f32 v74, -v68, v22, v74
    v_fma_f32 v75, -v68, v23, v75
    v_cvt_pk_bf16_f32 v76, v72, v73
    v_cvt_pk_bf16_f32 v77, v74, v75
    v_lshlrev_b32 v72, 16, v76
    v_and_b32 v73, s92, v76
    v_lshlrev_b32 v74, 16, v77
    v_and_b32 v75, s92, v77
    v_mul_f32 v76, s93, v72
    v_mul_f32 v77, s93, v73
    v_mul_f32 v78, s93, v74
    v_mul_f32 v79, s93, v75
    v_exp_f32 v76, v76
    v_exp_f32 v77, v77
    v_exp_f32 v78, v78
    v_exp_f32 v79, v79
    s_nop 0
    v_add_f32 v76, 1.0, v76
    v_add_f32 v77, 1.0, v77
    v_add_f32 v78, 1.0, v78
    v_add_f32 v79, 1.0, v79
    v_rcp_f32 v76, v76
    v_rcp_f32 v77, v77
    v_rcp_f32 v78, v78
    v_rcp_f32 v79, v79
    s_nop 0
    v_mul_f32 v72, v72, v76
    v_mul_f32 v73, v73, v77
    v_mul_f32 v74, v74, v78
    v_mul_f32 v75, v75, v79
    v_cvt_pk_bf16_f32 v98, v72, v73
    v_cvt_pk_bf16_f32 v99, v74, v75
    s_add_u32 s80, s14, 110592
    buffer_store_dwordx4 v[96:99], v4, s[60:63], s80 offen sc1
    v_accvgpr_read_b32 v80, a28
    v_accvgpr_read_b32 v81, a29
    v_accvgpr_read_b32 v82, a30
    v_accvgpr_read_b32 v83, a31
    v_mul_f32 v80, v80, v71
    v_mul_f32 v81, v81, v71
    v_mul_f32 v82, v82, v71
    v_mul_f32 v83, v83, v71
    v_fma_f32 v80, -v70, v20, v80
    v_fma_f32 v81, -v70, v21, v81
    v_fma_f32 v82, -v70, v22, v82
    v_fma_f32 v83, -v70, v23, v83
    v_cvt_pk_bf16_f32 v84, v80, v81
    v_cvt_pk_bf16_f32 v85, v82, v83
    v_lshlrev_b32 v80, 16, v84
    v_and_b32 v81, s92, v84
    v_lshlrev_b32 v82, 16, v85
    v_and_b32 v83, s92, v85
    v_mul_f32 v84, s93, v80
    v_mul_f32 v85, s93, v81
    v_mul_f32 v86, s93, v82
    v_mul_f32 v87, s93, v83
    v_exp_f32 v84, v84
    v_exp_f32 v85, v85
    v_exp_f32 v86, v86
    v_exp_f32 v87, v87
    s_nop 0
    v_add_f32 v84, 1.0, v84
    v_add_f32 v85, 1.0, v85
    v_add_f32 v86, 1.0, v86
    v_add_f32 v87, 1.0, v87
    v_rcp_f32 v84, v84
    v_rcp_f32 v85, v85
    v_rcp_f32 v86, v86
    v_rcp_f32 v87, v87
    s_nop 0
    v_mul_f32 v80, v80, v84
    v_mul_f32 v81, v81, v85
    v_mul_f32 v82, v82, v86
    v_mul_f32 v83, v83, v87
    v_cvt_pk_bf16_f32 v102, v80, v81
    v_cvt_pk_bf16_f32 v103, v82, v83
    s_add_u32 s80, s14, 165888
    buffer_store_dwordx4 v[100:103], v4, s[60:63], s80 offen sc1
    s_endpgm
g1_prod:
    s_setprio 3
    s_lshl_b32 s9, s6, 2
    s_add_u32 s9, s9, s3
    s_lshl_b32 s12, s3, 10
    v_add_u32 v3, s12, v4
    v_add_u32 v14, 0xa000, v3
    s_lshl_b32 s10, s9, 4
    v_add_u32 v1, s10, v6
    v_lshlrev_b32 v5, 6, v1
    s_mul_i32 s13, s9, 20480
    v_add_u32 v8, s13, v4
    v_lshlrev_b32 v9, 3, v2
    v_add_u32 v9, s13, v9
    s_waitcnt lgkmcnt(0)
    s_cmp_eq_u32 s94, 0
    s_mov_b32 s10, 0x800000
    s_mov_b32 s11, 0xc40000
    s_cselect_b32 s10, 0x2000000, s10
    s_cselect_b32 s11, 0xc00000, s11
    s_add_u32 s40, s38, s10
    s_addc_u32 s41, s39, 0
    s_mov_b32 s42, 0x280000
    s_mov_b32 s43, 0x00020000
    s_add_u32 s56, s38, s11
    s_addc_u32 s57, s39, 0
    s_mov_b32 s58, 0x20000
    s_mov_b32 s59, 0x00020000
    s_mov_b32 s44, s38
    s_mov_b32 s45, s39
    s_mov_b32 s46, 0x280000
    s_mov_b32 s47, 0x00020000
    buffer_load_dwordx4 v[64:67], v5, s[56:59], 0 offen offset:0
    buffer_load_dwordx4 v[68:71], v5, s[56:59], 0 offen offset:16
    buffer_load_dwordx4 v[72:75], v5, s[56:59], 0 offen offset:32
    buffer_load_dwordx4 v[76:79], v5, s[56:59], 0 offen offset:48
    buffer_load_dwordx4 v[16:19], v8, s[40:43], s70 offen offset:0
    buffer_load_dwordx2 v[20:21], v9, s[44:47], s70 offen offset:0
    buffer_load_dwordx2 v[22:23], v9, s[44:47], s70 offen offset:512
    buffer_load_dwordx4 v[24:27], v8, s[40:43], s70 offen offset:1024
    buffer_load_dwordx2 v[28:29], v9, s[44:47], s70 offen offset:1024
    buffer_load_dwordx2 v[30:31], v9, s[44:47], s70 offen offset:1536
    buffer_load_dwordx4 v[32:35], v8, s[40:43], s70 offen offset:2048
    buffer_load_dwordx2 v[36:37], v9, s[44:47], s70 offen offset:2048
    buffer_load_dwordx2 v[38:39], v9, s[44:47], s70 offen offset:2560
    buffer_load_dwordx4 v[40:43], v8, s[40:43], s70 offen offset:3072
    buffer_load_dwordx2 v[44:45], v9, s[44:47], s70 offen offset:3072
    buffer_load_dwordx2 v[46:47], v9, s[44:47], s70 offen offset:3584
    s_barrier
    buffer_load_dwordx4 v[48:51], v8, s[40:43], s71 offen offset:0
    buffer_load_dwordx2 v[52:53], v9, s[44:47], s71 offen offset:0
    buffer_load_dwordx2 v[54:55], v9, s[44:47], s71 offen offset:512
    buffer_load_dwordx4 v[56:59], v8, s[40:43], s71 offen offset:1024
    buffer_load_dwordx2 v[60:61], v9, s[44:47], s71 offen offset:1024
    buffer_load_dwordx2 v[62:63], v9, s[44:47], s71 offen offset:1536
    s_add_u32 s48, s38, 0x400000
    s_addc_u32 s49, s39, 0
    s_mov_b32 s50, 0x280000
    s_mov_b32 s51, 0x00020000
    v_accvgpr_write_b32 a0, 0
    v_accvgpr_write_b32 a1, 0
    v_accvgpr_write_b32 a2, 0
    v_accvgpr_write_b32 a3, 0
    v_accvgpr_write_b32 a4, 0
    v_accvgpr_write_b32 a5, 0
    v_accvgpr_write_b32 a6, 0
    v_accvgpr_write_b32 a7, 0
    v_mov_b32 v96, 0x3f803f80
    v_accvgpr_write_b32 a8, v96
    v_accvgpr_write_b32 a9, v96
    v_accvgpr_write_b32 a10, v96
    v_accvgpr_write_b32 a11, v96
    s_waitcnt vmcnt(18)
    v_add_f32 v80, v64, v66
    v_add_f32 v80, v80, v68
    v_add_f32 v80, v80, v70
    v_add_f32 v80, v80, v72
    v_add_f32 v80, v80, v74
    v_add_f32 v80, v80, v76
    v_add_f32 v80, v80, v78
    s_mov_b32 s90, 0x3acccccd
    s_mov_b32 s91, 0x3c4ccccd
    v_mul_f32 v80, s90, v80
    v_add_f32 v81, v65, v67
    v_add_f32 v81, v81, v69
    v_add_f32 v81, v81, v71
    v_add_f32 v81, v81, v73
    v_add_f32 v81, v81, v75
    v_add_f32 v81, v81, v77
    v_add_f32 v81, v81, v79
    v_mov_b32 v83, 0
    v_fma_f32 v82, v64, s91, -v80
    v_fma_f32 v83, v82, v82, v83
    v_fma_f32 v82, v66, s91, -v80
    v_fma_f32 v83, v82, v82, v83
    v_fma_f32 v82, v68, s91, -v80
    v_fma_f32 v83, v82, v82, v83
    v_fma_f32 v82, v70, s91, -v80
    v_fma_f32 v83, v82, v82, v83
    v_fma_f32 v82, v72, s91, -v80
    v_fma_f32 v83, v82, v82, v83
    v_fma_f32 v82, v74, s91, -v80
    v_fma_f32 v83, v82, v82, v83
    v_fma_f32 v82, v76, s91, -v80
    v_fma_f32 v83, v82, v82, v83
    v_fma_f32 v82, v78, s91, -v80
    v_fma_f32 v83, v82, v82, v83
    s_mov_b32 s91, 0x42a00000
    v_fma_f32 v81, v83, s91, v81
    v_mul_f32 v81, s90, v81
    v_cvt_pk_bf16_f32 v84, v80, v80
    v_lshlrev_b32 v84, 16, v84
    v_cvt_pk_bf16_f32 v81, v81, v81
    v_lshlrev_b32 v81, 16, v81
    s_mov_b32 s91, 0x3727c5ac
    v_add_f32 v81, s91, v81
    v_cvt_pk_bf16_f32 v81, v81, v81
    v_lshlrev_b32 v81, 16, v81
    v_sqrt_f32 v81, v81
    s_nop 0
    v_cvt_pk_bf16_f32 v81, v81, v81
    v_lshlrev_b32 v81, 16, v81
    v_rcp_f32 v5, v81
    s_nop 0
    v_mul_f32 v15, v84, v5
    v_sub_f32 v15, 0, v15
    v_mov_b32 v10, v5
    v_mov_b32 v12, v15
    s_waitcnt vmcnt(15)
    v_lshlrev_b32 v64, 16, v16
    v_and_b32 v65, s92, v16
    v_lshlrev_b32 v66, 16, v17
    v_and_b32 v67, s92, v17
    v_lshlrev_b32 v68, 16, v18
    v_and_b32 v69, s92, v18
    v_lshlrev_b32 v70, 16, v19
    v_and_b32 v71, s92, v19
    v_fma_f32 v80, v64, v5, v15
    v_fma_f32 v81, v65, v5, v15
    v_fma_f32 v82, v66, v5, v15
    v_fma_f32 v83, v67, v5, v15
    v_fma_f32 v84, v68, v5, v15
    v_fma_f32 v85, v69, v5, v15
    v_fma_f32 v86, v70, v5, v15
    v_fma_f32 v87, v71, v5, v15
    v_lshlrev_b32 v72, 16, v20
    v_and_b32 v73, s92, v20
    v_lshlrev_b32 v74, 16, v21
    v_and_b32 v75, s92, v21
    v_lshlrev_b32 v76, 16, v22
    v_and_b32 v77, s92, v22
    v_lshlrev_b32 v78, 16, v23
    v_and_b32 v79, s92, v23
    v_fma_f32 v80, v80, v72, v64
    v_fma_f32 v81, v81, v73, v65
    v_fma_f32 v82, v82, v74, v66
    v_fma_f32 v83, v83, v75, v67
    v_fma_f32 v84, v84, v76, v68
    v_fma_f32 v85, v85, v77, v69
    v_fma_f32 v86, v86, v78, v70
    v_fma_f32 v87, v87, v79, v71
    v_cvt_pk_bf16_f32 v88, v80, v81
    v_cvt_pk_bf16_f32 v89, v82, v83
    v_cvt_pk_bf16_f32 v90, v84, v85
    v_cvt_pk_bf16_f32 v91, v86, v87
    ds_write_b128 v3, v[88:91] offset:0
    buffer_load_dwordx4 v[16:19], v8, s[40:43], s71 offen offset:2048
    buffer_load_dwordx2 v[20:21], v9, s[44:47], s71 offen offset:2048
    buffer_load_dwordx2 v[22:23], v9, s[44:47], s71 offen offset:2560
    s_cmp_lg_u32 s7, 0
    s_cbranch_scc1 g1_zs_1
    buffer_store_dwordx4 v[88:91], v8, s[48:51], s70 offen offset:0 sc1
g1_zs_1:
    v_mfma_f32_16x16x32_bf16 a[0:3], a[8:11], v[88:91], a[0:3]
    v_mfma_f32_16x16x32_bf16 a[4:7], v[88:91], v[88:91], a[4:7]
    s_waitcnt vmcnt(15)
    v_lshlrev_b32 v64, 16, v24
    v_and_b32 v65, s92, v24
    v_lshlrev_b32 v66, 16, v25
    v_and_b32 v67, s92, v25
    v_lshlrev_b32 v68, 16, v26
    v_and_b32 v69, s92, v26
    v_lshlrev_b32 v70, 16, v27
    v_and_b32 v71, s92, v27
    v_fma_f32 v80, v64, v5, v15
    v_fma_f32 v81, v65, v5, v15
    v_fma_f32 v82, v66, v5, v15
    v_fma_f32 v83, v67, v5, v15
    v_fma_f32 v84, v68, v5, v15
    v_fma_f32 v85, v69, v5, v15
    v_fma_f32 v86, v70, v5, v15
    v_fma_f32 v87, v71, v5, v15
    v_lshlrev_b32 v72, 16, v28
    v_and_b32 v73, s92, v28
    v_lshlrev_b32 v74, 16, v29
    v_and_b32 v75, s92, v29
    v_lshlrev_b32 v76, 16, v30
    v_and_b32 v77, s92, v30
    v_lshlrev_b32 v78, 16, v31
    v_and_b32 v79, s92, v31
    v_fma_f32 v80, v80, v72, v64
    v_fma_f32 v81, v81, v73, v65
    v_fma_f32 v82, v82, v74, v66
    v_fma_f32 v83, v83, v75, v67
    v_fma_f32 v84, v84, v76, v68
    v_fma_f32 v85, v85, v77, v69
    v_fma_f32 v86, v86, v78, v70
    v_fma_f32 v87, v87, v79, v71
    v_cvt_pk_bf16_f32 v92, v80, v81
    v_cvt_pk_bf16_f32 v93, v82, v83
    v_cvt_pk_bf16_f32 v94, v84, v85
    v_cvt_pk_bf16_f32 v95, v86, v87
    ds_write_b128 v3, v[92:95] offset:4096
    buffer_load_dwordx4 v[24:27], v8, s[40:43], s71 offen offset:3072
    buffer_load_dwordx2 v[28:29], v9, s[44:47], s71 offen offset:3072
    buffer_load_dwordx2 v[30:31], v9, s[44:47], s71 offen offset:3584
    s_cmp_lg_u32 s7, 1
    s_cbranch_scc1 g1_zs_2
    buffer_store_dwordx4 v[92:95], v8, s[48:51], s70 offen offset:1024 sc1
g1_zs_2:
    v_mfma_f32_16x16x32_bf16 a[0:3], a[8:11], v[92:95], a[0:3]
    v_mfma_f32_16x16x32_bf16 a[4:7], v[92:95], v[92:95], a[4:7]
    s_waitcnt vmcnt(15)
    v_lshlrev_b32 v64, 16, v32
    v_and_b32 v65, s92, v32
    v_lshlrev_b32 v66, 16, v33
    v_and_b32 v67, s92, v33
    v_lshlrev_b32 v68, 16, v34
    v_and_b32 v69, s92, v34
    v_lshlrev_b32 v70, 16, v35
    v_and_b32 v71, s92, v35
    v_fma_f32 v80, v64, v5, v15
    v_fma_f32 v81, v65, v5, v15
    v_fma_f32 v82, v66, v5, v15
    v_fma_f32 v83, v67, v5, v15
    v_fma_f32 v84, v68, v5, v15
    v_fma_f32 v85, v69, v5, v15
    v_fma_f32 v86, v70, v5, v15
    v_fma_f32 v87, v71, v5, v15
    v_lshlrev_b32 v72, 16, v36
    v_and_b32 v73, s92, v36
    v_lshlrev_b32 v74, 16, v37
    v_and_b32 v75, s92, v37
    v_lshlrev_b32 v76, 16, v38
    v_and_b32 v77, s92, v38
    v_lshlrev_b32 v78, 16, v39
    v_and_b32 v79, s92, v39
    v_fma_f32 v80, v80, v72, v64
    v_fma_f32 v81, v81, v73, v65
    v_fma_f32 v82, v82, v74, v66
    v_fma_f32 v83, v83, v75, v67
    v_fma_f32 v84, v84, v76, v68
    v_fma_f32 v85, v85, v77, v69
    v_fma_f32 v86, v86, v78, v70
    v_fma_f32 v87, v87, v79, v71
    v_cvt_pk_bf16_f32 v88, v80, v81
    v_cvt_pk_bf16_f32 v89, v82, v83
    v_cvt_pk_bf16_f32 v90, v84, v85
    v_cvt_pk_bf16_f32 v91, v86, v87
    ds_write_b128 v3, v[88:91] offset:8192
    buffer_load_dwordx4 v[32:35], v8, s[40:43], s72 offen offset:0
    buffer_load_dwordx2 v[36:37], v9, s[44:47], s72 offen offset:0
    buffer_load_dwordx2 v[38:39], v9, s[44:47], s72 offen offset:512
    s_cmp_lg_u32 s7, 2
    s_cbranch_scc1 g1_zs_3
    buffer_store_dwordx4 v[88:91], v8, s[48:51], s70 offen offset:2048 sc1
g1_zs_3:
    v_mfma_f32_16x16x32_bf16 a[0:3], a[8:11], v[88:91], a[0:3]
    v_mfma_f32_16x16x32_bf16 a[4:7], v[88:91], v[88:91], a[4:7]
    s_waitcnt vmcnt(15)
    v_lshlrev_b32 v64, 16, v40
    v_and_b32 v65, s92, v40
    v_lshlrev_b32 v66, 16, v41
    v_and_b32 v67, s92, v41
    v_lshlrev_b32 v68, 16, v42
    v_and_b32 v69, s92, v42
    v_lshlrev_b32 v70, 16, v43
    v_and_b32 v71, s92, v43
    v_fma_f32 v80, v64, v5, v15
    v_fma_f32 v81, v65, v5, v15
    v_fma_f32 v82, v66, v5, v15
    v_fma_f32 v83, v67, v5, v15
    v_fma_f32 v84, v68, v5, v15
    v_fma_f32 v85, v69, v5, v15
    v_fma_f32 v86, v70, v5, v15
    v_fma_f32 v87, v71, v5, v15
    v_lshlrev_b32 v72, 16, v44
    v_and_b32 v73, s92, v44
    v_lshlrev_b32 v74, 16, v45
    v_and_b32 v75, s92, v45
    v_lshlrev_b32 v76, 16, v46
    v_and_b32 v77, s92, v46
    v_lshlrev_b32 v78, 16, v47
    v_and_b32 v79, s92, v47
    v_fma_f32 v80, v80, v72, v64
    v_fma_f32 v81, v81, v73, v65
    v_fma_f32 v82, v82, v74, v66
    v_fma_f32 v83, v83, v75, v67
    v_fma_f32 v84, v84, v76, v68
    v_fma_f32 v85, v85, v77, v69
    v_fma_f32 v86, v86, v78, v70
    v_fma_f32 v87, v87, v79, v71
    v_cvt_pk_bf16_f32 v92, v80, v81
    v_cvt_pk_bf16_f32 v93, v82, v83
    v_cvt_pk_bf16_f32 v94, v84, v85
    v_cvt_pk_bf16_f32 v95, v86, v87
    ds_write_b128 v3, v[92:95] offset:12288
    buffer_load_dwordx4 v[40:43], v8, s[40:43], s72 offen offset:1024
    buffer_load_dwordx2 v[44:45], v9, s[44:47], s72 offen offset:1024
    buffer_load_dwordx2 v[46:47], v9, s[44:47], s72 offen offset:1536
    s_cmp_lg_u32 s7, 3
    s_cbranch_scc1 g1_zs_4
    buffer_store_dwordx4 v[92:95], v8, s[48:51], s70 offen offset:3072 sc1
g1_zs_4:
    v_mfma_f32_16x16x32_bf16 a[0:3], a[8:11], v[92:95], a[0:3]
    v_mfma_f32_16x16x32_bf16 a[4:7], v[92:95], v[92:95], a[4:7]
    s_waitcnt lgkmcnt(0)
    s_barrier
    s_waitcnt vmcnt(15)
    v_lshlrev_b32 v64, 16, v48
    v_and_b32 v65, s92, v48
    v_lshlrev_b32 v66, 16, v49
    v_and_b32 v67, s92, v49
    v_lshlrev_b32 v68, 16, v50
    v_and_b32 v69, s92, v50
    v_lshlrev_b32 v70, 16, v51
    v_and_b32 v71, s92, v51
    v_fma_f32 v80, v64, v5, v15
    v_fma_f32 v81, v65, v5, v15
    v_fma_f32 v82, v66, v5, v15
    v_fma_f32 v83, v67, v5, v15
    v_fma_f32 v84, v68, v5, v15
    v_fma_f32 v85, v69, v5, v15
    v_fma_f32 v86, v70, v5, v15
    v_fma_f32 v87, v71, v5, v15
    v_lshlrev_b32 v72, 16, v52
    v_and_b32 v73, s92, v52
    v_lshlrev_b32 v74, 16, v53
    v_and_b32 v75, s92, v53
    v_lshlrev_b32 v76, 16, v54
    v_and_b32 v77, s92, v54
    v_lshlrev_b32 v78, 16, v55
    v_and_b32 v79, s92, v55
    v_fma_f32 v80, v80, v72, v64
    v_fma_f32 v81, v81, v73, v65
    v_fma_f32 v82, v82, v74, v66
    v_fma_f32 v83, v83, v75, v67
    v_fma_f32 v84, v84, v76, v68
    v_fma_f32 v85, v85, v77, v69
    v_fma_f32 v86, v86, v78, v70
    v_fma_f32 v87, v87, v79, v71
    v_cvt_pk_bf16_f32 v88, v80, v81
    v_cvt_pk_bf16_f32 v89, v82, v83
    v_cvt_pk_bf16_f32 v90, v84, v85
    v_cvt_pk_bf16_f32 v91, v86, v87
    ds_write_b128 v3, v[88:91] offset:16384
    buffer_load_dwordx4 v[48:51], v8, s[40:43], s72 offen offset:2048
    buffer_load_dwordx2 v[52:53], v9, s[44:47], s72 offen offset:2048
    buffer_load_dwordx2 v[54:55], v9, s[44:47], s72 offen offset:2560
    s_cmp_lg_u32 s7, 4
    s_cbranch_scc1 g1_zs_5
    buffer_store_dwordx4 v[88:91], v8, s[48:51], s71 offen offset:0 sc1
g1_zs_5:
    v_mfma_f32_16x16x32_bf16 a[0:3], a[8:11], v[88:91], a[0:3]
    v_mfma_f32_16x16x32_bf16 a[4:7], v[88:91], v[88:91], a[4:7]
    s_waitcnt vmcnt(15)
    v_lshlrev_b32 v64, 16, v56
    v_and_b32 v65, s92, v56
    v_lshlrev_b32 v66, 16, v57
    v_and_b32 v67, s92, v57
    v_lshlrev_b32 v68, 16, v58
    v_and_b32 v69, s92, v58
    v_lshlrev_b32 v70, 16, v59
    v_and_b32 v71, s92, v59
    v_fma_f32 v80, v64, v5, v15
    v_fma_f32 v81, v65, v5, v15
    v_fma_f32 v82, v66, v5, v15
    v_fma_f32 v83, v67, v5, v15
    v_fma_f32 v84, v68, v5, v15
    v_fma_f32 v85, v69, v5, v15
    v_fma_f32 v86, v70, v5, v15
    v_fma_f32 v87, v71, v5, v15
    v_lshlrev_b32 v72, 16, v60
    v_and_b32 v73, s92, v60
    v_lshlrev_b32 v74, 16, v61
    v_and_b32 v75, s92, v61
    v_lshlrev_b32 v76, 16, v62
    v_and_b32 v77, s92, v62
    v_lshlrev_b32 v78, 16, v63
    v_and_b32 v79, s92, v63
    v_fma_f32 v80, v80, v72, v64
    v_fma_f32 v81, v81, v73, v65
    v_fma_f32 v82, v82, v74, v66
    v_fma_f32 v83, v83, v75, v67
    v_fma_f32 v84, v84, v76, v68
    v_fma_f32 v85, v85, v77, v69
    v_fma_f32 v86, v86, v78, v70
    v_fma_f32 v87, v87, v79, v71
    v_cvt_pk_bf16_f32 v92, v80, v81
    v_cvt_pk_bf16_f32 v93, v82, v83
    v_cvt_pk_bf16_f32 v94, v84, v85
    v_cvt_pk_bf16_f32 v95, v86, v87
    ds_write_b128 v3, v[92:95] offset:20480
    buffer_load_dwordx4 v[56:59], v8, s[40:43], s72 offen offset:3072
    buffer_load_dwordx2 v[60:61], v9, s[44:47], s72 offen offset:3072
    buffer_load_dwordx2 v[62:63], v9, s[44:47], s72 offen offset:3584
    s_cmp_lg_u32 s7, 5
    s_cbranch_scc1 g1_zs_6
    buffer_store_dwordx4 v[92:95], v8, s[48:51], s71 offen offset:1024 sc1
g1_zs_6:
    v_mfma_f32_16x16x32_bf16 a[0:3], a[8:11], v[92:95], a[0:3]
    v_mfma_f32_16x16x32_bf16 a[4:7], v[92:95], v[92:95], a[4:7]
    s_waitcnt lgkmcnt(0)
    s_barrier
    s_waitcnt vmcnt(15)
    v_lshlrev_b32 v64, 16, v16
    v_and_b32 v65, s92, v16
    v_lshlrev_b32 v66, 16, v17
    v_and_b32 v67, s92, v17
    v_lshlrev_b32 v68, 16, v18
    v_and_b32 v69, s92, v18
    v_lshlrev_b32 v70, 16, v19
    v_and_b32 v71, s92, v19
    v_fma_f32 v80, v64, v5, v15
    v_fma_f32 v81, v65, v5, v15
    v_fma_f32 v82, v66, v5, v15
    v_fma_f32 v83, v67, v5, v15
    v_fma_f32 v84, v68, v5, v15
    v_fma_f32 v85, v69, v5, v15
    v_fma_f32 v86, v70, v5, v15
    v_fma_f32 v87, v71, v5, v15
    v_lshlrev_b32 v72, 16, v20
    v_and_b32 v73, s92, v20
    v_lshlrev_b32 v74, 16, v21
    v_and_b32 v75, s92, v21
    v_lshlrev_b32 v76, 16, v22
    v_and_b32 v77, s92, v22
    v_lshlrev_b32 v78, 16, v23
    v_and_b32 v79, s92, v23
    v_fma_f32 v80, v80, v72, v64
    v_fma_f32 v81, v81, v73, v65
    v_fma_f32 v82, v82, v74, v66
    v_fma_f32 v83, v83, v75, v67
    v_fma_f32 v84, v84, v76, v68
    v_fma_f32 v85, v85, v77, v69
    v_fma_f32 v86, v86, v78, v70
    v_fma_f32 v87, v87, v79, v71
    v_cvt_pk_bf16_f32 v88, v80, v81
    v_cvt_pk_bf16_f32 v89, v82, v83
    v_cvt_pk_bf16_f32 v90, v84, v85
    v_cvt_pk_bf16_f32 v91, v86, v87
    ds_write_b128 v3, v[88:91] offset:24576
    buffer_load_dwordx4 v[16:19], v8, s[40:43], s73 offen offset:0
    buffer_load_dwordx2 v[20:21], v9, s[44:47], s73 offen offset:0
    buffer_load_dwordx2 v[22:23], v9, s[44:47], s73 offen offset:512
    s_cmp_lg_u32 s7, 6
    s_cbranch_scc1 g1_zs_7
    buffer_store_dwordx4 v[88:91], v8, s[48:51], s71 offen offset:2048 sc1
g1_zs_7:
    v_mfma_f32_16x16x32_bf16 a[0:3], a[8:11], v[88:91], a[0:3]
    v_mfma_f32_16x16x32_bf16 a[4:7], v[88:91], v[88:91], a[4:7]
    s_waitcnt vmcnt(15)
    v_lshlrev_b32 v64, 16, v24
    v_and_b32 v65, s92, v24
    v_lshlrev_b32 v66, 16, v25
    v_and_b32 v67, s92, v25
    v_lshlrev_b32 v68, 16, v26
    v_and_b32 v69, s92, v26
    v_lshlrev_b32 v70, 16, v27
    v_and_b32 v71, s92, v27
    v_fma_f32 v80, v64, v5, v15
    v_fma_f32 v81, v65, v5, v15
    v_fma_f32 v82, v66, v5, v15
    v_fma_f32 v83, v67, v5, v15
    v_fma_f32 v84, v68, v5, v15
    v_fma_f32 v85, v69, v5, v15
    v_fma_f32 v86, v70, v5, v15
    v_fma_f32 v87, v71, v5, v15
    v_lshlrev_b32 v72, 16, v28
    v_and_b32 v73, s92, v28
    v_lshlrev_b32 v74, 16, v29
    v_and_b32 v75, s92, v29
    v_lshlrev_b32 v76, 16, v30
    v_and_b32 v77, s92, v30
    v_lshlrev_b32 v78, 16, v31
    v_and_b32 v79, s92, v31
    v_fma_f32 v80, v80, v72, v64
    v_fma_f32 v81, v81, v73, v65
    v_fma_f32 v82, v82, v74, v66
    v_fma_f32 v83, v83, v75, v67
    v_fma_f32 v84, v84, v76, v68
    v_fma_f32 v85, v85, v77, v69
    v_fma_f32 v86, v86, v78, v70
    v_fma_f32 v87, v87, v79, v71
    v_cvt_pk_bf16_f32 v92, v80, v81
    v_cvt_pk_bf16_f32 v93, v82, v83
    v_cvt_pk_bf16_f32 v94, v84, v85
    v_cvt_pk_bf16_f32 v95, v86, v87
    ds_write_b128 v3, v[92:95] offset:28672
    buffer_load_dwordx4 v[24:27], v8, s[40:43], s73 offen offset:1024
    buffer_load_dwordx2 v[28:29], v9, s[44:47], s73 offen offset:1024
    buffer_load_dwordx2 v[30:31], v9, s[44:47], s73 offen offset:1536
    s_cmp_lg_u32 s7, 7
    s_cbranch_scc1 g1_zs_8
    buffer_store_dwordx4 v[92:95], v8, s[48:51], s71 offen offset:3072 sc1
g1_zs_8:
    v_mfma_f32_16x16x32_bf16 a[0:3], a[8:11], v[92:95], a[0:3]
    v_mfma_f32_16x16x32_bf16 a[4:7], v[92:95], v[92:95], a[4:7]
    s_waitcnt lgkmcnt(0)
    s_barrier
    s_waitcnt vmcnt(15)
    v_lshlrev_b32 v64, 16, v32
    v_and_b32 v65, s92, v32
    v_lshlrev_b32 v66, 16, v33
    v_and_b32 v67, s92, v33
    v_lshlrev_b32 v68, 16, v34
    v_and_b32 v69, s92, v34
    v_lshlrev_b32 v70, 16, v35
    v_and_b32 v71, s92, v35
    v_fma_f32 v80, v64, v5, v15
    v_fma_f32 v81, v65, v5, v15
    v_fma_f32 v82, v66, v5, v15
    v_fma_f32 v83, v67, v5, v15
    v_fma_f32 v84, v68, v5, v15
    v_fma_f32 v85, v69, v5, v15
    v_fma_f32 v86, v70, v5, v15
    v_fma_f32 v87, v71, v5, v15
    v_lshlrev_b32 v72, 16, v36
    v_and_b32 v73, s92, v36
    v_lshlrev_b32 v74, 16, v37
    v_and_b32 v75, s92, v37
    v_lshlrev_b32 v76, 16, v38
    v_and_b32 v77, s92, v38
    v_lshlrev_b32 v78, 16, v39
    v_and_b32 v79, s92, v39
    v_fma_f32 v80, v80, v72, v64
    v_fma_f32 v81, v81, v73, v65
    v_fma_f32 v82, v82, v74, v66
    v_fma_f32 v83, v83, v75, v67
    v_fma_f32 v84, v84, v76, v68
    v_fma_f32 v85, v85, v77, v69
    v_fma_f32 v86, v86, v78, v70
    v_fma_f32 v87, v87, v79, v71
    v_cvt_pk_bf16_f32 v88, v80, v81
    v_cvt_pk_bf16_f32 v89, v82, v83
    v_cvt_pk_bf16_f32 v90, v84, v85
    v_cvt_pk_bf16_f32 v91, v86, v87
    ds_write_b128 v3, v[88:91] offset:32768
    buffer_load_dwordx4 v[32:35], v8, s[40:43], s73 offen offset:2048
    buffer_load_dwordx2 v[36:37], v9, s[44:47], s73 offen offset:2048
    buffer_load_dwordx2 v[38:39], v9, s[44:47], s73 offen offset:2560
    s_cmp_lg_u32 s7, 0
    s_cbranch_scc1 g1_zs_9
    buffer_store_dwordx4 v[88:91], v8, s[48:51], s72 offen offset:0 sc1
g1_zs_9:
    v_mfma_f32_16x16x32_bf16 a[0:3], a[8:11], v[88:91], a[0:3]
    v_mfma_f32_16x16x32_bf16 a[4:7], v[88:91], v[88:91], a[4:7]
    s_waitcnt vmcnt(15)
    v_lshlrev_b32 v64, 16, v40
    v_and_b32 v65, s92, v40
    v_lshlrev_b32 v66, 16, v41
    v_and_b32 v67, s92, v41
    v_lshlrev_b32 v68, 16, v42
    v_and_b32 v69, s92, v42
    v_lshlrev_b32 v70, 16, v43
    v_and_b32 v71, s92, v43
    v_fma_f32 v80, v64, v5, v15
    v_fma_f32 v81, v65, v5, v15
    v_fma_f32 v82, v66, v5, v15
    v_fma_f32 v83, v67, v5, v15
    v_fma_f32 v84, v68, v5, v15
    v_fma_f32 v85, v69, v5, v15
    v_fma_f32 v86, v70, v5, v15
    v_fma_f32 v87, v71, v5, v15
    v_lshlrev_b32 v72, 16, v44
    v_and_b32 v73, s92, v44
    v_lshlrev_b32 v74, 16, v45
    v_and_b32 v75, s92, v45
    v_lshlrev_b32 v76, 16, v46
    v_and_b32 v77, s92, v46
    v_lshlrev_b32 v78, 16, v47
    v_and_b32 v79, s92, v47
    v_fma_f32 v80, v80, v72, v64
    v_fma_f32 v81, v81, v73, v65
    v_fma_f32 v82, v82, v74, v66
    v_fma_f32 v83, v83, v75, v67
    v_fma_f32 v84, v84, v76, v68
    v_fma_f32 v85, v85, v77, v69
    v_fma_f32 v86, v86, v78, v70
    v_fma_f32 v87, v87, v79, v71
    v_cvt_pk_bf16_f32 v92, v80, v81
    v_cvt_pk_bf16_f32 v93, v82, v83
    v_cvt_pk_bf16_f32 v94, v84, v85
    v_cvt_pk_bf16_f32 v95, v86, v87
    ds_write_b128 v3, v[92:95] offset:36864
    buffer_load_dwordx4 v[40:43], v8, s[40:43], s73 offen offset:3072
    buffer_load_dwordx2 v[44:45], v9, s[44:47], s73 offen offset:3072
    buffer_load_dwordx2 v[46:47], v9, s[44:47], s73 offen offset:3584
    s_cmp_lg_u32 s7, 1
    s_cbranch_scc1 g1_zs_10
    buffer_store_dwordx4 v[92:95], v8, s[48:51], s72 offen offset:1024 sc1
g1_zs_10:
    v_mfma_f32_16x16x32_bf16 a[0:3], a[8:11], v[92:95], a[0:3]
    v_mfma_f32_16x16x32_bf16 a[4:7], v[92:95], v[92:95], a[4:7]
    s_waitcnt lgkmcnt(0)
    s_barrier
    s_waitcnt vmcnt(15)
    v_lshlrev_b32 v64, 16, v48
    v_and_b32 v65, s92, v48
    v_lshlrev_b32 v66, 16, v49
    v_and_b32 v67, s92, v49
    v_lshlrev_b32 v68, 16, v50
    v_and_b32 v69, s92, v50
    v_lshlrev_b32 v70, 16, v51
    v_and_b32 v71, s92, v51
    v_fma_f32 v80, v64, v5, v15
    v_fma_f32 v81, v65, v5, v15
    v_fma_f32 v82, v66, v5, v15
    v_fma_f32 v83, v67, v5, v15
    v_fma_f32 v84, v68, v5, v15
    v_fma_f32 v85, v69, v5, v15
    v_fma_f32 v86, v70, v5, v15
    v_fma_f32 v87, v71, v5, v15
    v_lshlrev_b32 v72, 16, v52
    v_and_b32 v73, s92, v52
    v_lshlrev_b32 v74, 16, v53
    v_and_b32 v75, s92, v53
    v_lshlrev_b32 v76, 16, v54
    v_and_b32 v77, s92, v54
    v_lshlrev_b32 v78, 16, v55
    v_and_b32 v79, s92, v55
    v_fma_f32 v80, v80, v72, v64
    v_fma_f32 v81, v81, v73, v65
    v_fma_f32 v82, v82, v74, v66
    v_fma_f32 v83, v83, v75, v67
    v_fma_f32 v84, v84, v76, v68
    v_fma_f32 v85, v85, v77, v69
    v_fma_f32 v86, v86, v78, v70
    v_fma_f32 v87, v87, v79, v71
    v_cvt_pk_bf16_f32 v88, v80, v81
    v_cvt_pk_bf16_f32 v89, v82, v83
    v_cvt_pk_bf16_f32 v90, v84, v85
    v_cvt_pk_bf16_f32 v91, v86, v87
    ds_write_b128 v14, v[88:91] offset:0
    buffer_load_dwordx4 v[48:51], v8, s[40:43], s74 offen offset:0
    buffer_load_dwordx2 v[52:53], v9, s[44:47], s74 offen offset:0
    buffer_load_dwordx2 v[54:55], v9, s[44:47], s74 offen offset:512
    s_cmp_lg_u32 s7, 2
    s_cbranch_scc1 g1_zs_11
    buffer_store_dwordx4 v[88:91], v8, s[48:51], s72 offen offset:2048 sc1
g1_zs_11:
    v_mfma_f32_16x16x32_bf16 a[0:3], a[8:11], v[88:91], a[0:3]
    v_mfma_f32_16x16x32_bf16 a[4:7], v[88:91], v[88:91], a[4:7]
    s_waitcnt vmcnt(15)
    v_lshlrev_b32 v64, 16, v56
    v_and_b32 v65, s92, v56
    v_lshlrev_b32 v66, 16, v57
    v_and_b32 v67, s92, v57
    v_lshlrev_b32 v68, 16, v58
    v_and_b32 v69, s92, v58
    v_lshlrev_b32 v70, 16, v59
    v_and_b32 v71, s92, v59
    v_fma_f32 v80, v64, v5, v15
    v_fma_f32 v81, v65, v5, v15
    v_fma_f32 v82, v66, v5, v15
    v_fma_f32 v83, v67, v5, v15
    v_fma_f32 v84, v68, v5, v15
    v_fma_f32 v85, v69, v5, v15
    v_fma_f32 v86, v70, v5, v15
    v_fma_f32 v87, v71, v5, v15
    v_lshlrev_b32 v72, 16, v60
    v_and_b32 v73, s92, v60
    v_lshlrev_b32 v74, 16, v61
    v_and_b32 v75, s92, v61
    v_lshlrev_b32 v76, 16, v62
    v_and_b32 v77, s92, v62
    v_lshlrev_b32 v78, 16, v63
    v_and_b32 v79, s92, v63
    v_fma_f32 v80, v80, v72, v64
    v_fma_f32 v81, v81, v73, v65
    v_fma_f32 v82, v82, v74, v66
    v_fma_f32 v83, v83, v75, v67
    v_fma_f32 v84, v84, v76, v68
    v_fma_f32 v85, v85, v77, v69
    v_fma_f32 v86, v86, v78, v70
    v_fma_f32 v87, v87, v79, v71
    v_cvt_pk_bf16_f32 v92, v80, v81
    v_cvt_pk_bf16_f32 v93, v82, v83
    v_cvt_pk_bf16_f32 v94, v84, v85
    v_cvt_pk_bf16_f32 v95, v86, v87
    ds_write_b128 v14, v[92:95] offset:4096
    buffer_load_dwordx4 v[56:59], v8, s[40:43], s74 offen offset:1024
    buffer_load_dwordx2 v[60:61], v9, s[44:47], s74 offen offset:1024
    buffer_load_dwordx2 v[62:63], v9, s[44:47], s74 offen offset:1536
    s_cmp_lg_u32 s7, 3
    s_cbranch_scc1 g1_zs_12
    buffer_store_dwordx4 v[92:95], v8, s[48:51], s72 offen offset:3072 sc1
g1_zs_12:
    v_mfma_f32_16x16x32_bf16 a[0:3], a[8:11], v[92:95], a[0:3]
    v_mfma_f32_16x16x32_bf16 a[4:7], v[92:95], v[92:95], a[4:7]
    s_waitcnt lgkmcnt(0)
    s_barrier
    s_waitcnt vmcnt(15)
    v_lshlrev_b32 v64, 16, v16
    v_and_b32 v65, s92, v16
    v_lshlrev_b32 v66, 16, v17
    v_and_b32 v67, s92, v17
    v_lshlrev_b32 v68, 16, v18
    v_and_b32 v69, s92, v18
    v_lshlrev_b32 v70, 16, v19
    v_and_b32 v71, s92, v19
    v_fma_f32 v80, v64, v5, v15
    v_fma_f32 v81, v65, v5, v15
    v_fma_f32 v82, v66, v5, v15
    v_fma_f32 v83, v67, v5, v15
    v_fma_f32 v84, v68, v5, v15
    v_fma_f32 v85, v69, v5, v15
    v_fma_f32 v86, v70, v5, v15
    v_fma_f32 v87, v71, v5, v15
    v_lshlrev_b32 v72, 16, v20
    v_and_b32 v73, s92, v20
    v_lshlrev_b32 v74, 16, v21
    v_and_b32 v75, s92, v21
    v_lshlrev_b32 v76, 16, v22
    v_and_b32 v77, s92, v22
    v_lshlrev_b32 v78, 16, v23
    v_and_b32 v79, s92, v23
    v_fma_f32 v80, v80, v72, v64
    v_fma_f32 v81, v81, v73, v65
    v_fma_f32 v82, v82, v74, v66
    v_fma_f32 v83, v83, v75, v67
    v_fma_f32 v84, v84, v76, v68
    v_fma_f32 v85, v85, v77, v69
    v_fma_f32 v86, v86, v78, v70
    v_fma_f32 v87, v87, v79, v71
    v_cvt_pk_bf16_f32 v88, v80, v81
    v_cvt_pk_bf16_f32 v89, v82, v83
    v_cvt_pk_bf16_f32 v90, v84, v85
    v_cvt_pk_bf16_f32 v91, v86, v87
    ds_write_b128 v14, v[88:91] offset:8192
    buffer_load_dwordx4 v[16:19], v8, s[40:43], s74 offen offset:2048
    buffer_load_dwordx2 v[20:21], v9, s[44:47], s74 offen offset:2048
    buffer_load_dwordx2 v[22:23], v9, s[44:47], s74 offen offset:2560
    s_cmp_lg_u32 s7, 4
    s_cbranch_scc1 g1_zs_13
    buffer_store_dwordx4 v[88:91], v8, s[48:51], s73 offen offset:0 sc1
g1_zs_13:
    v_mfma_f32_16x16x32_bf16 a[0:3], a[8:11], v[88:91], a[0:3]
    v_mfma_f32_16x16x32_bf16 a[4:7], v[88:91], v[88:91], a[4:7]
    s_waitcnt vmcnt(15)
    v_lshlrev_b32 v64, 16, v24
    v_and_b32 v65, s92, v24
    v_lshlrev_b32 v66, 16, v25
    v_and_b32 v67, s92, v25
    v_lshlrev_b32 v68, 16, v26
    v_and_b32 v69, s92, v26
    v_lshlrev_b32 v70, 16, v27
    v_and_b32 v71, s92, v27
    v_fma_f32 v80, v64, v5, v15
    v_fma_f32 v81, v65, v5, v15
    v_fma_f32 v82, v66, v5, v15
    v_fma_f32 v83, v67, v5, v15
    v_fma_f32 v84, v68, v5, v15
    v_fma_f32 v85, v69, v5, v15
    v_fma_f32 v86, v70, v5, v15
    v_fma_f32 v87, v71, v5, v15
    v_lshlrev_b32 v72, 16, v28
    v_and_b32 v73, s92, v28
    v_lshlrev_b32 v74, 16, v29
    v_and_b32 v75, s92, v29
    v_lshlrev_b32 v76, 16, v30
    v_and_b32 v77, s92, v30
    v_lshlrev_b32 v78, 16, v31
    v_and_b32 v79, s92, v31
    v_fma_f32 v80, v80, v72, v64
    v_fma_f32 v81, v81, v73, v65
    v_fma_f32 v82, v82, v74, v66
    v_fma_f32 v83, v83, v75, v67
    v_fma_f32 v84, v84, v76, v68
    v_fma_f32 v85, v85, v77, v69
    v_fma_f32 v86, v86, v78, v70
    v_fma_f32 v87, v87, v79, v71
    v_cvt_pk_bf16_f32 v92, v80, v81
    v_cvt_pk_bf16_f32 v93, v82, v83
    v_cvt_pk_bf16_f32 v94, v84, v85
    v_cvt_pk_bf16_f32 v95, v86, v87
    ds_write_b128 v14, v[92:95] offset:12288
    buffer_load_dwordx4 v[24:27], v8, s[40:43], s74 offen offset:3072
    buffer_load_dwordx2 v[28:29], v9, s[44:47], s74 offen offset:3072
    buffer_load_dwordx2 v[30:31], v9, s[44:47], s74 offen offset:3584
    s_cmp_lg_u32 s7, 5
    s_cbranch_scc1 g1_zs_14
    buffer_store_dwordx4 v[92:95], v8, s[48:51], s73 offen offset:1024 sc1
g1_zs_14:
    v_mfma_f32_16x16x32_bf16 a[0:3], a[8:11], v[92:95], a[0:3]
    v_mfma_f32_16x16x32_bf16 a[4:7], v[92:95], v[92:95], a[4:7]
    s_waitcnt lgkmcnt(0)
    s_barrier
    s_waitcnt vmcnt(15)
    v_lshlrev_b32 v64, 16, v32
    v_and_b32 v65, s92, v32
    v_lshlrev_b32 v66, 16, v33
    v_and_b32 v67, s92, v33
    v_lshlrev_b32 v68, 16, v34
    v_and_b32 v69, s92, v34
    v_lshlrev_b32 v70, 16, v35
    v_and_b32 v71, s92, v35
    v_fma_f32 v80, v64, v5, v15
    v_fma_f32 v81, v65, v5, v15
    v_fma_f32 v82, v66, v5, v15
    v_fma_f32 v83, v67, v5, v15
    v_fma_f32 v84, v68, v5, v15
    v_fma_f32 v85, v69, v5, v15
    v_fma_f32 v86, v70, v5, v15
    v_fma_f32 v87, v71, v5, v15
    v_lshlrev_b32 v72, 16, v36
    v_and_b32 v73, s92, v36
    v_lshlrev_b32 v74, 16, v37
    v_and_b32 v75, s92, v37
    v_lshlrev_b32 v76, 16, v38
    v_and_b32 v77, s92, v38
    v_lshlrev_b32 v78, 16, v39
    v_and_b32 v79, s92, v39
    v_fma_f32 v80, v80, v72, v64
    v_fma_f32 v81, v81, v73, v65
    v_fma_f32 v82, v82, v74, v66
    v_fma_f32 v83, v83, v75, v67
    v_fma_f32 v84, v84, v76, v68
    v_fma_f32 v85, v85, v77, v69
    v_fma_f32 v86, v86, v78, v70
    v_fma_f32 v87, v87, v79, v71
    v_cvt_pk_bf16_f32 v88, v80, v81
    v_cvt_pk_bf16_f32 v89, v82, v83
    v_cvt_pk_bf16_f32 v90, v84, v85
    v_cvt_pk_bf16_f32 v91, v86, v87
    ds_write_b128 v14, v[88:91] offset:16384
    s_cmp_lg_u32 s7, 6
    s_cbranch_scc1 g1_zs_15
    buffer_store_dwordx4 v[88:91], v8, s[48:51], s73 offen offset:2048 sc1
g1_zs_15:
    v_mfma_f32_16x16x32_bf16 a[0:3], a[8:11], v[88:91], a[0:3]
    v_mfma_f32_16x16x32_bf16 a[4:7], v[88:91], v[88:91], a[4:7]
    s_waitcnt vmcnt(12)
    v_lshlrev_b32 v64, 16, v40
    v_and_b32 v65, s92, v40
    v_lshlrev_b32 v66, 16, v41
    v_and_b32 v67, s92, v41
    v_lshlrev_b32 v68, 16, v42
    v_and_b32 v69, s92, v42
    v_lshlrev_b32 v70, 16, v43
    v_and_b32 v71, s92, v43
    v_fma_f32 v80, v64, v5, v15
    v_fma_f32 v81, v65, v5, v15
    v_fma_f32 v82, v66, v5, v15
    v_fma_f32 v83, v67, v5, v15
    v_fma_f32 v84, v68, v5, v15
    v_fma_f32 v85, v69, v5, v15
    v_fma_f32 v86, v70, v5, v15
    v_fma_f32 v87, v71, v5, v15
    v_lshlrev_b32 v72, 16, v44
    v_and_b32 v73, s92, v44
    v_lshlrev_b32 v74, 16, v45
    v_and_b32 v75, s92, v45
    v_lshlrev_b32 v76, 16, v46
    v_and_b32 v77, s92, v46
    v_lshlrev_b32 v78, 16, v47
    v_and_b32 v79, s92, v47
    v_fma_f32 v80, v80, v72, v64
    v_fma_f32 v81, v81, v73, v65
    v_fma_f32 v82, v82, v74, v66
    v_fma_f32 v83, v83, v75, v67
    v_fma_f32 v84, v84, v76, v68
    v_fma_f32 v85, v85, v77, v69
    v_fma_f32 v86, v86, v78, v70
    v_fma_f32 v87, v87, v79, v71
    v_cvt_pk_bf16_f32 v92, v80, v81
    v_cvt_pk_bf16_f32 v93, v82, v83
    v_cvt_pk_bf16_f32 v94, v84, v85
    v_cvt_pk_bf16_f32 v95, v86, v87
    ds_write_b128 v14, v[92:95] offset:20480
    s_cmp_lg_u32 s7, 7
    s_cbranch_scc1 g1_zs_16
    buffer_store_dwordx4 v[92:95], v8, s[48:51], s73 offen offset:3072 sc1
g1_zs_16:
    v_mfma_f32_16x16x32_bf16 a[0:3], a[8:11], v[92:95], a[0:3]
    v_mfma_f32_16x16x32_bf16 a[4:7], v[92:95], v[92:95], a[4:7]
    s_waitcnt lgkmcnt(0)
    s_barrier
    s_waitcnt vmcnt(9)
    v_lshlrev_b32 v64, 16, v48
    v_and_b32 v65, s92, v48
    v_lshlrev_b32 v66, 16, v49
    v_and_b32 v67, s92, v49
    v_lshlrev_b32 v68, 16, v50
    v_and_b32 v69, s92, v50
    v_lshlrev_b32 v70, 16, v51
    v_and_b32 v71, s92, v51
    v_fma_f32 v80, v64, v5, v15
    v_fma_f32 v81, v65, v5, v15
    v_fma_f32 v82, v66, v5, v15
    v_fma_f32 v83, v67, v5, v15
    v_fma_f32 v84, v68, v5, v15
    v_fma_f32 v85, v69, v5, v15
    v_fma_f32 v86, v70, v5, v15
    v_fma_f32 v87, v71, v5, v15
    v_lshlrev_b32 v72, 16, v52
    v_and_b32 v73, s92, v52
    v_lshlrev_b32 v74, 16, v53
    v_and_b32 v75, s92, v53
    v_lshlrev_b32 v76, 16, v54
    v_and_b32 v77, s92, v54
    v_lshlrev_b32 v78, 16, v55
    v_and_b32 v79, s92, v55
    v_fma_f32 v80, v80, v72, v64
    v_fma_f32 v81, v81, v73, v65
    v_fma_f32 v82, v82, v74, v66
    v_fma_f32 v83, v83, v75, v67
    v_fma_f32 v84, v84, v76, v68
    v_fma_f32 v85, v85, v77, v69
    v_fma_f32 v86, v86, v78, v70
    v_fma_f32 v87, v87, v79, v71
    v_cvt_pk_bf16_f32 v88, v80, v81
    v_cvt_pk_bf16_f32 v89, v82, v83
    v_cvt_pk_bf16_f32 v90, v84, v85
    v_cvt_pk_bf16_f32 v91, v86, v87
    ds_write_b128 v14, v[88:91] offset:24576
    s_cmp_lg_u32 s7, 0
    s_cbranch_scc1 g1_zs_17
    buffer_store_dwordx4 v[88:91], v8, s[48:51], s74 offen offset:0 sc1
g1_zs_17:
    v_mfma_f32_16x16x32_bf16 a[0:3], a[8:11], v[88:91], a[0:3]
    v_mfma_f32_16x16x32_bf16 a[4:7], v[88:91], v[88:91], a[4:7]
    s_waitcnt vmcnt(6)
    v_lshlrev_b32 v64, 16, v56
    v_and_b32 v65, s92, v56
    v_lshlrev_b32 v66, 16, v57
    v_and_b32 v67, s92, v57
    v_lshlrev_b32 v68, 16, v58
    v_and_b32 v69, s92, v58
    v_lshlrev_b32 v70, 16, v59
    v_and_b32 v71, s92, v59
    v_fma_f32 v80, v64, v5, v15
    v_fma_f32 v81, v65, v5, v15
    v_fma_f32 v82, v66, v5, v15
    v_fma_f32 v83, v67, v5, v15
    v_fma_f32 v84, v68, v5, v15
    v_fma_f32 v85, v69, v5, v15
    v_fma_f32 v86, v70, v5, v15
    v_fma_f32 v87, v71, v5, v15
    v_lshlrev_b32 v72, 16, v60
    v_and_b32 v73, s92, v60
    v_lshlrev_b32 v74, 16, v61
    v_and_b32 v75, s92, v61
    v_lshlrev_b32 v76, 16, v62
    v_and_b32 v77, s92, v62
    v_lshlrev_b32 v78, 16, v63
    v_and_b32 v79, s92, v63
    v_fma_f32 v80, v80, v72, v64
    v_fma_f32 v81, v81, v73, v65
    v_fma_f32 v82, v82, v74, v66
    v_fma_f32 v83, v83, v75, v67
    v_fma_f32 v84, v84, v76, v68
    v_fma_f32 v85, v85, v77, v69
    v_fma_f32 v86, v86, v78, v70
    v_fma_f32 v87, v87, v79, v71
    v_cvt_pk_bf16_f32 v92, v80, v81
    v_cvt_pk_bf16_f32 v93, v82, v83
    v_cvt_pk_bf16_f32 v94, v84, v85
    v_cvt_pk_bf16_f32 v95, v86, v87
    ds_write_b128 v14, v[92:95] offset:28672
    s_cmp_lg_u32 s7, 1
    s_cbranch_scc1 g1_zs_18
    buffer_store_dwordx4 v[92:95], v8, s[48:51], s74 offen offset:1024 sc1
g1_zs_18:
    v_mfma_f32_16x16x32_bf16 a[0:3], a[8:11], v[92:95], a[0:3]
    v_mfma_f32_16x16x32_bf16 a[4:7], v[92:95], v[92:95], a[4:7]
    s_waitcnt lgkmcnt(0)
    s_barrier
    s_waitcnt vmcnt(3)
    v_lshlrev_b32 v64, 16, v16
    v_and_b32 v65, s92, v16
    v_lshlrev_b32 v66, 16, v17
    v_and_b32 v67, s92, v17
    v_lshlrev_b32 v68, 16, v18
    v_and_b32 v69, s92, v18
    v_lshlrev_b32 v70, 16, v19
    v_and_b32 v71, s92, v19
    v_fma_f32 v80, v64, v5, v15
    v_fma_f32 v81, v65, v5, v15
    v_fma_f32 v82, v66, v5, v15
    v_fma_f32 v83, v67, v5, v15
    v_fma_f32 v84, v68, v5, v15
    v_fma_f32 v85, v69, v5, v15
    v_fma_f32 v86, v70, v5, v15
    v_fma_f32 v87, v71, v5, v15
    v_lshlrev_b32 v72, 16, v20
    v_and_b32 v73, s92, v20
    v_lshlrev_b32 v74, 16, v21
    v_and_b32 v75, s92, v21
    v_lshlrev_b32 v76, 16, v22
    v_and_b32 v77, s92, v22
    v_lshlrev_b32 v78, 16, v23
    v_and_b32 v79, s92, v23
    v_fma_f32 v80, v80, v72, v64
    v_fma_f32 v81, v81, v73, v65
    v_fma_f32 v82, v82, v74, v66
    v_fma_f32 v83, v83, v75, v67
    v_fma_f32 v84, v84, v76, v68
    v_fma_f32 v85, v85, v77, v69
    v_fma_f32 v86, v86, v78, v70
    v_fma_f32 v87, v87, v79, v71
    v_cvt_pk_bf16_f32 v88, v80, v81
    v_cvt_pk_bf16_f32 v89, v82, v83
    v_cvt_pk_bf16_f32 v90, v84, v85
    v_cvt_pk_bf16_f32 v91, v86, v87
    ds_write_b128 v14, v[88:91] offset:32768
    s_cmp_lg_u32 s7, 2
    s_cbranch_scc1 g1_zs_19
    buffer_store_dwordx4 v[88:91], v8, s[48:51], s74 offen offset:2048 sc1
g1_zs_19:
    v_mfma_f32_16x16x32_bf16 a[0:3], a[8:11], v[88:91], a[0:3]
    v_mfma_f32_16x16x32_bf16 a[4:7], v[88:91], v[88:91], a[4:7]
    s_waitcnt vmcnt(0)
    v_lshlrev_b32 v64, 16, v24
    v_and_b32 v65, s92, v24
    v_lshlrev_b32 v66, 16, v25
    v_and_b32 v67, s92, v25
    v_lshlrev_b32 v68, 16, v26
    v_and_b32 v69, s92, v26
    v_lshlrev_b32 v70, 16, v27
    v_and_b32 v71, s92, v27
    v_fma_f32 v80, v64, v5, v15
    v_fma_f32 v81, v65, v5, v15
    v_fma_f32 v82, v66, v5, v15
    v_fma_f32 v83, v67, v5, v15
    v_fma_f32 v84, v68, v5, v15
    v_fma_f32 v85, v69, v5, v15
    v_fma_f32 v86, v70, v5, v15
    v_fma_f32 v87, v71, v5, v15
    v_lshlrev_b32 v72, 16, v28
    v_and_b32 v73, s92, v28
    v_lshlrev_b32 v74, 16, v29
    v_and_b32 v75, s92, v29
    v_lshlrev_b32 v76, 16, v30
    v_and_b32 v77, s92, v30
    v_lshlrev_b32 v78, 16, v31
    v_and_b32 v79, s92, v31
    v_fma_f32 v80, v80, v72, v64
    v_fma_f32 v81, v81, v73, v65
    v_fma_f32 v82, v82, v74, v66
    v_fma_f32 v83, v83, v75, v67
    v_fma_f32 v84, v84, v76, v68
    v_fma_f32 v85, v85, v77, v69
    v_fma_f32 v86, v86, v78, v70
    v_fma_f32 v87, v87, v79, v71
    v_cvt_pk_bf16_f32 v92, v80, v81
    v_cvt_pk_bf16_f32 v93, v82, v83
    v_cvt_pk_bf16_f32 v94, v84, v85
    v_cvt_pk_bf16_f32 v95, v86, v87
    ds_write_b128 v14, v[92:95] offset:36864
    s_cmp_lg_u32 s7, 3
    s_cbranch_scc1 g1_zs_20
    buffer_store_dwordx4 v[92:95], v8, s[48:51], s74 offen offset:3072 sc1
g1_zs_20:
    v_mfma_f32_16x16x32_bf16 a[0:3], a[8:11], v[92:95], a[0:3]
    v_mfma_f32_16x16x32_bf16 a[4:7], v[92:95], v[92:95], a[4:7]
    s_waitcnt lgkmcnt(0)
    s_barrier
    v_and_b32 v36, 3, v6
    v_lshrrev_b32 v37, 2, v6
    s_lshl_b32 s12, s3, 7
    s_add_u32 s12, s12, 81920
    v_lshlrev_b32 v39, 3, v6
    v_add_u32 v40, s12, v39
    s_nop 7
    s_nop 7
    v_accvgpr_read_b32 v44, a4
    v_accvgpr_read_b32 v45, a5
    v_accvgpr_read_b32 v46, a6
    v_accvgpr_read_b32 v47, a7
    v_accvgpr_read_b32 v48, a0
    v_mov_b32 v33, v44
    v_cmp_eq_u32 vcc, 1, v36
    s_nop 1
    v_cndmask_b32 v33, v33, v45, vcc
    v_cmp_eq_u32 vcc, 2, v36
    s_nop 1
    v_cndmask_b32 v33, v33, v46, vcc
    v_cmp_eq_u32 vcc, 3, v36
    s_nop 1
    v_cndmask_b32 v33, v33, v47, vcc
    v_cmp_eq_u32 vcc, v37, v7
    v_mov_b32 v38, 0
    s_nop 1
    v_cndmask_b32 v33, v38, v33, vcc
    v_mov_b32 v38, v33
    s_nop 1
    v_permlane16_swap_b32 v33, v38
    s_nop 1
    v_add_f32 v33, v33, v38
    v_mov_b32 v38, v33
    s_nop 1
    v_permlane32_swap_b32 v33, v38
    s_nop 1
    v_add_f32 v33, v33, v38
    s_mov_b32 s90, 0x3acccccd
    v_mul_f32 v32, s90, v48
    v_mul_f32 v33, s90, v33
    v_fma_f32 v33, -v32, v32, v33
    v_max_f32 v33, 0, v33
    v_cvt_pk_bf16_f32 v34, v32, v32
    v_lshlrev_b32 v34, 16, v34
    v_cvt_pk_bf16_f32 v33, v33, v33
    v_lshlrev_b32 v33, 16, v33
    s_mov_b32 s91, 0x3727c5ac
    v_add_f32 v33, s91, v33
    v_cvt_pk_bf16_f32 v33, v33, v33
    v_lshlrev_b32 v33, 16, v33
    v_sqrt_f32 v33, v33
    s_nop 0
    v_cvt_pk_bf16_f32 v33, v33, v33
    v_lshlrev_b32 v33, 16, v33
    v_rcp_f32 v35, v33
    s_nop 0
    v_mul_f32 v34, v34, v35
    ds_write_b64 v40, v[34:35]
    s_waitcnt lgkmcnt(0)
    s_barrier
g1_exit:
    s_endpgm
.p2align 8
.globl g2b_kernel
.type g2b_kernel,@function
g2b_kernel:
    s_mov_b32 s94, 1
    s_branch g2_body
.p2align 8
.globl g2a_kernel
.type g2a_kernel,@function
g2a_kernel:
    s_mov_b32 s94, 0
g2_body:
    s_cmp_ge_u32 s2, 256
    s_cbranch_scc1 g2_exit
    s_load_dwordx16 s[16:31], s[0:1], 0
    s_load_dwordx8 s[32:39], s[0:1], 64
    v_lshrrev_b32 v1, 6, v0
    v_and_b32 v2, 63, v0
    v_readfirstlane_b32 s3, v1
    s_and_b32 s4, s2, 7
    s_lshr_b32 s5, s2, 3
    s_lshr_b32 s6, s4, 1
    s_lshl_b32 s6, s6, 3
    s_and_b32 s7, s5, 7
    s_add_u32 s6, s6, s7
    s_and_b32 s7, s4, 1
    s_lshl_b32 s7, s7, 2
    s_lshr_b32 s8, s5, 3
    s_add_u32 s7, s7, s8
    s_mul_i32 s8, s3, 14
    s_cmp_eq_u32 s3, 3
    s_cselect_b32 s9, 1, 0
    s_sub_u32 s8, s8, s9
    s_waitcnt lgkmcnt(0)
    s_add_u32 s40, s38, 0x1800000
    s_addc_u32 s41, s39, 0
    s_mov_b32 s42, 0x6c0000
    s_mov_b32 s43, 0x00020000
    s_add_u32 s44, s38, 0x1400000
    s_addc_u32 s45, s39, 0
    s_mov_b32 s46, 0x21c000
    s_mov_b32 s47, 0x00020000
    s_add_u32 s48, s38, 0x400000
    s_addc_u32 s49, s39, 0
    s_mov_b32 s50, 0x280000
    s_mov_b32 s51, 0x00020000
    s_add_u32 s52, s38, 0x800000
    s_addc_u32 s53, s39, 0
    s_mov_b32 s54, 0x280000
    s_mov_b32 s55, 0x00020000
    s_add_u32 s56, s38, 0xc40000
    s_addc_u32 s57, s39, 0
    s_mov_b32 s58, 0x20000
    s_mov_b32 s59, 0x00020000
    s_cmp_eq_u32 s94, 0
    s_cbranch_scc1 g2_l0
    s_mov_b32 s52, s34
    s_mov_b32 s53, s35
    s_mov_b32 s54, 0x280000
    s_mov_b32 s55, 0x00020000
g2_l0:
    v_lshlrev_b32 v3, 4, v2
    s_mul_i32 s10, s6, 216
    s_add_u32 s10, s10, s8
    s_lshl_b32 s10, s10, 10
    v_add_u32 v4, s10, v3
    s_add_u32 s10, s10, 55296
    v_add_u32 v5, s10, v3
    s_add_u32 s10, s10, 55296
    v_add_u32 v6, s10, v3
    s_add_u32 s10, s10, 55296
    v_add_u32 v7, s10, v3
    s_add_u32 s10, s10, 55296
    s_mul_i32 s10, s7, 270
    s_add_u32 s10, s10, s8
    s_lshl_b32 s10, s10, 10
    v_add_u32 v8, s10, v3
    s_add_u32 s10, s10, 55296
    v_add_u32 v9, s10, v3
    s_add_u32 s10, s10, 55296
    v_add_u32 v10, s10, v3
    s_add_u32 s10, s10, 55296
    v_add_u32 v11, s10, v3
    s_add_u32 s10, s10, 55296
    v_add_u32 v12, s10, v3
    s_add_u32 s10, s10, 55296
    s_mov_b32 s70, 0
    s_mov_b32 s71, 1024
    s_mov_b32 s72, 2048
    s_mov_b32 s73, 3072
    s_mov_b32 s74, 4096
    s_mov_b32 s75, 5120
    s_mov_b32 s76, 6144
    s_mov_b32 s77, 7168
    s_mov_b32 s78, 8192
    s_mov_b32 s79, 9216
    s_mov_b32 s80, 10240
    s_mov_b32 s81, 11264
    s_mov_b32 s82, 12288
    s_mov_b32 s83, 13312
    buffer_load_dwordx4 v[16:19], v4, s[40:43], s70 offen
    buffer_load_dwordx4 v[20:23], v5, s[40:43], s70 offen
    buffer_load_dwordx4 v[24:27], v6, s[40:43], s70 offen
    buffer_load_dwordx4 v[28:31], v7, s[40:43], s70 offen
    buffer_load_dwordx4 v[32:35], v8, s[44:47], s70 offen
    buffer_load_dwordx4 v[36:39], v9, s[44:47], s70 offen
    buffer_load_dwordx4 v[40:43], v10, s[44:47], s70 offen
    buffer_load_dwordx4 v[44:47], v11, s[44:47], s70 offen
    buffer_load_dwordx4 v[48:51], v12, s[44:47], s70 offen
    buffer_load_dwordx4 v[52:55], v4, s[40:43], s71 offen
    buffer_load_dwordx4 v[56:59], v5, s[40:43], s71 offen
    buffer_load_dwordx4 v[60:63], v6, s[40:43], s71 offen
    buffer_load_dwordx4 v[64:67], v7, s[40:43], s71 offen
    buffer_load_dwordx4 v[68:71], v8, s[44:47], s71 offen
    buffer_load_dwordx4 v[72:75], v9, s[44:47], s71 offen
    buffer_load_dwordx4 v[76:79], v10, s[44:47], s71 offen
    buffer_load_dwordx4 v[80:83], v11, s[44:47], s71 offen
    buffer_load_dwordx4 v[84:87], v12, s[44:47], s71 offen
    buffer_load_dwordx4 v[88:91], v4, s[40:43], s72 offen
    buffer_load_dwordx4 v[92:95], v5, s[40:43], s72 offen
    buffer_load_dwordx4 v[96:99], v6, s[40:43], s72 offen
    buffer_load_dwordx4 v[100:103], v7, s[40:43], s72 offen
    buffer_load_dwordx4 v[104:107], v8, s[44:47], s72 offen
    buffer_load_dwordx4 v[108:111], v9, s[44:47], s72 offen
    buffer_load_dwordx4 v[112:115], v10, s[44:47], s72 offen
    buffer_load_dwordx4 v[116:119], v11, s[44:47], s72 offen
    buffer_load_dwordx4 v[120:123], v12, s[44:47], s72 offen
    buffer_load_dwordx4 v[124:127], v4, s[40:43], s73 offen
    buffer_load_dwordx4 v[128:131], v5, s[40:43], s73 offen
    buffer_load_dwordx4 v[132:135], v6, s[40:43], s73 offen
    buffer_load_dwordx4 v[136:139], v7, s[40:43], s73 offen
    buffer_load_dwordx4 v[140:143], v8, s[44:47], s73 offen
    buffer_load_dwordx4 v[144:147], v9, s[44:47], s73 offen
    buffer_load_dwordx4 v[148:151], v10, s[44:47], s73 offen
    buffer_load_dwordx4 v[152:155], v11, s[44:47], s73 offen
    buffer_load_dwordx4 v[156:159], v12, s[44:47], s73 offen
    buffer_load_dwordx4 v[160:163], v4, s[40:43], s74 offen
    buffer_load_dwordx4 v[164:167], v5, s[40:43], s74 offen
    buffer_load_dwordx4 v[168:171], v6, s[40:43], s74 offen
    buffer_load_dwordx4 v[172:175], v7, s[40:43], s74 offen
    buffer_load_dwordx4 v[176:179], v8, s[44:47], s74 offen
    buffer_load_dwordx4 v[180:183], v9, s[44:47], s74 offen
    buffer_load_dwordx4 v[184:187], v10, s[44:47], s74 offen
    buffer_load_dwordx4 v[188:191], v11, s[44:47], s74 offen
    buffer_load_dwordx4 v[192:195], v12, s[44:47], s74 offen
    v_accvgpr_write_b32 a0, 0
    v_accvgpr_write_b32 a1, 0
    v_accvgpr_write_b32 a2, 0
    v_accvgpr_write_b32 a3, 0
    v_accvgpr_write_b32 a4, 0
    v_accvgpr_write_b32 a5, 0
    v_accvgpr_write_b32 a6, 0
    v_accvgpr_write_b32 a7, 0
    v_accvgpr_write_b32 a8, 0
    v_accvgpr_write_b32 a9, 0
    v_accvgpr_write_b32 a10, 0
    v_accvgpr_write_b32 a11, 0
    v_accvgpr_write_b32 a12, 0
    v_accvgpr_write_b32 a13, 0
    v_accvgpr_write_b32 a14, 0
    v_accvgpr_write_b32 a15, 0
    v_accvgpr_write_b32 a16, 0
    v_accvgpr_write_b32 a17, 0
    v_accvgpr_write_b32 a18, 0
    v_accvgpr_write_b32 a19, 0
    v_accvgpr_write_b32 a20, 0
    v_accvgpr_write_b32 a21, 0
    v_accvgpr_write_b32 a22, 0
    v_accvgpr_write_b32 a23, 0
    v_accvgpr_write_b32 a24, 0
    v_accvgpr_write_b32 a25, 0
    v_accvgpr_write_b32 a26, 0
    v_accvgpr_write_b32 a27, 0
    v_accvgpr_write_b32 a28, 0
    v_accvgpr_write_b32 a29, 0
    v_accvgpr_write_b32 a30, 0
    v_accvgpr_write_b32 a31, 0
    v_accvgpr_write_b32 a32, 0
    v_accvgpr_write_b32 a33, 0
    v_accvgpr_write_b32 a34, 0
    v_accvgpr_write_b32 a35, 0
    v_accvgpr_write_b32 a36, 0
    v_accvgpr_write_b32 a37, 0
    v_accvgpr_write_b32 a38, 0
    v_accvgpr_write_b32 a39, 0
    v_accvgpr_write_b32 a40, 0
    v_accvgpr_write_b32 a41, 0
    v_accvgpr_write_b32 a42, 0
    v_accvgpr_write_b32 a43, 0
    v_accvgpr_write_b32 a44, 0
    v_accvgpr_write_b32 a45, 0
    v_accvgpr_write_b32 a46, 0
    v_accvgpr_write_b32 a47, 0
    v_accvgpr_write_b32 a48, 0
    v_accvgpr_write_b32 a49, 0
    v_accvgpr_write_b32 a50, 0
    v_accvgpr_write_b32 a51, 0
    v_accvgpr_write_b32 a52, 0
    v_accvgpr_write_b32 a53, 0
    v_accvgpr_write_b32 a54, 0
    v_accvgpr_write_b32 a55, 0
    v_accvgpr_write_b32 a56, 0
    v_accvgpr_write_b32 a57, 0
    v_accvgpr_write_b32 a58, 0
    v_accvgpr_write_b32 a59, 0
    v_accvgpr_write_b32 a60, 0
    v_accvgpr_write_b32 a61, 0
    v_accvgpr_write_b32 a62, 0
    v_accvgpr_write_b32 a63, 0
    v_accvgpr_write_b32 a64, 0
    v_accvgpr_write_b32 a65, 0
    v_accvgpr_write_b32 a66, 0
    v_accvgpr_write_b32 a67, 0
    v_accvgpr_write_b32 a68, 0
    v_accvgpr_write_b32 a69, 0
    v_accvgpr_write_b32 a70, 0
    v_accvgpr_write_b32 a71, 0
    v_accvgpr_write_b32 a72, 0
    v_accvgpr_write_b32 a73, 0
    v_accvgpr_write_b32 a74, 0
    v_accvgpr_write_b32 a75, 0
    v_accvgpr_write_b32 a76, 0
    v_accvgpr_write_b32 a77, 0
    v_accvgpr_write_b32 a78, 0
    v_accvgpr_write_b32 a79, 0
    s_waitcnt vmcnt(36)
    buffer_load_dwordx4 v[196:199], v4, s[40:43], s75 offen
    buffer_load_dwordx4 v[200:203], v5, s[40:43], s75 offen
    buffer_load_dwordx4 v[204:207], v6, s[40:43], s75 offen
    buffer_load_dwordx4 v[208:211], v7, s[40:43], s75 offen
    buffer_load_dwordx4 v[212:215], v8, s[44:47], s75 offen
    buffer_load_dwordx4 v[216:219], v9, s[44:47], s75 offen
    buffer_load_dwordx4 v[220:223], v10, s[44:47], s75 offen
    buffer_load_dwordx4 v[224:227], v11, s[44:47], s75 offen
    buffer_load_dwordx4 v[228:231], v12, s[44:47], s75 offen
    v_mfma_f32_16x16x32_bf16 a[0:3], v[32:35], v[16:19], a[0:3]
    v_mfma_f32_16x16x32_bf16 a[4:7], v[36:39], v[16:19], a[4:7]
    v_mfma_f32_16x16x32_bf16 a[8:11], v[40:43], v[16:19], a[8:11]
    v_mfma_f32_16x16x32_bf16 a[12:15], v[44:47], v[16:19], a[12:15]
    v_mfma_f32_16x16x32_bf16 a[16:19], v[48:51], v[16:19], a[16:19]
    v_mfma_f32_16x16x32_bf16 a[20:23], v[32:35], v[20:23], a[20:23]
    v_mfma_f32_16x16x32_bf16 a[24:27], v[36:39], v[20:23], a[24:27]
    v_mfma_f32_16x16x32_bf16 a[28:31], v[40:43], v[20:23], a[28:31]
    v_mfma_f32_16x16x32_bf16 a[32:35], v[44:47], v[20:23], a[32:35]
    v_mfma_f32_16x16x32_bf16 a[36:39], v[48:51], v[20:23], a[36:39]
    v_mfma_f32_16x16x32_bf16 a[40:43], v[32:35], v[24:27], a[40:43]
    v_mfma_f32_16x16x32_bf16 a[44:47], v[36:39], v[24:27], a[44:47]
    v_mfma_f32_16x16x32_bf16 a[48:51], v[40:43], v[24:27], a[48:51]
    v_mfma_f32_16x16x32_bf16 a[52:55], v[44:47], v[24:27], a[52:55]
    v_mfma_f32_16x16x32_bf16 a[56:59], v[48:51], v[24:27], a[56:59]
    v_mfma_f32_16x16x32_bf16 a[60:63], v[32:35], v[28:31], a[60:63]
    v_mfma_f32_16x16x32_bf16 a[64:67], v[36:39], v[28:31], a[64:67]
    v_mfma_f32_16x16x32_bf16 a[68:71], v[40:43], v[28:31], a[68:71]
    v_mfma_f32_16x16x32_bf16 a[72:75], v[44:47], v[28:31], a[72:75]
    v_mfma_f32_16x16x32_bf16 a[76:79], v[48:51], v[28:31], a[76:79]
    s_waitcnt vmcnt(36)
    buffer_load_dwordx4 v[16:19], v4, s[40:43], s76 offen
    buffer_load_dwordx4 v[20:23], v5, s[40:43], s76 offen
    buffer_load_dwordx4 v[24:27], v6, s[40:43], s76 offen
    buffer_load_dwordx4 v[28:31], v7, s[40:43], s76 offen
    buffer_load_dwordx4 v[32:35], v8, s[44:47], s76 offen
    buffer_load_dwordx4 v[36:39], v9, s[44:47], s76 offen
    buffer_load_dwordx4 v[40:43], v10, s[44:47], s76 offen
    buffer_load_dwordx4 v[44:47], v11, s[44:47], s76 offen
    buffer_load_dwordx4 v[48:51], v12, s[44:47], s76 offen
    v_mfma_f32_16x16x32_bf16 a[0:3], v[68:71], v[52:55], a[0:3]
    v_mfma_f32_16x16x32_bf16 a[4:7], v[72:75], v[52:55], a[4:7]
    v_mfma_f32_16x16x32_bf16 a[8:11], v[76:79], v[52:55], a[8:11]
    v_mfma_f32_16x16x32_bf16 a[12:15], v[80:83], v[52:55], a[12:15]
    v_mfma_f32_16x16x32_bf16 a[16:19], v[84:87], v[52:55], a[16:19]
    v_mfma_f32_16x16x32_bf16 a[20:23], v[68:71], v[56:59], a[20:23]
    v_mfma_f32_16x16x32_bf16 a[24:27], v[72:75], v[56:59], a[24:27]
    v_mfma_f32_16x16x32_bf16 a[28:31], v[76:79], v[56:59], a[28:31]
    v_mfma_f32_16x16x32_bf16 a[32:35], v[80:83], v[56:59], a[32:35]
    v_mfma_f32_16x16x32_bf16 a[36:39], v[84:87], v[56:59], a[36:39]
    v_mfma_f32_16x16x32_bf16 a[40:43], v[68:71], v[60:63], a[40:43]
    v_mfma_f32_16x16x32_bf16 a[44:47], v[72:75], v[60:63], a[44:47]
    v_mfma_f32_16x16x32_bf16 a[48:51], v[76:79], v[60:63], a[48:51]
    v_mfma_f32_16x16x32_bf16 a[52:55], v[80:83], v[60:63], a[52:55]
    v_mfma_f32_16x16x32_bf16 a[56:59], v[84:87], v[60:63], a[56:59]
    v_mfma_f32_16x16x32_bf16 a[60:63], v[68:71], v[64:67], a[60:63]
    v_mfma_f32_16x16x32_bf16 a[64:67], v[72:75], v[64:67], a[64:67]
    v_mfma_f32_16x16x32_bf16 a[68:71], v[76:79], v[64:67], a[68:71]
    v_mfma_f32_16x16x32_bf16 a[72:75], v[80:83], v[64:67], a[72:75]
    v_mfma_f32_16x16x32_bf16 a[76:79], v[84:87], v[64:67], a[76:79]
    s_waitcnt vmcnt(36)
    buffer_load_dwordx4 v[52:55], v4, s[40:43], s77 offen
    buffer_load_dwordx4 v[56:59], v5, s[40:43], s77 offen
    buffer_load_dwordx4 v[60:63], v6, s[40:43], s77 offen
    buffer_load_dwordx4 v[64:67], v7, s[40:43], s77 offen
    buffer_load_dwordx4 v[68:71], v8, s[44:47], s77 offen
    buffer_load_dwordx4 v[72:75], v9, s[44:47], s77 offen
    buffer_load_dwordx4 v[76:79], v10, s[44:47], s77 offen
    buffer_load_dwordx4 v[80:83], v11, s[44:47], s77 offen
    buffer_load_dwordx4 v[84:87], v12, s[44:47], s77 offen
    v_mfma_f32_16x16x32_bf16 a[0:3], v[104:107], v[88:91], a[0:3]
    v_mfma_f32_16x16x32_bf16 a[4:7], v[108:111], v[88:91], a[4:7]
    v_mfma_f32_16x16x32_bf16 a[8:11], v[112:115], v[88:91], a[8:11]
    v_mfma_f32_16x16x32_bf16 a[12:15], v[116:119], v[88:91], a[12:15]
    v_mfma_f32_16x16x32_bf16 a[16:19], v[120:123], v[88:91], a[16:19]
    v_mfma_f32_16x16x32_bf16 a[20:23], v[104:107], v[92:95], a[20:23]
    v_mfma_f32_16x16x32_bf16 a[24:27], v[108:111], v[92:95], a[24:27]
    v_mfma_f32_16x16x32_bf16 a[28:31], v[112:115], v[92:95], a[28:31]
    v_mfma_f32_16x16x32_bf16 a[32:35], v[116:119], v[92:95], a[32:35]
    v_mfma_f32_16x16x32_bf16 a[36:39], v[120:123], v[92:95], a[36:39]
    v_mfma_f32_16x16x32_bf16 a[40:43], v[104:107], v[96:99], a[40:43]
    v_mfma_f32_16x16x32_bf16 a[44:47], v[108:111], v[96:99], a[44:47]
    v_mfma_f32_16x16x32_bf16 a[48:51], v[112:115], v[96:99], a[48:51]
    v_mfma_f32_16x16x32_bf16 a[52:55], v[116:119], v[96:99], a[52:55]
    v_mfma_f32_16x16x32_bf16 a[56:59], v[120:123], v[96:99], a[56:59]
    v_mfma_f32_16x16x32_bf16 a[60:63], v[104:107], v[100:103], a[60:63]
    v_mfma_f32_16x16x32_bf16 a[64:67], v[108:111], v[100:103], a[64:67]
    v_mfma_f32_16x16x32_bf16 a[68:71], v[112:115], v[100:103], a[68:71]
    v_mfma_f32_16x16x32_bf16 a[72:75], v[116:119], v[100:103], a[72:75]
    v_mfma_f32_16x16x32_bf16 a[76:79], v[120:123], v[100:103], a[76:79]
    s_waitcnt vmcnt(36)
    buffer_load_dwordx4 v[88:91], v4, s[40:43], s78 offen
    buffer_load_dwordx4 v[92:95], v5, s[40:43], s78 offen
    buffer_load_dwordx4 v[96:99], v6, s[40:43], s78 offen
    buffer_load_dwordx4 v[100:103], v7, s[40:43], s78 offen
    buffer_load_dwordx4 v[104:107], v8, s[44:47], s78 offen
    buffer_load_dwordx4 v[108:111], v9, s[44:47], s78 offen
    buffer_load_dwordx4 v[112:115], v10, s[44:47], s78 offen
    buffer_load_dwordx4 v[116:119], v11, s[44:47], s78 offen
    buffer_load_dwordx4 v[120:123], v12, s[44:47], s78 offen
    v_mfma_f32_16x16x32_bf16 a[0:3], v[140:143], v[124:127], a[0:3]
    v_mfma_f32_16x16x32_bf16 a[4:7], v[144:147], v[124:127], a[4:7]
    v_mfma_f32_16x16x32_bf16 a[8:11], v[148:151], v[124:127], a[8:11]
    v_mfma_f32_16x16x32_bf16 a[12:15], v[152:155], v[124:127], a[12:15]
    v_mfma_f32_16x16x32_bf16 a[16:19], v[156:159], v[124:127], a[16:19]
    v_mfma_f32_16x16x32_bf16 a[20:23], v[140:143], v[128:131], a[20:23]
    v_mfma_f32_16x16x32_bf16 a[24:27], v[144:147], v[128:131], a[24:27]
    v_mfma_f32_16x16x32_bf16 a[28:31], v[148:151], v[128:131], a[28:31]
    v_mfma_f32_16x16x32_bf16 a[32:35], v[152:155], v[128:131], a[32:35]
    v_mfma_f32_16x16x32_bf16 a[36:39], v[156:159], v[128:131], a[36:39]
    v_mfma_f32_16x16x32_bf16 a[40:43], v[140:143], v[132:135], a[40:43]
    v_mfma_f32_16x16x32_bf16 a[44:47], v[144:147], v[132:135], a[44:47]
    v_mfma_f32_16x16x32_bf16 a[48:51], v[148:151], v[132:135], a[48:51]
    v_mfma_f32_16x16x32_bf16 a[52:55], v[152:155], v[132:135], a[52:55]
    v_mfma_f32_16x16x32_bf16 a[56:59], v[156:159], v[132:135], a[56:59]
    v_mfma_f32_16x16x32_bf16 a[60:63], v[140:143], v[136:139], a[60:63]
    v_mfma_f32_16x16x32_bf16 a[64:67], v[144:147], v[136:139], a[64:67]
    v_mfma_f32_16x16x32_bf16 a[68:71], v[148:151], v[136:139], a[68:71]
    v_mfma_f32_16x16x32_bf16 a[72:75], v[152:155], v[136:139], a[72:75]
    v_mfma_f32_16x16x32_bf16 a[76:79], v[156:159], v[136:139], a[76:79]
    s_waitcnt vmcnt(36)
    buffer_load_dwordx4 v[124:127], v4, s[40:43], s79 offen
    buffer_load_dwordx4 v[128:131], v5, s[40:43], s79 offen
    buffer_load_dwordx4 v[132:135], v6, s[40:43], s79 offen
    buffer_load_dwordx4 v[136:139], v7, s[40:43], s79 offen
    buffer_load_dwordx4 v[140:143], v8, s[44:47], s79 offen
    buffer_load_dwordx4 v[144:147], v9, s[44:47], s79 offen
    buffer_load_dwordx4 v[148:151], v10, s[44:47], s79 offen
    buffer_load_dwordx4 v[152:155], v11, s[44:47], s79 offen
    buffer_load_dwordx4 v[156:159], v12, s[44:47], s79 offen
    v_mfma_f32_16x16x32_bf16 a[0:3], v[176:179], v[160:163], a[0:3]
    v_mfma_f32_16x16x32_bf16 a[4:7], v[180:183], v[160:163], a[4:7]
    v_mfma_f32_16x16x32_bf16 a[8:11], v[184:187], v[160:163], a[8:11]
    v_mfma_f32_16x16x32_bf16 a[12:15], v[188:191], v[160:163], a[12:15]
    v_mfma_f32_16x16x32_bf16 a[16:19], v[192:195], v[160:163], a[16:19]
    v_mfma_f32_16x16x32_bf16 a[20:23], v[176:179], v[164:167], a[20:23]
    v_mfma_f32_16x16x32_bf16 a[24:27], v[180:183], v[164:167], a[24:27]
    v_mfma_f32_16x16x32_bf16 a[28:31], v[184:187], v[164:167], a[28:31]
    v_mfma_f32_16x16x32_bf16 a[32:35], v[188:191], v[164:167], a[32:35]
    v_mfma_f32_16x16x32_bf16 a[36:39], v[192:195], v[164:167], a[36:39]
    v_mfma_f32_16x16x32_bf16 a[40:43], v[176:179], v[168:171], a[40:43]
    v_mfma_f32_16x16x32_bf16 a[44:47], v[180:183], v[168:171], a[44:47]
    v_mfma_f32_16x16x32_bf16 a[48:51], v[184:187], v[168:171], a[48:51]
    v_mfma_f32_16x16x32_bf16 a[52:55], v[188:191], v[168:171], a[52:55]
    v_mfma_f32_16x16x32_bf16 a[56:59], v[192:195], v[168:171], a[56:59]
    v_mfma_f32_16x16x32_bf16 a[60:63], v[176:179], v[172:175], a[60:63]
    v_mfma_f32_16x16x32_bf16 a[64:67], v[180:183], v[172:175], a[64:67]
    v_mfma_f32_16x16x32_bf16 a[68:71], v[184:187], v[172:175], a[68:71]
    v_mfma_f32_16x16x32_bf16 a[72:75], v[188:191], v[172:175], a[72:75]
    v_mfma_f32_16x16x32_bf16 a[76:79], v[192:195], v[172:175], a[76:79]
    s_waitcnt vmcnt(36)
    buffer_load_dwordx4 v[160:163], v4, s[40:43], s80 offen
    buffer_load_dwordx4 v[164:167], v5, s[40:43], s80 offen
    buffer_load_dwordx4 v[168:171], v6, s[40:43], s80 offen
    buffer_load_dwordx4 v[172:175], v7, s[40:43], s80 offen
    buffer_load_dwordx4 v[176:179], v8, s[44:47], s80 offen
    buffer_load_dwordx4 v[180:183], v9, s[44:47], s80 offen
    buffer_load_dwordx4 v[184:187], v10, s[44:47], s80 offen
    buffer_load_dwordx4 v[188:191], v11, s[44:47], s80 offen
    buffer_load_dwordx4 v[192:195], v12, s[44:47], s80 offen
    v_mfma_f32_16x16x32_bf16 a[0:3], v[212:215], v[196:199], a[0:3]
    v_mfma_f32_16x16x32_bf16 a[4:7], v[216:219], v[196:199], a[4:7]
    v_mfma_f32_16x16x32_bf16 a[8:11], v[220:223], v[196:199], a[8:11]
    v_mfma_f32_16x16x32_bf16 a[12:15], v[224:227], v[196:199], a[12:15]
    v_mfma_f32_16x16x32_bf16 a[16:19], v[228:231], v[196:199], a[16:19]
    v_mfma_f32_16x16x32_bf16 a[20:23], v[212:215], v[200:203], a[20:23]
    v_mfma_f32_16x16x32_bf16 a[24:27], v[216:219], v[200:203], a[24:27]
    v_mfma_f32_16x16x32_bf16 a[28:31], v[220:223], v[200:203], a[28:31]
    v_mfma_f32_16x16x32_bf16 a[32:35], v[224:227], v[200:203], a[32:35]
    v_mfma_f32_16x16x32_bf16 a[36:39], v[228:231], v[200:203], a[36:39]
    v_mfma_f32_16x16x32_bf16 a[40:43], v[212:215], v[204:207], a[40:43]
    v_mfma_f32_16x16x32_bf16 a[44:47], v[216:219], v[204:207], a[44:47]
    v_mfma_f32_16x16x32_bf16 a[48:51], v[220:223], v[204:207], a[48:51]
    v_mfma_f32_16x16x32_bf16 a[52:55], v[224:227], v[204:207], a[52:55]
    v_mfma_f32_16x16x32_bf16 a[56:59], v[228:231], v[204:207], a[56:59]
    v_mfma_f32_16x16x32_bf16 a[60:63], v[212:215], v[208:211], a[60:63]
    v_mfma_f32_16x16x32_bf16 a[64:67], v[216:219], v[208:211], a[64:67]
    v_mfma_f32_16x16x32_bf16 a[68:71], v[220:223], v[208:211], a[68:71]
    v_mfma_f32_16x16x32_bf16 a[72:75], v[224:227], v[208:211], a[72:75]
    v_mfma_f32_16x16x32_bf16 a[76:79], v[228:231], v[208:211], a[76:79]
    s_waitcnt vmcnt(36)
    buffer_load_dwordx4 v[196:199], v4, s[40:43], s81 offen
    buffer_load_dwordx4 v[200:203], v5, s[40:43], s81 offen
    buffer_load_dwordx4 v[204:207], v6, s[40:43], s81 offen
    buffer_load_dwordx4 v[208:211], v7, s[40:43], s81 offen
    buffer_load_dwordx4 v[212:215], v8, s[44:47], s81 offen
    buffer_load_dwordx4 v[216:219], v9, s[44:47], s81 offen
    buffer_load_dwordx4 v[220:223], v10, s[44:47], s81 offen
    buffer_load_dwordx4 v[224:227], v11, s[44:47], s81 offen
    buffer_load_dwordx4 v[228:231], v12, s[44:47], s81 offen
    v_mfma_f32_16x16x32_bf16 a[0:3], v[32:35], v[16:19], a[0:3]
    v_mfma_f32_16x16x32_bf16 a[4:7], v[36:39], v[16:19], a[4:7]
    v_mfma_f32_16x16x32_bf16 a[8:11], v[40:43], v[16:19], a[8:11]
    v_mfma_f32_16x16x32_bf16 a[12:15], v[44:47], v[16:19], a[12:15]
    v_mfma_f32_16x16x32_bf16 a[16:19], v[48:51], v[16:19], a[16:19]
    v_mfma_f32_16x16x32_bf16 a[20:23], v[32:35], v[20:23], a[20:23]
    v_mfma_f32_16x16x32_bf16 a[24:27], v[36:39], v[20:23], a[24:27]
    v_mfma_f32_16x16x32_bf16 a[28:31], v[40:43], v[20:23], a[28:31]
    v_mfma_f32_16x16x32_bf16 a[32:35], v[44:47], v[20:23], a[32:35]
    v_mfma_f32_16x16x32_bf16 a[36:39], v[48:51], v[20:23], a[36:39]
    v_mfma_f32_16x16x32_bf16 a[40:43], v[32:35], v[24:27], a[40:43]
    v_mfma_f32_16x16x32_bf16 a[44:47], v[36:39], v[24:27], a[44:47]
    v_mfma_f32_16x16x32_bf16 a[48:51], v[40:43], v[24:27], a[48:51]
    v_mfma_f32_16x16x32_bf16 a[52:55], v[44:47], v[24:27], a[52:55]
    v_mfma_f32_16x16x32_bf16 a[56:59], v[48:51], v[24:27], a[56:59]
    v_mfma_f32_16x16x32_bf16 a[60:63], v[32:35], v[28:31], a[60:63]
    v_mfma_f32_16x16x32_bf16 a[64:67], v[36:39], v[28:31], a[64:67]
    v_mfma_f32_16x16x32_bf16 a[68:71], v[40:43], v[28:31], a[68:71]
    v_mfma_f32_16x16x32_bf16 a[72:75], v[44:47], v[28:31], a[72:75]
    v_mfma_f32_16x16x32_bf16 a[76:79], v[48:51], v[28:31], a[76:79]
    s_waitcnt vmcnt(36)
    buffer_load_dwordx4 v[16:19], v4, s[40:43], s82 offen
    buffer_load_dwordx4 v[20:23], v5, s[40:43], s82 offen
    buffer_load_dwordx4 v[24:27], v6, s[40:43], s82 offen
    buffer_load_dwordx4 v[28:31], v7, s[40:43], s82 offen
    buffer_load_dwordx4 v[32:35], v8, s[44:47], s82 offen
    buffer_load_dwordx4 v[36:39], v9, s[44:47], s82 offen
    buffer_load_dwordx4 v[40:43], v10, s[44:47], s82 offen
    buffer_load_dwordx4 v[44:47], v11, s[44:47], s82 offen
    buffer_load_dwordx4 v[48:51], v12, s[44:47], s82 offen
    v_mfma_f32_16x16x32_bf16 a[0:3], v[68:71], v[52:55], a[0:3]
    v_mfma_f32_16x16x32_bf16 a[4:7], v[72:75], v[52:55], a[4:7]
    v_mfma_f32_16x16x32_bf16 a[8:11], v[76:79], v[52:55], a[8:11]
    v_mfma_f32_16x16x32_bf16 a[12:15], v[80:83], v[52:55], a[12:15]
    v_mfma_f32_16x16x32_bf16 a[16:19], v[84:87], v[52:55], a[16:19]
    v_mfma_f32_16x16x32_bf16 a[20:23], v[68:71], v[56:59], a[20:23]
    v_mfma_f32_16x16x32_bf16 a[24:27], v[72:75], v[56:59], a[24:27]
    v_mfma_f32_16x16x32_bf16 a[28:31], v[76:79], v[56:59], a[28:31]
    v_mfma_f32_16x16x32_bf16 a[32:35], v[80:83], v[56:59], a[32:35]
    v_mfma_f32_16x16x32_bf16 a[36:39], v[84:87], v[56:59], a[36:39]
    v_mfma_f32_16x16x32_bf16 a[40:43], v[68:71], v[60:63], a[40:43]
    v_mfma_f32_16x16x32_bf16 a[44:47], v[72:75], v[60:63], a[44:47]
    v_mfma_f32_16x16x32_bf16 a[48:51], v[76:79], v[60:63], a[48:51]
    v_mfma_f32_16x16x32_bf16 a[52:55], v[80:83], v[60:63], a[52:55]
    v_mfma_f32_16x16x32_bf16 a[56:59], v[84:87], v[60:63], a[56:59]
    v_mfma_f32_16x16x32_bf16 a[60:63], v[68:71], v[64:67], a[60:63]
    v_mfma_f32_16x16x32_bf16 a[64:67], v[72:75], v[64:67], a[64:67]
    v_mfma_f32_16x16x32_bf16 a[68:71], v[76:79], v[64:67], a[68:71]
    v_mfma_f32_16x16x32_bf16 a[72:75], v[80:83], v[64:67], a[72:75]
    v_mfma_f32_16x16x32_bf16 a[76:79], v[84:87], v[64:67], a[76:79]
    s_waitcnt vmcnt(36)
    buffer_load_dwordx4 v[52:55], v4, s[40:43], s83 offen
    buffer_load_dwordx4 v[56:59], v5, s[40:43], s83 offen
    buffer_load_dwordx4 v[60:63], v6, s[40:43], s83 offen
    buffer_load_dwordx4 v[64:67], v7, s[40:43], s83 offen
    buffer_load_dwordx4 v[68:71], v8, s[44:47], s83 offen
    buffer_load_dwordx4 v[72:75], v9, s[44:47], s83 offen
    buffer_load_dwordx4 v[76:79], v10, s[44:47], s83 offen
    buffer_load_dwordx4 v[80:83], v11, s[44:47], s83 offen
    buffer_load_dwordx4 v[84:87], v12, s[44:47], s83 offen
    v_and_b32 v13, 15, v2
    v_lshrrev_b32 v15, 4, v2
    v_lshrrev_b32 v14, 1, v15
    v_lshl_add_u32 v14, v14, 4, v13
    v_lshlrev_b32 v14, 4, v14
    v_and_b32 v15, 1, v15
    v_lshl_add_u32 v14, v15, 3, v14
    s_lshl_b32 s12, s6, 2
    s_add_u32 s12, s12, s3
    s_mul_i32 s12, s12, 20480
    s_mul_i32 s13, s7, 80
    s_add_u32 s14, s13, 0
    s_lshr_b32 s15, s14, 5
    s_lshl_b32 s15, s15, 10
    s_lshr_b32 s14, s14, 3
    s_and_b32 s14, s14, 3
    s_lshl_b32 s14, s14, 8
    s_add_u32 s15, s15, s14
    s_add_u32 s60, s15, s12
    s_add_u32 s14, s13, 16
    s_lshr_b32 s15, s14, 5
    s_lshl_b32 s15, s15, 10
    s_lshr_b32 s14, s14, 3
    s_and_b32 s14, s14, 3
    s_lshl_b32 s14, s14, 8
    s_add_u32 s15, s15, s14
    s_add_u32 s61, s15, s12
    s_add_u32 s14, s13, 32
    s_lshr_b32 s15, s14, 5
    s_lshl_b32 s15, s15, 10
    s_lshr_b32 s14, s14, 3
    s_and_b32 s14, s14, 3
    s_lshl_b32 s14, s14, 8
    s_add_u32 s15, s15, s14
    s_add_u32 s62, s15, s12
    s_add_u32 s14, s13, 48
    s_lshr_b32 s15, s14, 5
    s_lshl_b32 s15, s15, 10
    s_lshr_b32 s14, s14, 3
    s_and_b32 s14, s14, 3
    s_lshl_b32 s14, s14, 8
    s_add_u32 s15, s15, s14
    s_add_u32 s63, s15, s12
    s_add_u32 s14, s13, 64
    s_lshr_b32 s15, s14, 5
    s_lshl_b32 s15, s15, 10
    s_lshr_b32 s14, s14, 3
    s_and_b32 s14, s14, 3
    s_lshl_b32 s14, s14, 8
    s_add_u32 s15, s15, s14
    s_add_u32 s64, s15, s12
    buffer_load_dwordx2 v[232:233], v14, s[48:51], s60 offen
    buffer_load_dwordx2 v[234:235], v14, s[48:51], s61 offen
    buffer_load_dwordx2 v[236:237], v14, s[48:51], s62 offen
    buffer_load_dwordx2 v[238:239], v14, s[48:51], s63 offen
    buffer_load_dwordx2 v[240:241], v14, s[48:51], s64 offen
    v_mfma_f32_16x16x32_bf16 a[0:3], v[104:107], v[88:91], a[0:3]
    v_mfma_f32_16x16x32_bf16 a[4:7], v[108:111], v[88:91], a[4:7]
    v_mfma_f32_16x16x32_bf16 a[8:11], v[112:115], v[88:91], a[8:11]
    v_mfma_f32_16x16x32_bf16 a[12:15], v[116:119], v[88:91], a[12:15]
    v_mfma_f32_16x16x32_bf16 a[16:19], v[120:123], v[88:91], a[16:19]
    v_mfma_f32_16x16x32_bf16 a[20:23], v[104:107], v[92:95], a[20:23]
    v_mfma_f32_16x16x32_bf16 a[24:27], v[108:111], v[92:95], a[24:27]
    v_mfma_f32_16x16x32_bf16 a[28:31], v[112:115], v[92:95], a[28:31]
    v_mfma_f32_16x16x32_bf16 a[32:35], v[116:119], v[92:95], a[32:35]
    v_mfma_f32_16x16x32_bf16 a[36:39], v[120:123], v[92:95], a[36:39]
    v_mfma_f32_16x16x32_bf16 a[40:43], v[104:107], v[96:99], a[40:43]
    v_mfma_f32_16x16x32_bf16 a[44:47], v[108:111], v[96:99], a[44:47]
    v_mfma_f32_16x16x32_bf16 a[48:51], v[112:115], v[96:99], a[48:51]
    v_mfma_f32_16x16x32_bf16 a[52:55], v[116:119], v[96:99], a[52:55]
    v_mfma_f32_16x16x32_bf16 a[56:59], v[120:123], v[96:99], a[56:59]
    v_mfma_f32_16x16x32_bf16 a[60:63], v[104:107], v[100:103], a[60:63]
    v_mfma_f32_16x16x32_bf16 a[64:67], v[108:111], v[100:103], a[64:67]
    v_mfma_f32_16x16x32_bf16 a[68:71], v[112:115], v[100:103], a[68:71]
    v_mfma_f32_16x16x32_bf16 a[72:75], v[116:119], v[100:103], a[72:75]
    v_mfma_f32_16x16x32_bf16 a[76:79], v[120:123], v[100:103], a[76:79]
    s_waitcnt vmcnt(41)
    v_mfma_f32_16x16x32_bf16 a[0:3], v[140:143], v[124:127], a[0:3]
    v_mfma_f32_16x16x32_bf16 a[4:7], v[144:147], v[124:127], a[4:7]
    v_mfma_f32_16x16x32_bf16 a[8:11], v[148:151], v[124:127], a[8:11]
    v_mfma_f32_16x16x32_bf16 a[12:15], v[152:155], v[124:127], a[12:15]
    v_mfma_f32_16x16x32_bf16 a[16:19], v[156:159], v[124:127], a[16:19]
    v_mfma_f32_16x16x32_bf16 a[20:23], v[140:143], v[128:131], a[20:23]
    v_mfma_f32_16x16x32_bf16 a[24:27], v[144:147], v[128:131], a[24:27]
    v_mfma_f32_16x16x32_bf16 a[28:31], v[148:151], v[128:131], a[28:31]
    v_mfma_f32_16x16x32_bf16 a[32:35], v[152:155], v[128:131], a[32:35]
    v_mfma_f32_16x16x32_bf16 a[36:39], v[156:159], v[128:131], a[36:39]
    v_mfma_f32_16x16x32_bf16 a[40:43], v[140:143], v[132:135], a[40:43]
    v_mfma_f32_16x16x32_bf16 a[44:47], v[144:147], v[132:135], a[44:47]
    v_mfma_f32_16x16x32_bf16 a[48:51], v[148:151], v[132:135], a[48:51]
    v_mfma_f32_16x16x32_bf16 a[52:55], v[152:155], v[132:135], a[52:55]
    v_mfma_f32_16x16x32_bf16 a[56:59], v[156:159], v[132:135], a[56:59]
    v_mfma_f32_16x16x32_bf16 a[60:63], v[140:143], v[136:139], a[60:63]
    v_mfma_f32_16x16x32_bf16 a[64:67], v[144:147], v[136:139], a[64:67]
    v_mfma_f32_16x16x32_bf16 a[68:71], v[148:151], v[136:139], a[68:71]
    v_mfma_f32_16x16x32_bf16 a[72:75], v[152:155], v[136:139], a[72:75]
    v_mfma_f32_16x16x32_bf16 a[76:79], v[156:159], v[136:139], a[76:79]
    s_waitcnt vmcnt(32)
    v_mfma_f32_16x16x32_bf16 a[0:3], v[176:179], v[160:163], a[0:3]
    v_mfma_f32_16x16x32_bf16 a[4:7], v[180:183], v[160:163], a[4:7]
    v_mfma_f32_16x16x32_bf16 a[8:11], v[184:187], v[160:163], a[8:11]
    v_mfma_f32_16x16x32_bf16 a[12:15], v[188:191], v[160:163], a[12:15]
    v_mfma_f32_16x16x32_bf16 a[16:19], v[192:195], v[160:163], a[16:19]
    v_mfma_f32_16x16x32_bf16 a[20:23], v[176:179], v[164:167], a[20:23]
    v_mfma_f32_16x16x32_bf16 a[24:27], v[180:183], v[164:167], a[24:27]
    v_mfma_f32_16x16x32_bf16 a[28:31], v[184:187], v[164:167], a[28:31]
    v_mfma_f32_16x16x32_bf16 a[32:35], v[188:191], v[164:167], a[32:35]
    v_mfma_f32_16x16x32_bf16 a[36:39], v[192:195], v[164:167], a[36:39]
    v_mfma_f32_16x16x32_bf16 a[40:43], v[176:179], v[168:171], a[40:43]
    v_mfma_f32_16x16x32_bf16 a[44:47], v[180:183], v[168:171], a[44:47]
    v_mfma_f32_16x16x32_bf16 a[48:51], v[184:187], v[168:171], a[48:51]
    v_mfma_f32_16x16x32_bf16 a[52:55], v[188:191], v[168:171], a[52:55]
    v_mfma_f32_16x16x32_bf16 a[56:59], v[192:195], v[168:171], a[56:59]
    v_mfma_f32_16x16x32_bf16 a[60:63], v[176:179], v[172:175], a[60:63]
    v_mfma_f32_16x16x32_bf16 a[64:67], v[180:183], v[172:175], a[64:67]
    v_mfma_f32_16x16x32_bf16 a[68:71], v[184:187], v[172:175], a[68:71]
    v_mfma_f32_16x16x32_bf16 a[72:75], v[188:191], v[172:175], a[72:75]
    v_mfma_f32_16x16x32_bf16 a[76:79], v[192:195], v[172:175], a[76:79]
    s_waitcnt vmcnt(23)
    v_mfma_f32_16x16x32_bf16 a[0:3], v[212:215], v[196:199], a[0:3]
    v_mfma_f32_16x16x32_bf16 a[4:7], v[216:219], v[196:199], a[4:7]
    v_mfma_f32_16x16x32_bf16 a[8:11], v[220:223], v[196:199], a[8:11]
    v_mfma_f32_16x16x32_bf16 a[12:15], v[224:227], v[196:199], a[12:15]
    v_mfma_f32_16x16x32_bf16 a[16:19], v[228:231], v[196:199], a[16:19]
    v_mfma_f32_16x16x32_bf16 a[20:23], v[212:215], v[200:203], a[20:23]
    v_mfma_f32_16x16x32_bf16 a[24:27], v[216:219], v[200:203], a[24:27]
    v_mfma_f32_16x16x32_bf16 a[28:31], v[220:223], v[200:203], a[28:31]
    v_mfma_f32_16x16x32_bf16 a[32:35], v[224:227], v[200:203], a[32:35]
    v_mfma_f32_16x16x32_bf16 a[36:39], v[228:231], v[200:203], a[36:39]
    v_mfma_f32_16x16x32_bf16 a[40:43], v[212:215], v[204:207], a[40:43]
    v_mfma_f32_16x16x32_bf16 a[44:47], v[216:219], v[204:207], a[44:47]
    v_mfma_f32_16x16x32_bf16 a[48:51], v[220:223], v[204:207], a[48:51]
    v_mfma_f32_16x16x32_bf16 a[52:55], v[224:227], v[204:207], a[52:55]
    v_mfma_f32_16x16x32_bf16 a[56:59], v[228:231], v[204:207], a[56:59]
    v_mfma_f32_16x16x32_bf16 a[60:63], v[212:215], v[208:211], a[60:63]
    v_mfma_f32_16x16x32_bf16 a[64:67], v[216:219], v[208:211], a[64:67]
    v_mfma_f32_16x16x32_bf16 a[68:71], v[220:223], v[208:211], a[68:71]
    v_mfma_f32_16x16x32_bf16 a[72:75], v[224:227], v[208:211], a[72:75]
    v_mfma_f32_16x16x32_bf16 a[76:79], v[228:231], v[208:211], a[76:79]
    s_waitcnt vmcnt(14)
    v_mfma_f32_16x16x32_bf16 a[0:3], v[32:35], v[16:19], a[0:3]
    v_mfma_f32_16x16x32_bf16 a[4:7], v[36:39], v[16:19], a[4:7]
    v_mfma_f32_16x16x32_bf16 a[8:11], v[40:43], v[16:19], a[8:11]
    v_mfma_f32_16x16x32_bf16 a[12:15], v[44:47], v[16:19], a[12:15]
    v_mfma_f32_16x16x32_bf16 a[16:19], v[48:51], v[16:19], a[16:19]
    v_mfma_f32_16x16x32_bf16 a[20:23], v[32:35], v[20:23], a[20:23]
    v_mfma_f32_16x16x32_bf16 a[24:27], v[36:39], v[20:23], a[24:27]
    v_mfma_f32_16x16x32_bf16 a[28:31], v[40:43], v[20:23], a[28:31]
    v_mfma_f32_16x16x32_bf16 a[32:35], v[44:47], v[20:23], a[32:35]
    v_mfma_f32_16x16x32_bf16 a[36:39], v[48:51], v[20:23], a[36:39]
    v_mfma_f32_16x16x32_bf16 a[40:43], v[32:35], v[24:27], a[40:43]
    v_mfma_f32_16x16x32_bf16 a[44:47], v[36:39], v[24:27], a[44:47]
    v_mfma_f32_16x16x32_bf16 a[48:51], v[40:43], v[24:27], a[48:51]
    v_mfma_f32_16x16x32_bf16 a[52:55], v[44:47], v[24:27], a[52:55]
    v_mfma_f32_16x16x32_bf16 a[56:59], v[48:51], v[24:27], a[56:59]
    v_mfma_f32_16x16x32_bf16 a[60:63], v[32:35], v[28:31], a[60:63]
    v_mfma_f32_16x16x32_bf16 a[64:67], v[36:39], v[28:31], a[64:67]
    v_mfma_f32_16x16x32_bf16 a[68:71], v[40:43], v[28:31], a[68:71]
    v_mfma_f32_16x16x32_bf16 a[72:75], v[44:47], v[28:31], a[72:75]
    v_mfma_f32_16x16x32_bf16 a[76:79], v[48:51], v[28:31], a[76:79]
    s_cmp_ge_u32 s3, 2
    s_cbranch_scc1 g2_red
    s_waitcnt vmcnt(5)
    v_mfma_f32_16x16x32_bf16 a[0:3], v[68:71], v[52:55], a[0:3]
    v_mfma_f32_16x16x32_bf16 a[4:7], v[72:75], v[52:55], a[4:7]
    v_mfma_f32_16x16x32_bf16 a[8:11], v[76:79], v[52:55], a[8:11]
    v_mfma_f32_16x16x32_bf16 a[12:15], v[80:83], v[52:55], a[12:15]
    v_mfma_f32_16x16x32_bf16 a[16:19], v[84:87], v[52:55], a[16:19]
    v_mfma_f32_16x16x32_bf16 a[20:23], v[68:71], v[56:59], a[20:23]
    v_mfma_f32_16x16x32_bf16 a[24:27], v[72:75], v[56:59], a[24:27]
    v_mfma_f32_16x16x32_bf16 a[28:31], v[76:79], v[56:59], a[28:31]
    v_mfma_f32_16x16x32_bf16 a[32:35], v[80:83], v[56:59], a[32:35]
    v_mfma_f32_16x16x32_bf16 a[36:39], v[84:87], v[56:59], a[36:39]
    v_mfma_f32_16x16x32_bf16 a[40:43], v[68:71], v[60:63], a[40:43]
    v_mfma_f32_16x16x32_bf16 a[44:47], v[72:75], v[60:63], a[44:47]
    v_mfma_f32_16x16x32_bf16 a[48:51], v[76:79], v[60:63], a[48:51]
    v_mfma_f32_16x16x32_bf16 a[52:55], v[80:83], v[60:63], a[52:55]
    v_mfma_f32_16x16x32_bf16 a[56:59], v[84:87], v[60:63], a[56:59]
    v_mfma_f32_16x16x32_bf16 a[60:63], v[68:71], v[64:67], a[60:63]
    v_mfma_f32_16x16x32_bf16 a[64:67], v[72:75], v[64:67], a[64:67]
    v_mfma_f32_16x16x32_bf16 a[68:71], v[76:79], v[64:67], a[68:71]
    v_mfma_f32_16x16x32_bf16 a[72:75], v[80:83], v[64:67], a[72:75]
    v_mfma_f32_16x16x32_bf16 a[76:79], v[84:87], v[64:67], a[76:79]
g2_red:
    s_waitcnt vmcnt(0)
    v_and_b32 v9, 15, v2
    v_lshrrev_b32 v10, 4, v2
    s_lshl_b32 s10, s6, 2
    s_add_u32 s10, s10, s3
    s_lshl_b32 s10, s10, 4
    v_add_u32 v11, s10, v9
    v_mul_u32_u24 v12, 1280, v11
    s_mul_i32 s11, s7, 160
    v_lshl_add_u32 v12, v10, 3, v12
    v_add_u32 v12, s11, v12
    s_nop 7
    s_cmp_eq_u32 s3, 0
    s_cbranch_scc1 g2_w0
    s_cmp_eq_u32 s3, 1
    s_cbranch_scc1 g2_w1
    s_cmp_eq_u32 s3, 2
    s_cbranch_scc1 g2_w2
    ds_write_b128 v3, a[0:3] offset:10240
    ds_write_b128 v3, a[4:7] offset:11264
    ds_write_b128 v3, a[8:11] offset:12288
    ds_write_b128 v3, a[12:15] offset:13312
    ds_write_b128 v3, a[16:19] offset:14336
    ds_write_b128 v3, a[20:23] offset:20480
    ds_write_b128 v3, a[24:27] offset:21504
    ds_write_b128 v3, a[28:31] offset:22528
    ds_write_b128 v3, a[32:35] offset:23552
    ds_write_b128 v3, a[36:39] offset:24576
    ds_write_b128 v3, a[40:43] offset:30720
    ds_write_b128 v3, a[44:47] offset:31744
    ds_write_b128 v3, a[48:51] offset:32768
    ds_write_b128 v3, a[52:55] offset:33792
    ds_write_b128 v3, a[56:59] offset:34816
    v_accvgpr_read_b32 v16, a60
    v_accvgpr_read_b32 v17, a61
    v_accvgpr_read_b32 v18, a62
    v_accvgpr_read_b32 v19, a63
    v_accvgpr_read_b32 v20, a64
    v_accvgpr_read_b32 v21, a65
    v_accvgpr_read_b32 v22, a66
    v_accvgpr_read_b32 v23, a67
    v_accvgpr_read_b32 v24, a68
    v_accvgpr_read_b32 v25, a69
    v_accvgpr_read_b32 v26, a70
    v_accvgpr_read_b32 v27, a71
    v_accvgpr_read_b32 v28, a72
    v_accvgpr_read_b32 v29, a73
    v_accvgpr_read_b32 v30, a74
    v_accvgpr_read_b32 v31, a75
    v_accvgpr_read_b32 v32, a76
    v_accvgpr_read_b32 v33, a77
    v_accvgpr_read_b32 v34, a78
    v_accvgpr_read_b32 v35, a79
    s_branch g2_join
g2_w0:
    ds_write_b128 v3, a[20:23] offset:25600
    ds_write_b128 v3, a[24:27] offset:26624
    ds_write_b128 v3, a[28:31] offset:27648
    ds_write_b128 v3, a[32:35] offset:28672
    ds_write_b128 v3, a[36:39] offset:29696
    ds_write_b128 v3, a[40:43] offset:35840
    ds_write_b128 v3, a[44:47] offset:36864
    ds_write_b128 v3, a[48:51] offset:37888
    ds_write_b128 v3, a[52:55] offset:38912
    ds_write_b128 v3, a[56:59] offset:39936
    ds_write_b128 v3, a[60:63] offset:46080
    ds_write_b128 v3, a[64:67] offset:47104
    ds_write_b128 v3, a[68:71] offset:48128
    ds_write_b128 v3, a[72:75] offset:49152
    ds_write_b128 v3, a[76:79] offset:50176
    v_accvgpr_read_b32 v16, a0
    v_accvgpr_read_b32 v17, a1
    v_accvgpr_read_b32 v18, a2
    v_accvgpr_read_b32 v19, a3
    v_accvgpr_read_b32 v20, a4
    v_accvgpr_read_b32 v21, a5
    v_accvgpr_read_b32 v22, a6
    v_accvgpr_read_b32 v23, a7
    v_accvgpr_read_b32 v24, a8
    v_accvgpr_read_b32 v25, a9
    v_accvgpr_read_b32 v26, a10
    v_accvgpr_read_b32 v27, a11
    v_accvgpr_read_b32 v28, a12
    v_accvgpr_read_b32 v29, a13
    v_accvgpr_read_b32 v30, a14
    v_accvgpr_read_b32 v31, a15
    v_accvgpr_read_b32 v32, a16
    v_accvgpr_read_b32 v33, a17
    v_accvgpr_read_b32 v34, a18
    v_accvgpr_read_b32 v35, a19
    s_branch g2_join
g2_w1:
    ds_write_b128 v3, a[0:3] offset:0
    ds_write_b128 v3, a[4:7] offset:1024
    ds_write_b128 v3, a[8:11] offset:2048
    ds_write_b128 v3, a[12:15] offset:3072
    ds_write_b128 v3, a[16:19] offset:4096
    ds_write_b128 v3, a[40:43] offset:40960
    ds_write_b128 v3, a[44:47] offset:41984
    ds_write_b128 v3, a[48:51] offset:43008
    ds_write_b128 v3, a[52:55] offset:44032
    ds_write_b128 v3, a[56:59] offset:45056
    ds_write_b128 v3, a[60:63] offset:51200
    ds_write_b128 v3, a[64:67] offset:52224
    ds_write_b128 v3, a[68:71] offset:53248
    ds_write_b128 v3, a[72:75] offset:54272
    ds_write_b128 v3, a[76:79] offset:55296
    v_accvgpr_read_b32 v16, a20
    v_accvgpr_read_b32 v17, a21
    v_accvgpr_read_b32 v18, a22
    v_accvgpr_read_b32 v19, a23
    v_accvgpr_read_b32 v20, a24
    v_accvgpr_read_b32 v21, a25
    v_accvgpr_read_b32 v22, a26
    v_accvgpr_read_b32 v23, a27
    v_accvgpr_read_b32 v24, a28
    v_accvgpr_read_b32 v25, a29
    v_accvgpr_read_b32 v26, a30
    v_accvgpr_read_b32 v27, a31
    v_accvgpr_read_b32 v28, a32
    v_accvgpr_read_b32 v29, a33
    v_accvgpr_read_b32 v30, a34
    v_accvgpr_read_b32 v31, a35
    v_accvgpr_read_b32 v32, a36
    v_accvgpr_read_b32 v33, a37
    v_accvgpr_read_b32 v34, a38
    v_accvgpr_read_b32 v35, a39
    s_branch g2_join
g2_w2:
    ds_write_b128 v3, a[0:3] offset:5120
    ds_write_b128 v3, a[4:7] offset:6144
    ds_write_b128 v3, a[8:11] offset:7168
    ds_write_b128 v3, a[12:15] offset:8192
    ds_write_b128 v3, a[16:19] offset:9216
    ds_write_b128 v3, a[20:23] offset:15360
    ds_write_b128 v3, a[24:27] offset:16384
    ds_write_b128 v3, a[28:31] offset:17408
    ds_write_b128 v3, a[32:35] offset:18432
    ds_write_b128 v3, a[36:39] offset:19456
    ds_write_b128 v3, a[60:63] offset:56320
    ds_write_b128 v3, a[64:67] offset:57344
    ds_write_b128 v3, a[68:71] offset:58368
    ds_write_b128 v3, a[72:75] offset:59392
    ds_write_b128 v3, a[76:79] offset:60416
    v_accvgpr_read_b32 v16, a40
    v_accvgpr_read_b32 v17, a41
    v_accvgpr_read_b32 v18, a42
    v_accvgpr_read_b32 v19, a43
    v_accvgpr_read_b32 v20, a44
    v_accvgpr_read_b32 v21, a45
    v_accvgpr_read_b32 v22, a46
    v_accvgpr_read_b32 v23, a47
    v_accvgpr_read_b32 v24, a48
    v_accvgpr_read_b32 v25, a49
    v_accvgpr_read_b32 v26, a50
    v_accvgpr_read_b32 v27, a51
    v_accvgpr_read_b32 v28, a52
    v_accvgpr_read_b32 v29, a53
    v_accvgpr_read_b32 v30, a54
    v_accvgpr_read_b32 v31, a55
    v_accvgpr_read_b32 v32, a56
    v_accvgpr_read_b32 v33, a57
    v_accvgpr_read_b32 v34, a58
    v_accvgpr_read_b32 v35, a59
g2_join:
    s_waitcnt lgkmcnt(0)
    s_barrier
    s_mul_i32 s12, s3, 15360
    v_add_u32 v13, s12, v3
    ds_read_b128 v[112:115], v13 offset:0
    ds_read_b128 v[116:119], v13 offset:1024
    ds_read_b128 v[120:123], v13 offset:2048
    ds_read_b128 v[124:127], v13 offset:3072
    ds_read_b128 v[128:131], v13 offset:4096
    ds_read_b128 v[132:135], v13 offset:5120
    ds_read_b128 v[136:139], v13 offset:6144
    ds_read_b128 v[140:143], v13 offset:7168
    ds_read_b128 v[144:147], v13 offset:8192
    ds_read_b128 v[148:151], v13 offset:9216
    ds_read_b128 v[152:155], v13 offset:10240
    ds_read_b128 v[156:159], v13 offset:11264
    ds_read_b128 v[160:163], v13 offset:12288
    ds_read_b128 v[164:167], v13 offset:13312
    ds_read_b128 v[168:171], v13 offset:14336
    s_waitcnt lgkmcnt(10)
    v_add_f32 v16, v16, v112
    v_add_f32 v17, v17, v113
    v_add_f32 v18, v18, v114
    v_add_f32 v19, v19, v115
    v_add_f32 v20, v20, v116
    v_add_f32 v21, v21, v117
    v_add_f32 v22, v22, v118
    v_add_f32 v23, v23, v119
    v_add_f32 v24, v24, v120
    v_add_f32 v25, v25, v121
    v_add_f32 v26, v26, v122
    v_add_f32 v27, v27, v123
    v_add_f32 v28, v28, v124
    v_add_f32 v29, v29, v125
    v_add_f32 v30, v30, v126
    v_add_f32 v31, v31, v127
    v_add_f32 v32, v32, v128
    v_add_f32 v33, v33, v129
    v_add_f32 v34, v34, v130
    v_add_f32 v35, v35, v131
    s_waitcnt lgkmcnt(5)
    v_add_f32 v16, v16, v132
    v_add_f32 v17, v17, v133
    v_add_f32 v18, v18, v134
    v_add_f32 v19, v19, v135
    v_add_f32 v20, v20, v136
    v_add_f32 v21, v21, v137
    v_add_f32 v22, v22, v138
    v_add_f32 v23, v23, v139
    v_add_f32 v24, v24, v140
    v_add_f32 v25, v25, v141
    v_add_f32 v26, v26, v142
    v_add_f32 v27, v27, v143
    v_add_f32 v28, v28, v144
    v_add_f32 v29, v29, v145
    v_add_f32 v30, v30, v146
    v_add_f32 v31, v31, v147
    v_add_f32 v32, v32, v148
    v_add_f32 v33, v33, v149
    v_add_f32 v34, v34, v150
    v_add_f32 v35, v35, v151
    s_waitcnt lgkmcnt(0)
    v_add_f32 v16, v16, v152
    v_add_f32 v17, v17, v153
    v_add_f32 v18, v18, v154
    v_add_f32 v19, v19, v155
    v_add_f32 v20, v20, v156
    v_add_f32 v21, v21, v157
    v_add_f32 v22, v22, v158
    v_add_f32 v23, v23, v159
    v_add_f32 v24, v24, v160
    v_add_f32 v25, v25, v161
    v_add_f32 v26, v26, v162
    v_add_f32 v27, v27, v163
    v_add_f32 v28, v28, v164
    v_add_f32 v29, v29, v165
    v_add_f32 v30, v30, v166
    v_add_f32 v31, v31, v167
    v_add_f32 v32, v32, v168
    v_add_f32 v33, v33, v169
    v_add_f32 v34, v34, v170
    v_add_f32 v35, v35, v171
    s_mov_b32 s92, 0xffff0000
    v_mul_u32_u24 v182, 160, v9
    v_lshl_add_u32 v182, v10, 3, v182
    v_add_u32 v182, s12, v182
    s_cmp_eq_u32 s94, 0
    s_cbranch_scc1 g2_f0
    v_cvt_pk_bf16_f32 v176, v16, v17
    v_cvt_pk_bf16_f32 v177, v18, v19
    v_lshlrev_b32 v16, 16, v176
    v_and_b32 v17, s92, v176
    v_lshlrev_b32 v18, 16, v177
    v_and_b32 v19, s92, v177
    v_lshlrev_b32 v178, 16, v232
    v_and_b32 v179, s92, v232
    v_lshlrev_b32 v180, 16, v233
    v_and_b32 v181, s92, v233
    v_add_f32 v16, v16, v178
    v_add_f32 v17, v17, v179
    v_add_f32 v18, v18, v180
    v_add_f32 v19, v19, v181
    v_cvt_pk_bf16_f32 v184, v16, v17
    v_cvt_pk_bf16_f32 v185, v18, v19
    ds_write_b64 v182, v[184:185] offset:0
    v_cvt_pk_bf16_f32 v176, v20, v21
    v_cvt_pk_bf16_f32 v177, v22, v23
    v_lshlrev_b32 v20, 16, v176
    v_and_b32 v21, s92, v176
    v_lshlrev_b32 v22, 16, v177
    v_and_b32 v23, s92, v177
    v_lshlrev_b32 v178, 16, v234
    v_and_b32 v179, s92, v234
    v_lshlrev_b32 v180, 16, v235
    v_and_b32 v181, s92, v235
    v_add_f32 v20, v20, v178
    v_add_f32 v21, v21, v179
    v_add_f32 v22, v22, v180
    v_add_f32 v23, v23, v181
    v_cvt_pk_bf16_f32 v186, v20, v21
    v_cvt_pk_bf16_f32 v187, v22, v23
    ds_write_b64 v182, v[186:187] offset:32
    v_cvt_pk_bf16_f32 v176, v24, v25
    v_cvt_pk_bf16_f32 v177, v26, v27
    v_lshlrev_b32 v24, 16, v176
    v_and_b32 v25, s92, v176
    v_lshlrev_b32 v26, 16, v177
    v_and_b32 v27, s92, v177
    v_lshlrev_b32 v178, 16, v236
    v_and_b32 v179, s92, v236
    v_lshlrev_b32 v180, 16, v237
    v_and_b32 v181, s92, v237
    v_add_f32 v24, v24, v178
    v_add_f32 v25, v25, v179
    v_add_f32 v26, v26, v180
    v_add_f32 v27, v27, v181
    v_cvt_pk_bf16_f32 v188, v24, v25
    v_cvt_pk_bf16_f32 v189, v26, v27
    ds_write_b64 v182, v[188:189] offset:64
    v_cvt_pk_bf16_f32 v176, v28, v29
    v_cvt_pk_bf16_f32 v177, v30, v31
    v_lshlrev_b32 v28, 16, v176
    v_and_b32 v29, s92, v176
    v_lshlrev_b32 v30, 16, v177
    v_and_b32 v31, s92, v177
    v_lshlrev_b32 v178, 16, v238
    v_and_b32 v179, s92, v238
    v_lshlrev_b32 v180, 16, v239
    v_and_b32 v181, s92, v239
    v_add_f32 v28, v28, v178
    v_add_f32 v29, v29, v179
    v_add_f32 v30, v30, v180
    v_add_f32 v31, v31, v181
    v_cvt_pk_bf16_f32 v190, v28, v29
    v_cvt_pk_bf16_f32 v191, v30, v31
    ds_write_b64 v182, v[190:191] offset:96
    v_cvt_pk_bf16_f32 v176, v32, v33
    v_cvt_pk_bf16_f32 v177, v34, v35
    v_lshlrev_b32 v32, 16, v176
    v_and_b32 v33, s92, v176
    v_lshlrev_b32 v34, 16, v177
    v_and_b32 v35, s92, v177
    v_lshlrev_b32 v178, 16, v240
    v_and_b32 v179, s92, v240
    v_lshlrev_b32 v180, 16, v241
    v_and_b32 v181, s92, v241
    v_add_f32 v32, v32, v178
    v_add_f32 v33, v33, v179
    v_add_f32 v34, v34, v180
    v_add_f32 v35, v35, v181
    v_cvt_pk_bf16_f32 v192, v32, v33
    v_cvt_pk_bf16_f32 v193, v34, v35
    ds_write_b64 v182, v[192:193] offset:128
    v_add_u32 v183, 0, v2
    v_mul_u32_u24 v195, 205, v183
    v_lshrrev_b32 v195, 11, v195
    v_mul_u32_u24 v194, 10, v195
    v_sub_u32 v194, v183, v194
    v_mul_u32_u24 v196, 160, v195
    v_lshl_add_u32 v196, v194, 4, v196
    v_mul_u32_u24 v200, 1280, v195
    v_lshl_add_u32 v200, v194, 4, v200
    v_add_u32 v196, s12, v196
    v_add_u32 v183, 64, v2
    v_mul_u32_u24 v195, 205, v183
    v_lshrrev_b32 v195, 11, v195
    v_mul_u32_u24 v194, 10, v195
    v_sub_u32 v194, v183, v194
    v_mul_u32_u24 v197, 160, v195
    v_lshl_add_u32 v197, v194, 4, v197
    v_mul_u32_u24 v201, 1280, v195
    v_lshl_add_u32 v201, v194, 4, v201
    v_add_u32 v197, s12, v197
    v_add_u32 v183, 128, v2
    v_mul_u32_u24 v195, 205, v183
    v_lshrrev_b32 v195, 11, v195
    v_mul_u32_u24 v194, 10, v195
    v_sub_u32 v194, v183, v194
    v_mul_u32_u24 v198, 160, v195
    v_lshl_add_u32 v198, v194, 4, v198
    v_mul_u32_u24 v202, 1280, v195
    v_lshl_add_u32 v202, v194, 4, v202
    v_add_u32 v198, s12, v198
    s_mul_i32 s13, s10, 1280
    s_add_u32 s13, s13, s11
    s_waitcnt lgkmcnt(0)
    ds_read_b128 v[204:207], v196
    ds_read_b128 v[208:211], v197
    ds_read_b128 v[212:215], v198
    s_waitcnt lgkmcnt(0)
    buffer_store_dwordx4 v[204:207], v200, s[52:55], s13 offen sc1
    buffer_store_dwordx4 v[208:211], v201, s[52:55], s13 offen sc1
    s_mov_b64 exec, 0xffffffff
    buffer_store_dwordx4 v[212:215], v202, s[52:55], s13 offen sc1
    s_mov_b64 exec, -1
    s_branch g2_fin
g2_f0:
    v_cvt_pk_bf16_f32 v176, v16, v17
    v_cvt_pk_bf16_f32 v177, v18, v19
    v_lshlrev_b32 v16, 16, v176
    v_and_b32 v17, s92, v176
    v_lshlrev_b32 v18, 16, v177
    v_and_b32 v19, s92, v177
    v_lshlrev_b32 v178, 16, v232
    v_and_b32 v179, s92, v232
    v_lshlrev_b32 v180, 16, v233
    v_and_b32 v181, s92, v233
    v_add_f32 v16, v16, v178
    v_add_f32 v17, v17, v179
    v_add_f32 v18, v18, v180
    v_add_f32 v19, v19, v181
    v_cvt_pk_bf16_f32 v184, v16, v17
    v_cvt_pk_bf16_f32 v185, v18, v19
    buffer_store_dwordx2 v[184:185], v14, s[52:55], s60 offen sc1
    v_lshlrev_b32 v40, 16, v184
    v_and_b32 v41, s92, v184
    v_lshlrev_b32 v42, 16, v185
    v_and_b32 v43, s92, v185
    v_cvt_pk_bf16_f32 v176, v20, v21
    v_cvt_pk_bf16_f32 v177, v22, v23
    v_lshlrev_b32 v20, 16, v176
    v_and_b32 v21, s92, v176
    v_lshlrev_b32 v22, 16, v177
    v_and_b32 v23, s92, v177
    v_lshlrev_b32 v178, 16, v234
    v_and_b32 v179, s92, v234
    v_lshlrev_b32 v180, 16, v235
    v_and_b32 v181, s92, v235
    v_add_f32 v20, v20, v178
    v_add_f32 v21, v21, v179
    v_add_f32 v22, v22, v180
    v_add_f32 v23, v23, v181
    v_cvt_pk_bf16_f32 v186, v20, v21
    v_cvt_pk_bf16_f32 v187, v22, v23
    buffer_store_dwordx2 v[186:187], v14, s[52:55], s61 offen sc1
    v_lshlrev_b32 v44, 16, v186
    v_and_b32 v45, s92, v186
    v_lshlrev_b32 v46, 16, v187
    v_and_b32 v47, s92, v187
    v_cvt_pk_bf16_f32 v176, v24, v25
    v_cvt_pk_bf16_f32 v177, v26, v27
    v_lshlrev_b32 v24, 16, v176
    v_and_b32 v25, s92, v176
    v_lshlrev_b32 v26, 16, v177
    v_and_b32 v27, s92, v177
    v_lshlrev_b32 v178, 16, v236
    v_and_b32 v179, s92, v236
    v_lshlrev_b32 v180, 16, v237
    v_and_b32 v181, s92, v237
    v_add_f32 v24, v24, v178
    v_add_f32 v25, v25, v179
    v_add_f32 v26, v26, v180
    v_add_f32 v27, v27, v181
    v_cvt_pk_bf16_f32 v188, v24, v25
    v_cvt_pk_bf16_f32 v189, v26, v27
    buffer_store_dwordx2 v[188:189], v14, s[52:55], s62 offen sc1
    v_lshlrev_b32 v48, 16, v188
    v_and_b32 v49, s92, v188
    v_lshlrev_b32 v50, 16, v189
    v_and_b32 v51, s92, v189
    v_cvt_pk_bf16_f32 v176, v28, v29
    v_cvt_pk_bf16_f32 v177, v30, v31
    v_lshlrev_b32 v28, 16, v176
    v_and_b32 v29, s92, v176
    v_lshlrev_b32 v30, 16, v177
    v_and_b32 v31, s92, v177
    v_lshlrev_b32 v178, 16, v238
    v_and_b32 v179, s92, v238
    v_lshlrev_b32 v180, 16, v239
    v_and_b32 v181, s92, v239
    v_add_f32 v28, v28, v178
    v_add_f32 v29, v29, v179
    v_add_f32 v30, v30, v180
    v_add_f32 v31, v31, v181
    v_cvt_pk_bf16_f32 v190, v28, v29
    v_cvt_pk_bf16_f32 v191, v30, v31
    buffer_store_dwordx2 v[190:191], v14, s[52:55], s63 offen sc1
    v_lshlrev_b32 v52, 16, v190
    v_and_b32 v53, s92, v190
    v_lshlrev_b32 v54, 16, v191
    v_and_b32 v55, s92, v191
    v_cvt_pk_bf16_f32 v176, v32, v33
    v_cvt_pk_bf16_f32 v177, v34, v35
    v_lshlrev_b32 v32, 16, v176
    v_and_b32 v33, s92, v176
    v_lshlrev_b32 v34, 16, v177
    v_and_b32 v35, s92, v177
    v_lshlrev_b32 v178, 16, v240
    v_and_b32 v179, s92, v240
    v_lshlrev_b32 v180, 16, v241
    v_and_b32 v181, s92, v241
    v_add_f32 v32, v32, v178
    v_add_f32 v33, v33, v179
    v_add_f32 v34, v34, v180
    v_add_f32 v35, v35, v181
    v_cvt_pk_bf16_f32 v192, v32, v33
    v_cvt_pk_bf16_f32 v193, v34, v35
    buffer_store_dwordx2 v[192:193], v14, s[52:55], s64 offen sc1
    v_lshlrev_b32 v56, 16, v192
    v_and_b32 v57, s92, v192
    v_lshlrev_b32 v58, 16, v193
    v_and_b32 v59, s92, v193
    v_add_f32 v176, v40, v41
    v_add_f32 v176, v176, v42
    v_add_f32 v176, v176, v43
    v_add_f32 v176, v176, v44
    v_add_f32 v176, v176, v45
    v_add_f32 v176, v176, v46
    v_add_f32 v176, v176, v47
    v_add_f32 v176, v176, v48
    v_add_f32 v176, v176, v49
    v_add_f32 v176, v176, v50
    v_add_f32 v176, v176, v51
    v_add_f32 v176, v176, v52
    v_add_f32 v176, v176, v53
    v_add_f32 v176, v176, v54
    v_add_f32 v176, v176, v55
    v_add_f32 v176, v176, v56
    v_add_f32 v176, v176, v57
    v_add_f32 v176, v176, v58
    v_add_f32 v176, v176, v59
    v_mov_b32 v178, v176
    s_nop 1
    v_permlane16_swap_b32 v176, v178
    s_nop 1
    v_add_f32 v176, v176, v178
    v_mov_b32 v178, v176
    s_nop 1
    v_permlane32_swap_b32 v176, v178
    s_nop 1
    v_add_f32 v176, v176, v178
    s_mov_b32 s91, 0x3c4ccccd
    v_mul_f32 v178, s91, v176
    v_sub_f32 v40, v40, v178
    v_sub_f32 v41, v41, v178
    v_sub_f32 v42, v42, v178
    v_sub_f32 v43, v43, v178
    v_sub_f32 v44, v44, v178
    v_sub_f32 v45, v45, v178
    v_sub_f32 v46, v46, v178
    v_sub_f32 v47, v47, v178
    v_sub_f32 v48, v48, v178
    v_sub_f32 v49, v49, v178
    v_sub_f32 v50, v50, v178
    v_sub_f32 v51, v51, v178
    v_sub_f32 v52, v52, v178
    v_sub_f32 v53, v53, v178
    v_sub_f32 v54, v54, v178
    v_sub_f32 v55, v55, v178
    v_sub_f32 v56, v56, v178
    v_sub_f32 v57, v57, v178
    v_sub_f32 v58, v58, v178
    v_sub_f32 v59, v59, v178
    v_mul_f32 v177, v40, v40
    v_fma_f32 v177, v41, v41, v177
    v_fma_f32 v177, v42, v42, v177
    v_fma_f32 v177, v43, v43, v177
    v_fma_f32 v177, v44, v44, v177
    v_fma_f32 v177, v45, v45, v177
    v_fma_f32 v177, v46, v46, v177
    v_fma_f32 v177, v47, v47, v177
    v_fma_f32 v177, v48, v48, v177
    v_fma_f32 v177, v49, v49, v177
    v_fma_f32 v177, v50, v50, v177
    v_fma_f32 v177, v51, v51, v177
    v_fma_f32 v177, v52, v52, v177
    v_fma_f32 v177, v53, v53, v177
    v_fma_f32 v177, v54, v54, v177
    v_fma_f32 v177, v55, v55, v177
    v_fma_f32 v177, v56, v56, v177
    v_fma_f32 v177, v57, v57, v177
    v_fma_f32 v177, v58, v58, v177
    v_fma_f32 v177, v59, v59, v177
    v_mov_b32 v178, v177
    s_nop 1
    v_permlane16_swap_b32 v177, v178
    s_nop 1
    v_add_f32 v177, v177, v178
    v_mov_b32 v178, v177
    s_nop 1
    v_permlane32_swap_b32 v177, v178
    s_nop 1
    v_add_f32 v177, v177, v178
    v_lshlrev_b32 v11, 6, v11
    s_lshl_b32 s11, s7, 3
    v_add_u32 v11, s11, v11
    buffer_store_dwordx2 v[176:177], v11, s[56:59], 0 offen sc1
g2_fin:
    s_waitcnt vmcnt(0)
    s_endpgm
g2_exit:
    s_endpgm
.section .rodata,"a"
.p2align 6
.amdhsa_kernel k0_kernel
  .amdhsa_next_free_vgpr 112
  .amdhsa_next_free_sgpr 102
  .amdhsa_accum_offset 112
  .amdhsa_group_segment_fixed_size 0
  .amdhsa_kernarg_size 96
  .amdhsa_user_sgpr_count 2
  .amdhsa_user_sgpr_kernarg_segment_ptr 1
  .amdhsa_system_sgpr_workgroup_id_x 1
.end_amdhsa_kernel
.p2align 6
.amdhsa_kernel k1_kernel
  .amdhsa_next_free_vgpr 192
  .amdhsa_next_free_sgpr 102
  .amdhsa_accum_offset 192
  .amdhsa_group_segment_fixed_size 0
  .amdhsa_kernarg_size 96
  .amdhsa_user_sgpr_count 2
  .amdhsa_user_sgpr_kernarg_segment_ptr 1
  .amdhsa_system_sgpr_workgroup_id_x 1
.end_amdhsa_kernel
.p2align 6
.amdhsa_kernel g1a_kernel
  .amdhsa_next_free_vgpr 256
  .amdhsa_next_free_sgpr 102
  .amdhsa_accum_offset 104
  .amdhsa_group_segment_fixed_size 0
  .amdhsa_kernarg_size 96
  .amdhsa_user_sgpr_count 2
  .amdhsa_user_sgpr_kernarg_segment_ptr 1
  .amdhsa_system_sgpr_workgroup_id_x 1
.end_amdhsa_kernel
.p2align 6
.amdhsa_kernel g2a_kernel
  .amdhsa_next_free_vgpr 324
  .amdhsa_next_free_sgpr 102
  .amdhsa_accum_offset 244
  .amdhsa_group_segment_fixed_size 0
  .amdhsa_kernarg_size 96
  .amdhsa_user_sgpr_count 2
  .amdhsa_user_sgpr_kernarg_segment_ptr 1
  .amdhsa_system_sgpr_workgroup_id_x 1
.end_amdhsa_kernel
.p2align 6
.amdhsa_kernel g1b_kernel
  .amdhsa_next_free_vgpr 256
  .amdhsa_next_free_sgpr 102
  .amdhsa_accum_offset 104
  .amdhsa_group_segment_fixed_size 0
  .amdhsa_kernarg_size 96
  .amdhsa_user_sgpr_count 2
  .amdhsa_user_sgpr_kernarg_segment_ptr 1
  .amdhsa_system_sgpr_workgroup_id_x 1
.end_amdhsa_kernel
.p2align 6
.amdhsa_kernel g2b_kernel
  .amdhsa_next_free_vgpr 324
  .amdhsa_next_free_sgpr 102
  .amdhsa_accum_offset 244
  .amdhsa_group_segment_fixed_size 0
  .amdhsa_kernarg_size 96
  .amdhsa_user_sgpr_count 2
  .amdhsa_user_sgpr_kernarg_segment_ptr 1
  .amdhsa_system_sgpr_workgroup_id_x 1
.end_amdhsa_kernel
```
